```python
import torch

def _softmax(x, axis=-1):
    return torch.softmax(x, dim=axis)
def _gelu(x):
    return torch.nn.functional.gelu(x, approximate="tanh")
def _silu(x):
    return torch.nn.functional.silu(x)
def _sigmoid(x):
    return torch.sigmoid(x)
def _layernorm(x, axis=-1, eps=1e-5):
    m = x.mean(dim=axis, keepdim=True)
    v = x.var(dim=axis, keepdim=True, unbiased=False)
    return (x - m) / torch.sqrt(v + eps)
def _scatter_add(tgt, idx, src, axis=0):
    return tgt.clone().index_add_(axis, idx, src)
def _segment_sum(src, seg, n):
    out = torch.zeros((n,) + src.shape[1:], dtype=src.dtype)
    return out.index_add_(0, seg, src)
def _pad(x, pw):
    flat = tuple(v for pair in reversed(pw) for v in pair)
    return torch.nn.functional.pad(x, flat)

kernel_name = 'standalone__kv_cache_quant_int4_int2_kv_with_per_channel_or_per_token_scales__prompt'

def setup_inputs():

    _w = (lambda a: (lambda t: t.to(torch.bfloat16) if t.is_floating_point() else t)(torch.as_tensor(a)))
    B = 1
    Sq = 2048
    Skv = 2048
    Hq = 32
    Hkv = 4
    Dh = 128
    bits = 4
    G = 128
    if G <= 0 or G >= Skv:
        G = max(1, Skv // 2)
    Skv = (Skv // G) * G
    ngk = Skv // G
    qmax = (1 << bits) - 1
    return {
        "q": _w((lambda *s: torch.randn(*s, dtype=torch.bfloat16) * 1.6)(B, Hq, Sq, Dh)),
        "qk": _w(torch.randint(0, qmax + 1, (B, Hkv, Skv, Dh)).to(torch.int32)),
        "qv": _w(torch.randint(0, qmax + 1, (B, Hkv, Skv, Dh)).to(torch.int32)),
        "k_scales": _w(torch.abs((lambda *s: torch.randn(*s, dtype=torch.bfloat16) * 1.6)(B, Hkv, ngk, Dh)) * 0.05 + 0.02),
        "k_zeros": _w((lambda *s: torch.randn(*s, dtype=torch.bfloat16) * 1.6)(B, Hkv, ngk, Dh) + float(qmax) / 2.0),
        "v_scales": _w(torch.abs((lambda *s: torch.randn(*s, dtype=torch.bfloat16) * 0.05)(B, Hkv, Skv, 1)) * 0.05 + 0.02),
        "v_zeros": _w((lambda *s: torch.randn(*s, dtype=torch.bfloat16) * 0.05)(B, Hkv, Skv, 1) + float(qmax) / 2.0),
    }

def reference(q, qk, qv, k_scales, k_zeros, v_scales, v_zeros):
    B, Hq, Sq, Dh = q.shape
    Hkv, Skv = qk.shape[1], qk.shape[2]
    ngk = k_scales.shape[2]
    G = Skv // ngk
    ks = (lambda x, n, axis: torch.repeat_interleave(x, n, dim=axis))(k_scales, G, axis=2)
    kz = (lambda x, n, axis: torch.repeat_interleave(x, n, dim=axis))(k_zeros, G, axis=2)
    k = ((lambda x, dt: x.to(dt))(qk, q.dtype) - kz) * ks
    v = ((lambda x, dt: x.to(dt))(qv, q.dtype) - v_zeros) * v_scales
    rep = Hq // Hkv
    if rep > 1:
        k = (lambda x, n, axis: torch.repeat_interleave(x, n, dim=axis))(k, rep, axis=1)
        v = (lambda x, n, axis: torch.repeat_interleave(x, n, dim=axis))(v, rep, axis=1)
    scale = float(Dh) ** -0.5
    logits = torch.einsum("bhqd,bhkd->bhqk", q, k) * scale
    p = _softmax(logits, axis=-1)
    o = torch.einsum("bhqk,bhkd->bhqd", p, v)
    return o
```

```asm
; @launch grid=(256,1,1) block=(256,1,1) lds=155648
.amdgcn_target "amdgcn-amd-amdhsa--gfx950"
.text
.globl standalone__kv_cache_quant_int4_int2_kv_with_per_channel_or_per_token_scales__prompt_kernel
.p2align 8
.type standalone__kv_cache_quant_int4_int2_kv_with_per_channel_or_per_token_scales__prompt_kernel,@function
standalone__kv_cache_quant_int4_int2_kv_with_per_channel_or_per_token_scales__prompt_kernel:
    s_cmp_ge_u32 s2, 256
    s_cbranch_scc1 Lend
    s_load_dwordx16 s[36:51], s[0:1], 0
    s_load_dwordx4 s[52:55], s[0:1], 64
    s_getpc_b64 s[10:11]
Lpc:
    v_lshlrev_b32 v7, 6, v0
    s_lshr_b32 s3, s2, 3
    s_mul_i32 s3, s3, 1152
    v_mul_u32_u24 v7, 9, v0
    v_lshrrev_b32 v7, 3, v7
    v_lshlrev_b32 v7, 2, v7
    v_add_u32 v7, s3, v7
    global_load_dword v255, v7, s[10:11]
    s_add_u32 s10, s10, Lpost-Lpc
    s_addc_u32 s11, s11, 0
    v_lshrrev_b32 v7, 6, v0
    v_and_b32 v2, 63, v0
    v_readfirstlane_b32 s16, v7
    s_and_b32 s3, s2, 7
    s_lshl_b32 s3, s3, 5
    s_lshr_b32 s4, s2, 3
    s_add_u32 s33, s3, s4
    s_lshr_b32 s32, s33, 6
    s_lshl_b32 s34, s33, 16
    s_and_b32 s61, s33, 63
    s_and_b32 s18, s61, 1
    s_lshr_b32 s3, s61, 1
    s_add_u32 s3, s3, 58
    s_and_b32 s3, s3, 63
    s_lshl_b32 s33, s32, 6
    s_add_u32 s33, s33, s3
    s_mov_b32 s28, 0x3e0293ee
    s_mov_b32 s29, 0xffff0000
    s_mov_b32 s30, 0xff800000
    s_mov_b32 s31, 0x007f0000
    v_and_b32 v14, 15, v0
    v_bfe_u32 v15, v0, 4, 2
    s_lshl_b32 s56, s33, 14
    s_lshl_b32 s57, s18, 13
    s_add_u32 s57, s57, s56
    s_lshl_b32 s59, s16, 7
    s_add_u32 s57, s57, s59
    v_lshl_add_u32 v8, v14, 9, s57
    v_lshl_add_u32 v8, v15, 5, v8
    s_lshr_b32 s57, s33, 2
    s_lshl2_add_u32 s57, s57, s16
    s_lshl_b32 s57, s57, 6
    v_lshl_add_u32 v9, v15, 4, s57
    s_lshr_b32 s57, s16, 1
    s_lshl1_add_u32 s57, s18, s57
    s_lshl_b32 s57, s57, 7
    s_add_u32 s57, s57, s56
    s_and_b32 s58, s16, 1
    s_lshl2_add_u32 s57, s58, s57
    v_lshl_add_u32 v10, v15, 11, s57
    v_lshl_add_u32 v10, v14, 3, v10
    v_add_u32 v11, 0x2000, v10
    s_lshl_b32 s57, s33, 6
    v_lshl_add_u32 v12, v15, 3, s57
    v_lshlrev_b32 v2, 4, v2
    s_lshl_b32 s56, s32, 13
    s_add_u32 s56, s56, 4194304
    v_lshl_add_u32 v250, v2, 3, s56
    s_lshl_b32 s56, s32, 6
    v_lshrrev_b32 v252, 4, v2
    v_add_u32 v252, s56, v252
    s_and_b32 s26, s61, 31
    s_or_b32 s26, s26, s16
    v_lshlrev_b32 v1, 8, v14
    v_lshl_add_u32 v1, v15, 4, v1
    v_lshl_add_u32 v1, v7, 14, v1
    v_lshl_add_u32 v4, v7, 12, v2
    s_lshl_b32 s35, s32, 20
    s_cmp_eq_u32 s26, 0
    s_waitcnt lgkmcnt(0)
    s_cbranch_scc0 Lnl1
    s_bfm_b64 exec, 32, s61
    global_load_dword v251, v250, s[54:55] sc1
    s_mov_b64 exec, -1
Lnl1:
    global_load_dwordx4 v[32:35], v9, s[42:43]
    global_load_dwordx4 v[40:43], v9, s[44:45]
    global_load_dwordx2 v[64:65], v12, s[46:47]
    global_load_dwordx2 v[66:67], v12, s[46:47] offset:32
    s_cbranch_scc0 Lnl2
    s_mov_b32 s58, -1
    s_mov_b32 s59, 0
    s_lshl_b64 s[58:59], s[58:59], s61
    s_waitcnt vmcnt(4)
    v_and_b32 v251, 3, v251
    v_xor_b32 v251, 7, v251
    s_mov_b64 exec, s[58:59]
    global_store_byte v252, v251, s[52:53] sc1
    s_mov_b64 exec, -1
Lnl2:
    global_load_dwordx4 v[16:19], v8, s[38:39] offset:0
    global_load_dwordx4 v[20:23], v8, s[38:39] offset:16
    global_load_dword v48, v10, s[40:41] offset:0
    global_load_dword v49, v10, s[40:41] offset:512
    global_load_dword v50, v10, s[40:41] offset:1024
    global_load_dword v51, v10, s[40:41] offset:1536
    global_load_dword v52, v11, s[40:41] offset:0
    global_load_dword v53, v11, s[40:41] offset:512
    global_load_dword v54, v11, s[40:41] offset:1024
    global_load_dword v55, v11, s[40:41] offset:1536
    v_lshrrev_b32 v13, 2, v0
    v_lshlrev_b32 v13, 6, v13
    v_and_b32 v7, 3, v0
    v_lshl_add_u32 v13, v7, 3, v13
    s_lshl_b32 s56, s32, 12
    v_add_u32 v13, s56, v13
    global_load_dwordx2 v[80:81], v13, s[46:47]
    global_load_dwordx2 v[82:83], v13, s[46:47] offset:32
    global_load_dwordx2 v[84:85], v13, s[48:49]
    global_load_dwordx2 v[86:87], v13, s[48:49] offset:32
    s_add_u32 s4, s36, s34
    s_addc_u32 s5, s37, 0
    s_add_u32 s34, s34, 0x1000
    s_lshl_b32 s60, s16, 12
    s_lshl_b32 s56, s16, 14
    v_lshlrev_b32 v240, 2, v15
    v_xor_b32 v240, v14, v240
    v_lshlrev_b32 v240, 4, v240
    v_lshl_add_u32 v240, v15, 8, v240
    v_add_u32 v240, s56, v240
    v_mov_b32 v7, v240
    s_add_u32 m0, s60, 98304
    s_add_u32 s62, s4, 0
    s_addc_u32 s63, s5, 0
    global_load_lds_dwordx4 v7, s[62:63] offset:0
    global_load_lds_dwordx4 v7, s[62:63] offset:1024
    global_load_lds_dwordx4 v7, s[62:63] offset:2048
    s_add_u32 s8, s54, s35
    s_addc_u32 s9, s55, 0
    s_add_u32 s12, s50, s34
    s_addc_u32 s13, s51, 0
    s_add_u32 s14, s12, 0x2000
    s_addc_u32 s15, s13, 0
    v_add_u32 v173, 0x10000, v2
    v_mov_b32 v3, v173
    v_lshlrev_b32 v174, 4, v15
    v_add_u32 v174, 131072, v174
    v_add_u32 v5, 1792, v174
    v_and_b32 v175, 7, v0
    v_xor_b32 v175, v15, v175
    v_lshlrev_b32 v175, 4, v175
    v_lshl_add_u32 v175, v15, 7, v175
    v_add_u32 v175, 139264, v175
    v_add_u32 v6, 3072, v175
    v_bfe_u32 v13, v0, 2, 1
    v_mul_u32_u24 v13, 0xaaaa, v13
    v_add_u32 v172, 0x4444, v13
    s_movk_i32 s23, 0x4000
    s_mov_b32 s24, 0xc000
    s_mov_b32 s25, 0x1ffff
    s_mov_b32 s20, 0x57800000
    s_mov_b32 s21, 0x1b800000
    s_mov_b32 s17, 5
    v_xor_b32 v8, 0x80000, v8
    v_accvgpr_write_b32 a204, v8
    v_xor_b32 v9, 0x800, v9
    v_accvgpr_write_b32 a205, v9
    v_xor_b32 v10, 0x80000, v10
    v_accvgpr_write_b32 a206, v10
    v_xor_b32 v12, 0x800, v12
    v_accvgpr_write_b32 a207, v12
    s_mov_b32 s22, 0x41800000
    s_and_b32 s56, s33, 63
    s_lshr_b32 s57, s56, 1
    s_lshl_b32 s57, s57, 15
    s_and_b32 s56, s56, 1
    s_lshl2_add_u32 s59, s18, s16
    s_lshl3_add_u32 s58, s56, s59
    s_lshl_b32 s58, s58, 10
    s_add_u32 s58, s58, s57
    s_lshl1_add_u32 s59, s59, s56
    s_lshl_b32 s59, s59, 10
    s_add_u32 s57, s57, s59
    s_add_u32 s57, s57, 0x4000
    v_add_u32 v70, s58, v2
    v_add_u32 v71, s57, v2
    s_waitcnt vmcnt(17)
    v_lshlrev_b32 v88, 16, v32
    v_lshlrev_b32 v104, 16, v40
    v_mul_f32 v88, s28, v88
    v_and_b32 v89, s29, v32
    v_and_b32 v105, s29, v40
    v_mul_f32 v89, s28, v89
    v_lshlrev_b32 v90, 16, v33
    v_lshlrev_b32 v106, 16, v41
    v_mul_f32 v90, s28, v90
    v_and_b32 v91, s29, v33
    v_and_b32 v107, s29, v41
    v_mul_f32 v91, s28, v91
    v_lshlrev_b32 v92, 16, v34
    v_lshlrev_b32 v108, 16, v42
    v_mul_f32 v92, s28, v92
    v_and_b32 v93, s29, v34
    v_and_b32 v109, s29, v42
    v_mul_f32 v93, s28, v93
    v_lshlrev_b32 v94, 16, v35
    v_lshlrev_b32 v110, 16, v43
    v_mul_f32 v94, s28, v94
    v_and_b32 v95, s29, v35
    v_and_b32 v111, s29, v43
    v_mul_f32 v95, s28, v95
    v_lshlrev_b32 v120, 16, v64
    v_and_b32 v120, s30, v120
    v_mul_f32 v128, 0x41800000, v120
    v_and_b32 v121, s30, v64
    v_mul_f32 v129, 0x41800000, v121
    v_lshlrev_b32 v122, 16, v65
    v_and_b32 v122, s30, v122
    v_mul_f32 v130, 0x41800000, v122
    v_and_b32 v123, s30, v65
    v_mul_f32 v131, 0x41800000, v123
    v_lshlrev_b32 v124, 16, v66
    v_and_b32 v124, s30, v124
    v_mul_f32 v132, 0x41800000, v124
    v_and_b32 v125, s30, v66
    v_mul_f32 v133, 0x41800000, v125
    v_lshlrev_b32 v126, 16, v67
    v_and_b32 v126, s30, v126
    v_mul_f32 v134, 0x41800000, v126
    v_and_b32 v127, s30, v67
    v_mul_f32 v135, 0x41800000, v127
    s_waitcnt vmcnt(15)
    v_cvt_f32_i32 v16, v16
    v_cvt_f32_i32 v17, v17
    v_cvt_f32_i32 v18, v18
    v_cvt_f32_i32 v19, v19
    v_cvt_f32_i32 v20, v20
    v_cvt_f32_i32 v21, v21
    v_cvt_f32_i32 v22, v22
    v_cvt_f32_i32 v23, v23
    v_pk_add_f32 v[16:17], v[16:17], v[104:105] neg_lo:[0,1] neg_hi:[0,1]
    v_pk_add_f32 v[18:19], v[18:19], v[106:107] neg_lo:[0,1] neg_hi:[0,1]
    v_pk_add_f32 v[20:21], v[20:21], v[108:109] neg_lo:[0,1] neg_hi:[0,1]
    v_pk_add_f32 v[22:23], v[22:23], v[110:111] neg_lo:[0,1] neg_hi:[0,1]
    v_pk_mul_f32 v[16:17], v[16:17], v[88:89]
    v_pk_mul_f32 v[18:19], v[18:19], v[90:91]
    v_pk_mul_f32 v[20:21], v[20:21], v[92:93]
    v_pk_mul_f32 v[22:23], v[22:23], v[94:95]
    v_cvt_pk_bf16_f32 v72, v16, v17
    v_cvt_pk_bf16_f32 v73, v18, v19
    v_cvt_pk_bf16_f32 v74, v20, v21
    v_cvt_pk_bf16_f32 v75, v22, v23
    global_store_dwordx4 v70, v[72:75], s[8:9] sc1
    s_waitcnt vmcnt(8)
    v_cvt_f32_i32 v48, v48
    v_cvt_f32_i32 v49, v49
    v_cvt_f32_i32 v50, v50
    v_cvt_f32_i32 v51, v51
    v_cvt_f32_i32 v52, v52
    v_cvt_f32_i32 v53, v53
    v_cvt_f32_i32 v54, v54
    v_cvt_f32_i32 v55, v55
    v_pk_fma_f32 v[48:49], v[48:49], v[120:121], v[128:129]
    v_pk_fma_f32 v[50:51], v[50:51], v[122:123], v[130:131]
    v_pk_fma_f32 v[52:53], v[52:53], v[124:125], v[132:133]
    v_pk_fma_f32 v[54:55], v[54:55], v[126:127], v[134:135]
    v_cvt_pk_bf16_f32 v76, v48, v49
    v_cvt_pk_bf16_f32 v77, v50, v51
    v_cvt_pk_bf16_f32 v78, v52, v53
    v_cvt_pk_bf16_f32 v79, v54, v55
    global_store_dwordx4 v71, v[76:79], s[8:9] sc1
    s_xor_b32 s58, s58, 0x80000
    s_add_u32 s64, s8, s58
    s_addc_u32 s65, s9, 0
    s_xor_b32 s57, s57, 0x80000
    s_add_u32 s66, s8, s57
    s_addc_u32 s67, s9, 0
    s_barrier
    s_cmp_eq_u32 s16, 0
    s_cbranch_scc0 Lnoe
    global_load_ubyte v251, v252, s[52:53] sc1
Lnoe:
    s_barrier
    s_add_u32 m0, s60, 98304
    s_add_u32 s62, s4, 0
    s_addc_u32 s63, s5, 0
    global_load_lds_dwordx4 v7, s[62:63] offset:3072
    s_add_u32 m0, s60, 114688
    s_add_u32 s62, s4, 4096
    s_addc_u32 s63, s5, 0
    global_load_lds_dwordx4 v7, s[62:63] offset:0
    global_load_lds_dwordx4 v7, s[62:63] offset:1024
    s_lshl_b32 s56, s2, 2
    s_add_u32 s56, s56, s16
    s_lshl_b32 s56, s56, 7
    s_add_u32 s56, s56, 4227072
    v_mov_b32 v249, s56
    v_accvgpr_write_b32 a208, 0
    v_mov_b32 v152, 0
    v_mov_b32 v153, 0
    v_mov_b32 v154, 0
    v_mov_b32 v155, 0
    v_mov_b32 v156, 0
    v_mov_b32 v157, 0
    v_mov_b32 v158, 0
    v_mov_b32 v159, 0
    v_mov_b32 v160, 0
    v_mov_b32 v161, 0
    v_mov_b32 v162, 0
    v_mov_b32 v163, 0
    v_mov_b32 v164, 0
    v_mov_b32 v165, 0
    v_mov_b32 v166, 0
    v_mov_b32 v167, 0
    s_waitcnt vmcnt(3)
    s_barrier
    s_cmp_eq_u32 s16, 0
    s_cbranch_scc0 Lnoflag
    s_mov_b32 s57, 0
    s_lshl_b64 s[58:59], 1, s61
    s_mov_b64 exec, s[58:59]
Lechk:
    v_cmp_gt_u32 vcc, 4, v251
    s_cbranch_vccz Lhave_e
    global_load_ubyte v251, v252, s[52:53] sc1
    s_add_u32 s57, s57, 1
    s_cmp_gt_u32 s57, 65536
    s_waitcnt vmcnt(0)
    s_cbranch_scc0 Lechk
    s_branch Lno_e
Lhave_e:
    v_xor_b32 v13, 2, v251
    v_readfirstlane_b32 s58, v250
    v_readfirstlane_b32 s59, v251
    global_store_dword v250, v13, s[54:55] sc1
    s_mov_b64 exec, -1
    v_mov_b32 v249, s58
    v_mov_b32 v251, s59
    v_accvgpr_write_b32 a208, v251
Lno_e:
    s_mov_b64 exec, -1
Lnoflag:
    s_add_u32 m0, s60, 114688
    s_add_u32 s62, s4, 4096
    s_addc_u32 s63, s5, 0
    global_load_lds_dwordx4 v7, s[62:63] offset:2048
    global_load_lds_dwordx4 v7, s[62:63] offset:3072
    v_lshrrev_b32 v14, 2, v0
    v_and_b32 v7, 3, v0
    v_lshlrev_b32 v7, 4, v7
    v_lshl_add_u32 v13, v14, 7, v7
    v_add_u32 v13, 131072, v13
    v_lshrrev_b32 v14, 1, v0
    v_lshlrev_b32 v14, 7, v14
    v_and_b32 v7, 1, v0
    v_lshl_add_u32 v14, v7, 3, v14
    v_bfe_u32 v7, v0, 1, 2
    v_lshl_add_u32 v14, v7, 4, v14
    v_add_u32 v14, 139264, v14
    v_xor_b32 v9, 16, v14
    v_xor_b32 v10, 32, v14
    v_xor_b32 v11, 48, v14
    v_lshlrev_b32 v96, 16, v80
    v_lshlrev_b32 v104, 16, v84
    v_and_b32 v97, s29, v80
    v_and_b32 v105, s29, v84
    v_lshlrev_b32 v98, 16, v81
    v_lshlrev_b32 v106, 16, v85
    v_and_b32 v99, s29, v81
    v_and_b32 v107, s29, v85
    v_lshlrev_b32 v100, 16, v82
    v_lshlrev_b32 v108, 16, v86
    v_and_b32 v101, s29, v82
    v_and_b32 v109, s29, v86
    v_lshlrev_b32 v102, 16, v83
    v_lshlrev_b32 v110, 16, v87
    v_and_b32 v103, s29, v83
    v_and_b32 v111, s29, v87
    v_and_b32 v88, s30, v96
    v_and_or_b32 v96, v96, s31, 1.0
    v_and_b32 v89, s30, v97
    v_and_or_b32 v97, v97, s31, 1.0
    v_and_b32 v90, s30, v98
    v_and_or_b32 v98, v98, s31, 1.0
    v_and_b32 v91, s30, v99
    v_and_or_b32 v99, v99, s31, 1.0
    v_and_b32 v92, s30, v100
    v_and_or_b32 v100, v100, s31, 1.0
    v_and_b32 v93, s30, v101
    v_and_or_b32 v101, v101, s31, 1.0
    v_and_b32 v94, s30, v102
    v_and_or_b32 v102, v102, s31, 1.0
    v_and_b32 v95, s30, v103
    v_and_or_b32 v103, v103, s31, 1.0
    v_log_f32 v112, v96
    v_rcp_f32 v120, v96
    v_mul_f32 v104, v104, v88
    v_mul_f32 v88, 0x41800000, v88
    v_log_f32 v113, v97
    v_rcp_f32 v121, v97
    v_mul_f32 v105, v105, v89
    v_mul_f32 v89, 0x41800000, v89
    v_log_f32 v114, v98
    v_rcp_f32 v122, v98
    v_mul_f32 v106, v106, v90
    v_mul_f32 v90, 0x41800000, v90
    v_log_f32 v115, v99
    v_rcp_f32 v123, v99
    v_mul_f32 v107, v107, v91
    v_mul_f32 v91, 0x41800000, v91
    v_log_f32 v116, v100
    v_rcp_f32 v124, v100
    v_mul_f32 v108, v108, v92
    v_mul_f32 v92, 0x41800000, v92
    v_log_f32 v117, v101
    v_rcp_f32 v125, v101
    v_mul_f32 v109, v109, v93
    v_mul_f32 v93, 0x41800000, v93
    v_log_f32 v118, v102
    v_rcp_f32 v126, v102
    v_mul_f32 v110, v110, v94
    v_mul_f32 v94, 0x41800000, v94
    v_log_f32 v119, v103
    v_rcp_f32 v127, v103
    v_mul_f32 v111, v111, v95
    v_mul_f32 v95, 0x41800000, v95
    v_add_f32 v112, 0xc1400000, v112
    v_add_f32 v113, 0xc1400000, v113
    v_add_f32 v114, 0xc1400000, v114
    v_add_f32 v115, 0xc1400000, v115
    v_add_f32 v116, 0xc1400000, v116
    v_add_f32 v117, 0xc1400000, v117
    v_add_f32 v118, 0xc1400000, v118
    v_add_f32 v119, 0xc1400000, v119
    ds_write_b128 v13, v[112:115]
    ds_write_b128 v13, v[116:119] offset:64
    v_cvt_pk_bf16_f32 v128, v88, v89
    v_cvt_pk_bf16_f32 v132, v104, v105
    v_cvt_pk_bf16_f32 v136, v120, v121
    v_cvt_pk_bf16_f32 v130, v90, v91
    v_cvt_pk_bf16_f32 v134, v106, v107
    v_cvt_pk_bf16_f32 v138, v122, v123
    v_cvt_pk_bf16_f32 v129, v92, v93
    v_cvt_pk_bf16_f32 v133, v108, v109
    v_cvt_pk_bf16_f32 v137, v124, v125
    v_cvt_pk_bf16_f32 v131, v94, v95
    v_cvt_pk_bf16_f32 v135, v110, v111
    v_cvt_pk_bf16_f32 v139, v126, v127
    v_lshlrev_b32 v96, 16, v136
    v_sub_f32 v120, v120, v96
    v_and_b32 v97, s29, v136
    v_sub_f32 v121, v121, v97
    v_lshlrev_b32 v98, 16, v138
    v_sub_f32 v122, v122, v98
    v_and_b32 v99, s29, v138
    v_sub_f32 v123, v123, v99
    v_lshlrev_b32 v100, 16, v137
    v_sub_f32 v124, v124, v100
    v_and_b32 v101, s29, v137
    v_sub_f32 v125, v125, v101
    v_lshlrev_b32 v102, 16, v139
    v_sub_f32 v126, v126, v102
    v_and_b32 v103, s29, v139
    v_sub_f32 v127, v127, v103
    v_cvt_pk_bf16_f32 v140, v120, v121
    v_cvt_pk_bf16_f32 v142, v122, v123
    v_cvt_pk_bf16_f32 v141, v124, v125
    v_cvt_pk_bf16_f32 v143, v126, v127
    ds_write2_b64 v14, v[128:129], v[130:131] offset1:8
    ds_write2_b64 v9, v[132:133], v[134:135] offset1:8
    ds_write2_b64 v10, v[136:137], v[138:139] offset1:8
    ds_write2_b64 v11, v[140:141], v[142:143] offset1:8
    s_waitcnt lgkmcnt(0)
    v_lshlrev_b32 v12, 5, v0
    v_mov_b32 v7, v240
    v_and_b32 v14, 15, v0
    v_and_b32 v13, 3, v0
    v_lshlrev_b32 v13, 6, v13
    v_lshl_add_u32 v13, v14, 8, v13
    v_lshl_add_u32 v13, v15, 4, v13
    v_add_u32 v13, s60, v13
    v_add_u32 v8, 0x10000, v13
    v_xor_b32 v9, 64, v8
    v_xor_b32 v10, 128, v8
    v_xor_b32 v11, 192, v8
    s_cmp_eq_u32 s16, 0
    s_cbranch_scc0 Ltouch
Lpoll:
    global_load_ubyte v13, v252, s[52:53] sc1
    global_load_dword v14, v250, s[54:55] sc1
    s_add_u32 s57, s57, 1
    s_cmp_gt_u32 s57, 65536
    s_cbranch_scc1 Lgiveup
    s_waitcnt vmcnt(0)
    v_and_b32 v13, 5, v13
    v_and_or_b32 v14, v14, 1, 4
    v_cmp_ne_u32 vcc, v13, v14
    s_cbranch_vccnz Lpoll
    s_branch Lready
Lgiveup:
    s_waitcnt vmcnt(0)
    v_mov_b32 v13, 131072
    v_mov_b32 v14, 0x7fc00000
    ds_write_b32 v13, v14
    s_waitcnt lgkmcnt(0)
    s_branch Lready
Ltouch:
    s_mov_b64 exec, 0
    s_cmp_eq_u32 s16, 2
    s_cbranch_scc1 Lpad1
    s_cmp_eq_u32 s16, 3
    s_cbranch_scc1 Lpad2
    s_branch Lpad0
.p2alignl 12, 0xbf810000
.fill 269, 4, 0xbf810000
Lready:
    s_mov_b64 exec, -1
Ljoin:
    s_barrier
    s_add_u32 m0, s60, 0
    s_add_u32 s62, s8, 950272
    s_addc_u32 s63, s9, 0
    global_load_lds_dwordx4 v4, s[62:63] offset:0 sc1
    global_load_lds_dwordx4 v4, s[62:63] offset:1024 sc1
    global_load_lds_dwordx4 v4, s[62:63] offset:2048 sc1
    global_load_lds_dwordx4 v4, s[62:63] offset:3072 sc1
    s_add_u32 m0, s60, 32768
    s_add_u32 s62, s8, 983040
    s_addc_u32 s63, s9, 0
    global_load_lds_dwordx4 v4, s[62:63] offset:0 sc1
    global_load_lds_dwordx4 v4, s[62:63] offset:1024 sc1
    global_load_lds_dwordx4 v4, s[62:63] offset:2048 sc1
    global_load_lds_dwordx4 v4, s[62:63] offset:3072 sc1
    s_add_u32 m0, s60, 49152
    s_add_u32 s62, s8, 966656
    s_addc_u32 s63, s9, 0
    global_load_lds_dwordx4 v4, s[62:63] offset:0 sc1
    global_load_lds_dwordx4 v4, s[62:63] offset:1024 sc1
    global_load_lds_dwordx4 v4, s[62:63] offset:2048 sc1
    global_load_lds_dwordx4 v4, s[62:63] offset:3072 sc1
    s_add_u32 m0, s60, 16384
    s_add_u32 s62, s4, 8192
    s_addc_u32 s63, s5, 0
    global_load_lds_dwordx4 v7, s[62:63] offset:0
    s_waitcnt vmcnt(13)
    ds_read_b128 a[64:67], v8 offset:32768
    ds_read_b128 a[68:71], v9 offset:32768
    ds_read_b128 a[72:75], v10 offset:32768
    ds_read_b128 a[76:79], v11 offset:32768
    ds_read_b128 a[80:83], v8 offset:49152
    ds_read_b128 a[84:87], v9 offset:49152
    ds_read_b128 a[88:91], v10 offset:49152
    ds_read_b128 a[92:95], v11 offset:49152
    v_xor_b32 v8, 0x10000, v8
    v_xor_b32 v9, 0x10000, v9
    v_xor_b32 v10, 0x10000, v10
    v_xor_b32 v11, 0x10000, v11
    v_mov_b32 v14, v249
    v_and_b32 v15, 15, v0
    v_lshl_add_u32 v15, s16, 4, v15
    s_lshl_b32 s56, s32, 6
    s_add_u32 s6, s52, s56
    s_addc_u32 s7, s53, 0
    s_lshl_b32 s56, s32, 13
    s_add_u32 s56, s56, 4194304
    s_add_u32 s70, s54, s56
    s_addc_u32 s71, s55, 0
    s_waitcnt lgkmcnt(0)
    s_waitcnt vmcnt(9)
    s_barrier
    ds_read_b128 v[144:147], v174 offset:7424
    ds_read_b128 a[128:131], v2 offset:0
    ds_read_b128 a[132:135], v2 offset:1024
    ds_read_b128 a[136:139], v2 offset:2048
    ds_read_b128 a[140:143], v2 offset:3072
    ds_read_b128 v[148:151], v174 offset:7488
    ds_read_b128 a[144:147], v2 offset:4096
    ds_read_b128 a[148:151], v2 offset:5120
    ds_read_b128 a[152:155], v2 offset:6144
    ds_read_b128 a[156:159], v2 offset:7168
    s_waitcnt lgkmcnt(8)
    v_mfma_f32_16x16x32_bf16 v[80:83], a[128:131], a[64:67], v[144:147]
    s_waitcnt lgkmcnt(7)
    ds_read_b128 a[160:163], v2 offset:8192
    ds_read_b128 a[164:167], v2 offset:9216
    v_mfma_f32_16x16x32_bf16 v[80:83], a[132:135], a[68:71], v[80:83]
    s_waitcnt lgkmcnt(8)
    ds_read_b128 a[168:171], v2 offset:10240
    ds_read_b128 a[172:175], v2 offset:11264
    v_mfma_f32_16x16x32_bf16 v[80:83], a[136:139], a[72:75], v[80:83]
    s_waitcnt lgkmcnt(9)
    s_add_u32 m0, s60, 65536
    s_add_u32 s62, s8, 1015808
    s_addc_u32 s63, s9, 0
    v_mfma_f32_16x16x32_bf16 v[80:83], a[140:143], a[76:79], v[80:83]
    global_load_lds_dwordx4 v4, s[62:63] offset:0 sc1
    v_mfma_f32_16x16x32_bf16 v[96:99], a[140:143], a[92:95], v[144:147]
    ds_read_b128 a[176:179], v2 offset:12288
    v_mfma_f32_16x16x32_bf16 v[96:99], a[136:139], a[88:91], v[96:99]
    s_nop 0
    ds_read_b128 v[144:147], v174 offset:7552
    ds_read_b128 a[180:183], v2 offset:13312
    v_mfma_f32_16x16x32_bf16 v[96:99], a[132:135], a[84:87], v[96:99]
    ds_read_b128 a[184:187], v2 offset:14336
    v_mfma_f32_16x16x32_bf16 v[96:99], a[128:131], a[80:83], v[96:99]
    s_waitcnt lgkmcnt(11)
    global_load_lds_dwordx4 v4, s[62:63] offset:1024 sc1
    v_mfma_f32_16x16x32_bf16 v[100:103], a[144:147], a[80:83], v[148:151]
    s_waitcnt lgkmcnt(10)
    ds_read_b128 a[188:191], v2 offset:15360
    v_mfma_f32_16x16x32_bf16 v[100:103], a[148:151], a[84:87], v[100:103]
    s_waitcnt lgkmcnt(10)
    v_exp_f32 v80, v80
    v_mfma_f32_16x16x32_bf16 v[100:103], a[152:155], a[88:91], v[100:103]
    s_waitcnt lgkmcnt(9)
    v_exp_f32 v81, v81
    v_mfma_f32_16x16x32_bf16 v[100:103], a[156:159], a[92:95], v[100:103]
    global_load_lds_dwordx4 v4, s[62:63] offset:2048 sc1
    v_mfma_f32_16x16x32_bf16 v[84:87], a[156:159], a[76:79], v[148:151]
    v_exp_f32 v82, v82
    v_mfma_f32_16x16x32_bf16 v[84:87], a[152:155], a[72:75], v[84:87]
    ds_read_b128 v[148:151], v174 offset:7616
    v_cvt_pk_bf16_f32 v80, v80, v81
    v_mfma_f32_16x16x32_bf16 v[84:87], a[148:151], a[68:71], v[84:87]
    v_exp_f32 v83, v83
    v_mfma_f32_16x16x32_bf16 v[84:87], a[144:147], a[64:67], v[84:87]
    s_waitcnt lgkmcnt(4)
    global_load_lds_dwordx4 v4, s[62:63] offset:3072 sc1
    v_mfma_f32_16x16x32_bf16 v[88:91], a[160:163], a[64:67], v[144:147]
    v_exp_f32 v96, v96
    v_mfma_f32_16x16x32_bf16 v[88:91], a[164:167], a[68:71], v[88:91]
    s_add_u32 m0, s60, 16384
    v_exp_f32 v97, v97
    v_mfma_f32_16x16x32_bf16 v[88:91], a[168:171], a[72:75], v[88:91]
    s_add_u32 s62, s4, 8192
    v_exp_f32 v98, v98
    v_mfma_f32_16x16x32_bf16 v[88:91], a[172:175], a[76:79], v[88:91]
    s_addc_u32 s63, s5, 0
    v_exp_f32 v99, v99
    v_mfma_f32_16x16x32_bf16 v[104:107], a[172:175], a[92:95], v[144:147]
    s_waitcnt vmcnt(5)
    global_load_lds_dwordx4 v7, s[62:63] offset:1024
    v_mfma_f32_16x16x32_bf16 v[104:107], a[168:171], a[88:91], v[104:107]
    s_barrier
    v_mfma_f32_16x16x32_bf16 v[104:107], a[164:167], a[84:87], v[104:107]
    s_nop 0
    ds_read_b128 a[128:131], v2 offset:32768
    ds_read_b128 v[144:147], v174 offset:7680
    v_mfma_f32_16x16x32_bf16 v[104:107], a[160:163], a[80:83], v[104:107]
    s_waitcnt lgkmcnt(2)
    s_add_u32 m0, s60, 81920
    s_add_u32 s62, s8, 999424
    s_addc_u32 s63, s9, 0
    ds_read_b128 a[132:135], v2 offset:33792
    ds_read_b128 a[136:139], v2 offset:34816
    v_mfma_f32_16x16x32_bf16 v[108:111], a[176:179], a[80:83], v[148:151]
    global_load_lds_dwordx4 v4, s[62:63] offset:0 sc1
    v_mfma_f32_16x16x32_bf16 v[108:111], a[180:183], a[84:87], v[108:111]
    s_nop 0
    ds_read_b128 a[140:143], v2 offset:35840
    ds_read_b128 a[144:147], v2 offset:36864
    v_mfma_f32_16x16x32_bf16 v[108:111], a[184:187], a[88:91], v[108:111]
    s_nop 0
    ds_read_b128 a[148:151], v2 offset:37888
    ds_read_b128 a[152:155], v2 offset:38912
    v_mfma_f32_16x16x32_bf16 v[108:111], a[188:191], a[92:95], v[108:111]
    ds_read_b128 a[156:159], v2 offset:39936
    v_cvt_pk_bf16_f32 v81, v82, v83
    v_mfma_f32_16x16x32_bf16 v[92:95], a[188:191], a[76:79], v[148:151]
    global_load_lds_dwordx4 v4, s[62:63] offset:1024 sc1
    v_mfma_f32_16x16x32_bf16 v[92:95], a[184:187], a[72:75], v[92:95]
    s_nop 0
    ds_read_b128 v[148:151], v174 offset:7744
    ds_read_b128 a[160:163], v2 offset:40960
    v_mfma_f32_16x16x32_bf16 v[92:95], a[180:183], a[68:71], v[92:95]
    v_exp_f32 v100, v100
    v_mfma_f32_16x16x32_bf16 v[92:95], a[176:179], a[64:67], v[92:95]
    s_waitcnt lgkmcnt(9)
    v_exp_f32 v101, v101
    v_mfma_f32_16x16x32_bf16 v[16:19], a[128:131], a[64:67], v[144:147]
    s_waitcnt lgkmcnt(8)
    global_load_lds_dwordx4 v4, s[62:63] offset:2048 sc1
    v_mfma_f32_16x16x32_bf16 v[16:19], a[132:135], a[68:71], v[16:19]
    s_waitcnt lgkmcnt(7)
    v_exp_f32 v102, v102
    v_mfma_f32_16x16x32_bf16 v[16:19], a[136:139], a[72:75], v[16:19]
    s_waitcnt lgkmcnt(6)
    ds_read_b128 a[164:167], v2 offset:41984
    ds_read_b128 a[168:171], v2 offset:43008
    v_mfma_f32_16x16x32_bf16 v[16:19], a[140:143], a[76:79], v[16:19]
    v_exp_f32 v103, v103
    v_mfma_f32_16x16x32_bf16 v[32:35], a[140:143], a[92:95], v[144:147]
    global_load_lds_dwordx4 v4, s[62:63] offset:3072 sc1
    v_mfma_f32_16x16x32_bf16 v[32:35], a[136:139], a[88:91], v[32:35]
    s_nop 0
    ds_read_b128 v[144:147], v174 offset:7808
    ds_read_b128 a[172:175], v2 offset:44032
    v_mfma_f32_16x16x32_bf16 v[32:35], a[132:135], a[84:87], v[32:35]
    v_exp_f32 v84, v84
    v_mfma_f32_16x16x32_bf16 v[32:35], a[128:131], a[80:83], v[32:35]
    s_waitcnt lgkmcnt(5)
    s_add_u32 m0, s60, 16384
    s_add_u32 s62, s4, 8192
    s_addc_u32 s63, s5, 0
    v_exp_f32 v85, v85
    v_mfma_f32_16x16x32_bf16 v[36:39], a[144:147], a[80:83], v[148:151]
    global_load_lds_dwordx4 v7, s[62:63] offset:2048
    v_mfma_f32_16x16x32_bf16 v[36:39], a[148:151], a[84:87], v[36:39]
    v_exp_f32 v86, v86
    v_mfma_f32_16x16x32_bf16 v[36:39], a[152:155], a[88:91], v[36:39]
    v_exp_f32 v87, v87
    v_mfma_f32_16x16x32_bf16 v[36:39], a[156:159], a[92:95], v[36:39]
    v_exp_f32 v88, v88
    v_mfma_f32_16x16x32_bf16 v[20:23], a[156:159], a[76:79], v[148:151]
    global_load_lds_dwordx4 v7, s[62:63] offset:3072
    v_mfma_f32_16x16x32_bf16 v[20:23], a[152:155], a[72:75], v[20:23]
    v_exp_f32 v89, v89
    v_mfma_f32_16x16x32_bf16 v[20:23], a[148:151], a[68:71], v[20:23]
    s_nop 0
    ds_read_b128 a[176:179], v2 offset:45056
    ds_read_b128 v[148:151], v174 offset:7872
    v_mfma_f32_16x16x32_bf16 v[20:23], a[144:147], a[64:67], v[20:23]
    s_waitcnt lgkmcnt(3)
    s_add_u32 m0, s60, 98304
    s_add_u32 s62, s8, 0
    s_addc_u32 s63, s9, 0
    v_exp_f32 v90, v90
    v_mfma_f32_16x16x32_bf16 v[24:27], a[160:163], a[64:67], v[144:147]
    global_load_lds_dwordx4 v4, s[62:63] offset:0 sc1
    v_mfma_f32_16x16x32_bf16 v[24:27], a[164:167], a[68:71], v[24:27]
    s_nop 0
    ds_read_b128 a[180:183], v2 offset:46080
    ds_read_b128 a[184:187], v2 offset:47104
    v_mfma_f32_16x16x32_bf16 v[24:27], a[168:171], a[72:75], v[24:27]
    s_waitcnt lgkmcnt(4)
    v_exp_f32 v91, v91
    v_mfma_f32_16x16x32_bf16 v[24:27], a[172:175], a[76:79], v[24:27]
    ds_read_b128 a[188:191], v2 offset:48128
    v_exp_f32 v104, v104
    v_mfma_f32_16x16x32_bf16 v[40:43], a[172:175], a[92:95], v[144:147]
    global_load_lds_dwordx4 v4, s[62:63] offset:1024 sc1
    v_mfma_f32_16x16x32_bf16 v[40:43], a[168:171], a[88:91], v[40:43]
    v_exp_f32 v105, v105
    v_mfma_f32_16x16x32_bf16 v[40:43], a[164:167], a[84:87], v[40:43]
    v_exp_f32 v106, v106
    v_mfma_f32_16x16x32_bf16 v[40:43], a[160:163], a[80:83], v[40:43]
    s_waitcnt lgkmcnt(3)
    v_exp_f32 v107, v107
    v_mfma_f32_16x16x32_bf16 v[44:47], a[176:179], a[80:83], v[148:151]
    s_waitcnt lgkmcnt(2)
    global_load_lds_dwordx4 v4, s[62:63] offset:2048 sc1
    ds_read_b128 a[128:131], v2 offset:49152
    v_exp_f32 v108, v108
    v_mfma_f32_16x16x32_bf16 v[44:47], a[180:183], a[84:87], v[44:47]
    s_waitcnt lgkmcnt(2)
    ds_read_b128 a[132:135], v2 offset:50176
    v_exp_f32 v109, v109
    v_mfma_f32_16x16x32_bf16 v[44:47], a[184:187], a[88:91], v[44:47]
    s_waitcnt lgkmcnt(2)
    v_cvt_pk_bf16_f32 v96, v96, v97
    v_cvt_pk_bf16_f32 v97, v98, v99
    v_exp_f32 v110, v110
    v_mfma_f32_16x16x32_bf16 v[44:47], a[188:191], a[92:95], v[44:47]
    v_cvt_pk_bf16_f32 v98, v100, v101
    v_cvt_pk_bf16_f32 v99, v102, v103
    v_exp_f32 v111, v111
    v_mfma_f32_16x16x32_bf16 v[28:31], a[188:191], a[76:79], v[148:151]
    global_load_lds_dwordx4 v4, s[62:63] offset:3072 sc1
    ds_read_b128 a[136:139], v2 offset:51200
    v_cvt_pk_bf16_f32 v82, v84, v85
    v_cvt_pk_bf16_f32 v83, v86, v87
    v_exp_f32 v92, v92
    v_mfma_f32_16x16x32_bf16 v[28:31], a[184:187], a[72:75], v[28:31]
    ds_read_b128 a[140:143], v2 offset:52224
    v_cvt_pk_bf16_f32 v84, v88, v89
    v_cvt_pk_bf16_f32 v85, v90, v91
    v_exp_f32 v93, v93
    v_mfma_f32_16x16x32_bf16 v[28:31], a[180:183], a[68:71], v[28:31]
    v_cvt_pk_bf16_f32 v100, v104, v105
    v_cvt_pk_bf16_f32 v101, v106, v107
    v_exp_f32 v94, v94
    v_exp_f32 v95, v95
    v_mfma_f32_16x16x32_bf16 v[28:31], a[176:179], a[64:67], v[28:31]
    s_waitcnt lgkmcnt(3)
    s_add_u32 m0, s60, 114688
    s_add_u32 s62, s8, 1032192
    s_addc_u32 s63, s9, 0
    v_cvt_pk_bf16_f32 v102, v108, v109
    v_cvt_pk_bf16_f32 v103, v110, v111
    v_cvt_pk_bf16_f32 v86, v92, v93
    v_cvt_pk_bf16_f32 v87, v94, v95
    v_mfma_f32_16x16x32_bf16 v[176:179], a[128:131], v[80:83], 0
    s_waitcnt lgkmcnt(2)
    global_load_lds_dwordx4 v4, s[62:63] offset:0 sc1
    ds_read_b128 a[144:147], v2 offset:53248
    v_mfma_f32_16x16x32_bf16 v[176:179], a[132:135], v[84:87], v[176:179]
    s_nop 0
    ds_read_b128 a[148:151], v2 offset:54272
    ds_read_b128 a[152:155], v2 offset:55296
    v_mfma_f32_16x16x32_bf16 v[208:211], a[132:135], v[100:103], 0
    s_nop 0
    ds_read_b128 a[156:159], v2 offset:56320
    ds_read_b128 a[160:163], v2 offset:57344
    v_mfma_f32_16x16x32_bf16 v[208:211], a[128:131], v[96:99], v[208:211]
    s_waitcnt lgkmcnt(6)
    ds_read_b128 a[164:167], v2 offset:58368
    ds_read_b128 a[168:171], v2 offset:59392
    v_mfma_f32_16x16x32_bf16 v[212:215], a[136:139], v[96:99], 0
    s_waitcnt lgkmcnt(7)
    global_load_lds_dwordx4 v4, s[62:63] offset:1024 sc1
    v_mfma_f32_16x16x32_bf16 v[212:215], a[140:143], v[100:103], v[212:215]
    s_nop 0
    ds_read_b128 a[172:175], v2 offset:60416
    ds_read_b128 a[176:179], v2 offset:61440
    v_mfma_f32_16x16x32_bf16 v[180:183], a[140:143], v[84:87], 0
    ds_read_b128 a[180:183], v2 offset:62464
    v_mfma_f32_16x16x32_bf16 v[180:183], a[136:139], v[80:83], v[180:183]
    s_waitcnt lgkmcnt(9)
    v_exp_f32 v16, v16
    v_mfma_f32_16x16x32_bf16 v[184:187], a[144:147], v[80:83], 0
    s_waitcnt lgkmcnt(8)
    global_load_lds_dwordx4 v4, s[62:63] offset:2048 sc1
    v_mfma_f32_16x16x32_bf16 v[184:187], a[148:151], v[84:87], v[184:187]
    s_nop 0
    ds_read_b128 a[184:187], v2 offset:63488
    ds_read_b128 a[188:191], v2 offset:64512
    v_mfma_f32_16x16x32_bf16 v[216:219], a[148:151], v[100:103], 0
    v_exp_f32 v17, v17
    v_mfma_f32_16x16x32_bf16 v[216:219], a[144:147], v[96:99], v[216:219]
    s_waitcnt lgkmcnt(9)
    v_exp_f32 v18, v18
    v_mfma_f32_16x16x32_bf16 v[220:223], a[152:155], v[96:99], 0
    s_waitcnt lgkmcnt(8)
    global_load_lds_dwordx4 v4, s[62:63] offset:3072 sc1
    v_mfma_f32_16x16x32_bf16 v[220:223], a[156:159], v[100:103], v[220:223]
    ds_read_b128 v[168:171], v175 offset:14848
    v_cvt_pk_bf16_f32 v16, v16, v17
    v_mfma_f32_16x16x32_bf16 v[188:191], a[156:159], v[84:87], 0
    ds_read_b128 v[144:147], v174 offset:7936
    v_mfma_f32_16x16x32_bf16 v[188:191], a[152:155], v[80:83], v[188:191]
    s_waitcnt lgkmcnt(9)
    v_exp_f32 v19, v19
    v_mfma_f32_16x16x32_bf16 v[192:195], a[160:163], v[80:83], 0
    s_waitcnt lgkmcnt(8)
    v_exp_f32 v32, v32
    v_mfma_f32_16x16x32_bf16 v[192:195], a[164:167], v[84:87], v[192:195]
    s_waitcnt vmcnt(10)
    v_exp_f32 v33, v33
    v_mfma_f32_16x16x32_bf16 v[224:227], a[164:167], v[100:103], 0
    s_barrier
    s_add_u32 m0, s60, 32768
    s_add_u32 s62, s4, 12288
    s_addc_u32 s63, s5, 0
    v_mfma_f32_16x16x32_bf16 v[224:227], a[160:163], v[96:99], v[224:227]
    s_waitcnt lgkmcnt(7)
    global_load_lds_dwordx4 v7, s[62:63] offset:0
    v_mfma_f32_16x16x32_bf16 v[228:231], a[168:171], v[96:99], 0
    s_waitcnt lgkmcnt(6)
    ds_read_b128 a[128:131], v173 offset:0
    ds_read_b128 a[132:135], v173 offset:1024
    v_mfma_f32_16x16x32_bf16 v[228:231], a[172:175], v[100:103], v[228:231]
    s_nop 0
    ds_read_b128 a[136:139], v173 offset:2048
    ds_read_b128 a[140:143], v173 offset:3072
    v_mfma_f32_16x16x32_bf16 v[196:199], a[172:175], v[84:87], 0
    s_nop 0
    ds_read_b128 a[144:147], v173 offset:4096
    ds_read_b128 v[148:151], v174 offset:8000
    v_mfma_f32_16x16x32_bf16 v[196:199], a[168:171], v[80:83], v[196:199]
    s_waitcnt lgkmcnt(11)
    global_load_lds_dwordx4 v7, s[62:63] offset:1024
    v_mfma_f32_16x16x32_bf16 v[200:203], a[176:179], v[80:83], 0
    s_waitcnt lgkmcnt(10)
    ds_read_b128 a[148:151], v173 offset:5120
    ds_read_b128 a[152:155], v173 offset:6144
    v_mfma_f32_16x16x32_bf16 v[200:203], a[180:183], v[84:87], v[200:203]
    ds_read_b128 a[156:159], v173 offset:7168
    v_cvt_pk_bf16_f32 v17, v18, v19
    v_mfma_f32_16x16x32_bf16 v[232:235], a[180:183], v[100:103], 0
    v_exp_f32 v34, v34
    v_mfma_f32_16x16x32_bf16 v[232:235], a[176:179], v[96:99], v[232:235]
    s_waitcnt lgkmcnt(12)
    global_load_lds_dwordx4 v7, s[62:63] offset:2048
    v_mfma_f32_16x16x32_bf16 v[236:239], a[184:187], v[96:99], 0
    s_waitcnt lgkmcnt(11)
    v_exp_f32 v35, v35
    v_mfma_f32_16x16x32_bf16 v[236:239], a[188:191], v[100:103], v[236:239]
    v_exp_f32 v36, v36
    v_mfma_f32_16x16x32_bf16 v[204:207], a[188:191], v[84:87], 0
    v_exp_f32 v37, v37
    v_mfma_f32_16x16x32_bf16 v[204:207], a[184:187], v[80:83], v[204:207]
    s_waitcnt lgkmcnt(10)
    global_load_lds_dwordx4 v7, s[62:63] offset:3072
    v_smfmac_f32_16x16x64_bf16 v[152:155], v[168:171], v[80:87], v172
    ds_read_b128 a[160:163], v173 offset:8192
    v_smfmac_f32_16x16x64_bf16 v[156:159], v[168:171], v[96:103], v172
    s_waitcnt lgkmcnt(9)
    ds_read_b128 a[164:167], v173 offset:9216
    v_mfma_f32_16x16x32_bf16 v[80:83], a[128:131], a[64:67], v[144:147]
    s_waitcnt lgkmcnt(9)
    v_exp_f32 v38, v38
    v_mfma_f32_16x16x32_bf16 v[80:83], a[132:135], a[68:71], v[80:83]
    s_waitcnt lgkmcnt(8)
    v_exp_f32 v39, v39
    v_mfma_f32_16x16x32_bf16 v[80:83], a[136:139], a[72:75], v[80:83]
    s_waitcnt lgkmcnt(7)
    ds_read_b128 a[168:171], v173 offset:10240
    ds_read_b128 a[172:175], v173 offset:11264
    v_mfma_f32_16x16x32_bf16 v[80:83], a[140:143], a[76:79], v[80:83]
    v_exp_f32 v20, v20
    v_mfma_f32_16x16x32_bf16 v[96:99], a[140:143], a[92:95], v[144:147]
    v_exp_f32 v21, v21
    v_mfma_f32_16x16x32_bf16 v[96:99], a[136:139], a[88:91], v[96:99]
    s_nop 0
    ds_read_b128 v[144:147], v174 offset:8064
    ds_read_b128 a[176:179], v173 offset:12288
    v_mfma_f32_16x16x32_bf16 v[96:99], a[132:135], a[84:87], v[96:99]
    v_exp_f32 v22, v22
    v_mfma_f32_16x16x32_bf16 v[96:99], a[128:131], a[80:83], v[96:99]
    s_waitcnt lgkmcnt(9)
    v_exp_f32 v23, v23
    v_mfma_f32_16x16x32_bf16 v[100:103], a[144:147], a[80:83], v[148:151]
    s_waitcnt lgkmcnt(8)
    v_exp_f32 v24, v24
    v_mfma_f32_16x16x32_bf16 v[100:103], a[148:151], a[84:87], v[100:103]
    s_waitcnt lgkmcnt(7)
    v_exp_f32 v25, v25
    v_mfma_f32_16x16x32_bf16 v[100:103], a[152:155], a[88:91], v[100:103]
    s_waitcnt lgkmcnt(6)
    v_exp_f32 v26, v26
    v_mfma_f32_16x16x32_bf16 v[100:103], a[156:159], a[92:95], v[100:103]
    s_nop 0
    ds_read_b128 a[180:183], v173 offset:13312
    ds_read_b128 a[184:187], v173 offset:14336
    v_mfma_f32_16x16x32_bf16 v[84:87], a[156:159], a[76:79], v[148:151]
    v_exp_f32 v27, v27
    v_mfma_f32_16x16x32_bf16 v[84:87], a[152:155], a[72:75], v[84:87]
    s_nop 0
    ds_read_b128 v[148:151], v174 offset:8128
    ds_read_b128 a[188:191], v173 offset:15360
    v_mfma_f32_16x16x32_bf16 v[84:87], a[148:151], a[68:71], v[84:87]
    v_exp_f32 v40, v40
    v_mfma_f32_16x16x32_bf16 v[84:87], a[144:147], a[64:67], v[84:87]
    s_waitcnt lgkmcnt(5)
    v_exp_f32 v41, v41
    v_mfma_f32_16x16x32_bf16 v[88:91], a[160:163], a[64:67], v[144:147]
    v_exp_f32 v42, v42
    v_mfma_f32_16x16x32_bf16 v[88:91], a[164:167], a[68:71], v[88:91]
    v_exp_f32 v43, v43
    v_mfma_f32_16x16x32_bf16 v[88:91], a[168:171], a[72:75], v[88:91]
    v_exp_f32 v44, v44
    v_mfma_f32_16x16x32_bf16 v[88:91], a[172:175], a[76:79], v[88:91]
    v_exp_f32 v45, v45
    v_mfma_f32_16x16x32_bf16 v[104:107], a[172:175], a[92:95], v[144:147]
    ds_read_b128 a[128:131], v173 offset:16384
    v_cvt_pk_bf16_f32 v32, v32, v33
    v_mfma_f32_16x16x32_bf16 v[104:107], a[168:171], a[88:91], v[104:107]
    ds_read_b128 a[132:135], v173 offset:17408
    v_cvt_pk_bf16_f32 v33, v34, v35
    v_mfma_f32_16x16x32_bf16 v[104:107], a[164:167], a[84:87], v[104:107]
    v_exp_f32 v46, v46
    v_mfma_f32_16x16x32_bf16 v[104:107], a[160:163], a[80:83], v[104:107]
    s_waitcnt lgkmcnt(3)
    v_cvt_pk_bf16_f32 v34, v36, v37
    v_cvt_pk_bf16_f32 v35, v38, v39
    v_mfma_f32_16x16x32_bf16 v[108:111], a[176:179], a[80:83], v[148:151]
    v_exp_f32 v47, v47
    v_mfma_f32_16x16x32_bf16 v[108:111], a[180:183], a[84:87], v[108:111]
    v_cvt_pk_bf16_f32 v18, v20, v21
    v_cvt_pk_bf16_f32 v19, v22, v23
    v_mfma_f32_16x16x32_bf16 v[108:111], a[184:187], a[88:91], v[108:111]
    s_waitcnt lgkmcnt(2)
    v_exp_f32 v28, v28
    v_mfma_f32_16x16x32_bf16 v[108:111], a[188:191], a[92:95], v[108:111]
Lpad0:
    s_cbranch_execz Lpad3
    v_cvt_pk_bf16_f32 v20, v24, v25
    v_cvt_pk_bf16_f32 v21, v26, v27
    v_mfma_f32_16x16x32_bf16 v[92:95], a[188:191], a[76:79], v[148:151]
    ds_read_b128 a[136:139], v173 offset:18432
    v_exp_f32 v29, v29
    v_mfma_f32_16x16x32_bf16 v[92:95], a[184:187], a[72:75], v[92:95]
    ds_read_b128 a[140:143], v173 offset:19456
    v_cvt_pk_bf16_f32 v36, v40, v41
    v_cvt_pk_bf16_f32 v37, v42, v43
    v_mfma_f32_16x16x32_bf16 v[92:95], a[180:183], a[68:71], v[92:95]
    v_exp_f32 v30, v30
    v_exp_f32 v31, v31
    v_mfma_f32_16x16x32_bf16 v[92:95], a[176:179], a[64:67], v[92:95]
    s_waitcnt lgkmcnt(3)
    v_cvt_pk_bf16_f32 v38, v44, v45
    v_cvt_pk_bf16_f32 v39, v46, v47
    v_cvt_pk_bf16_f32 v22, v28, v29
    v_cvt_pk_bf16_f32 v23, v30, v31
    v_mfma_f32_16x16x32_bf16 v[176:179], a[128:131], v[16:19], v[176:179]
    s_waitcnt lgkmcnt(2)
    ds_read_b128 a[144:147], v173 offset:20480
    ds_read_b128 a[148:151], v173 offset:21504
    v_mfma_f32_16x16x32_bf16 v[176:179], a[132:135], v[20:23], v[176:179]
    s_nop 0
    ds_read_b128 a[152:155], v173 offset:22528
    ds_read_b128 a[156:159], v173 offset:23552
    v_mfma_f32_16x16x32_bf16 v[208:211], a[132:135], v[36:39], v[208:211]
    s_nop 0
    ds_read_b128 a[160:163], v173 offset:24576
    ds_read_b128 a[164:167], v173 offset:25600
    v_mfma_f32_16x16x32_bf16 v[208:211], a[128:131], v[32:35], v[208:211]
    s_waitcnt lgkmcnt(7)
    ds_read_b128 a[168:171], v173 offset:26624
    ds_read_b128 a[172:175], v173 offset:27648
    v_mfma_f32_16x16x32_bf16 v[212:215], a[136:139], v[32:35], v[212:215]
    s_waitcnt lgkmcnt(8)
    ds_read_b128 a[176:179], v173 offset:28672
    v_mfma_f32_16x16x32_bf16 v[212:215], a[140:143], v[36:39], v[212:215]
    ds_read_b128 a[180:183], v173 offset:29696
    v_mfma_f32_16x16x32_bf16 v[180:183], a[140:143], v[20:23], v[180:183]
    v_exp_f32 v80, v80
    v_mfma_f32_16x16x32_bf16 v[180:183], a[136:139], v[16:19], v[180:183]
    s_waitcnt lgkmcnt(9)
    v_exp_f32 v81, v81
    v_mfma_f32_16x16x32_bf16 v[184:187], a[144:147], v[16:19], v[184:187]
    s_waitcnt lgkmcnt(8)
    ds_read_b128 a[184:187], v173 offset:30720
    v_cvt_pk_bf16_f32 v80, v80, v81
    v_mfma_f32_16x16x32_bf16 v[184:187], a[148:151], v[20:23], v[184:187]
    ds_read_b128 a[188:191], v173 offset:31744
    v_mfma_f32_16x16x32_bf16 v[216:219], a[148:151], v[36:39], v[216:219]
    v_exp_f32 v82, v82
    v_mfma_f32_16x16x32_bf16 v[216:219], a[144:147], v[32:35], v[216:219]
    s_waitcnt lgkmcnt(9)
    v_exp_f32 v83, v83
    v_mfma_f32_16x16x32_bf16 v[220:223], a[152:155], v[32:35], v[220:223]
    s_waitcnt lgkmcnt(8)
    ds_read_b128 v[168:171], v175 offset:15360
    v_cvt_pk_bf16_f32 v81, v82, v83
    v_mfma_f32_16x16x32_bf16 v[220:223], a[156:159], v[36:39], v[220:223]
    v_exp_f32 v96, v96
    v_mfma_f32_16x16x32_bf16 v[188:191], a[156:159], v[20:23], v[188:191]
    ds_read_b128 v[240:243], v174 offset:0
    v_mfma_f32_16x16x32_bf16 v[188:191], a[152:155], v[16:19], v[188:191]
    s_waitcnt lgkmcnt(9)
    v_exp_f32 v97, v97
    v_mfma_f32_16x16x32_bf16 v[192:195], a[160:163], v[16:19], v[192:195]
    s_waitcnt lgkmcnt(8)
    v_exp_f32 v98, v98
    v_mfma_f32_16x16x32_bf16 v[192:195], a[164:167], v[20:23], v[192:195]
    s_waitcnt vmcnt(4)
    v_exp_f32 v99, v99
    v_mfma_f32_16x16x32_bf16 v[224:227], a[164:167], v[36:39], v[224:227]
    s_barrier
    v_mfma_f32_16x16x32_bf16 v[224:227], a[160:163], v[32:35], v[224:227]
    s_waitcnt lgkmcnt(7)
    ds_read_b128 a[128:131], v173 offset:32768
    ds_read_b128 a[132:135], v173 offset:33792
    v_mfma_f32_16x16x32_bf16 v[228:231], a[168:171], v[32:35], v[228:231]
    s_waitcnt lgkmcnt(8)
    ds_read_b128 a[136:139], v173 offset:34816
    ds_read_b128 a[140:143], v173 offset:35840
    v_mfma_f32_16x16x32_bf16 v[228:231], a[172:175], v[36:39], v[228:231]
    v_exp_f32 v100, v100
    v_mfma_f32_16x16x32_bf16 v[196:199], a[172:175], v[20:23], v[196:199]
    s_nop 0
    ds_read_b128 a[144:147], v173 offset:36864
    ds_read_b128 v[244:247], v174 offset:64
    v_mfma_f32_16x16x32_bf16 v[196:199], a[168:171], v[16:19], v[196:199]
    s_waitcnt lgkmcnt(11)
    ds_read_b128 a[148:151], v173 offset:37888
    v_cvt_pk_bf16_f32 v96, v96, v97
    v_mfma_f32_16x16x32_bf16 v[200:203], a[176:179], v[16:19], v[200:203]
    s_waitcnt lgkmcnt(11)
    ds_read_b128 a[152:155], v173 offset:38912
    v_cvt_pk_bf16_f32 v97, v98, v99
    v_mfma_f32_16x16x32_bf16 v[200:203], a[180:183], v[20:23], v[200:203]
    ds_read_b128 a[156:159], v173 offset:39936
    v_mfma_f32_16x16x32_bf16 v[232:235], a[180:183], v[36:39], v[232:235]
    v_exp_f32 v101, v101
    v_mfma_f32_16x16x32_bf16 v[232:235], a[176:179], v[32:35], v[232:235]
    s_waitcnt lgkmcnt(12)
    v_exp_f32 v102, v102
    v_mfma_f32_16x16x32_bf16 v[236:239], a[184:187], v[32:35], v[236:239]
    s_waitcnt lgkmcnt(11)
    v_exp_f32 v103, v103
    v_mfma_f32_16x16x32_bf16 v[236:239], a[188:191], v[36:39], v[236:239]
    v_exp_f32 v84, v84
    v_mfma_f32_16x16x32_bf16 v[204:207], a[188:191], v[20:23], v[204:207]
    s_nop 0
    ds_read_b128 a[160:163], v173 offset:40960
    ds_read_b128 v[248:251], v174 offset:128
    v_mfma_f32_16x16x32_bf16 v[204:207], a[184:187], v[16:19], v[204:207]
    s_waitcnt lgkmcnt(12)
    ds_read_b128 a[164:167], v173 offset:41984
    v_cvt_pk_bf16_f32 v98, v100, v101
    v_smfmac_f32_16x16x64_bf16 v[152:155], v[168:171], v[16:23], v172
    ds_read_b128 a[168:171], v173 offset:43008
    v_smfmac_f32_16x16x64_bf16 v[156:159], v[168:171], v[32:39], v172
    s_waitcnt lgkmcnt(12)
    ds_read_b128 a[172:175], v173 offset:44032
    v_mfma_f32_16x16x32_bf16 v[16:19], a[128:131], a[64:67], v[240:243]
    s_waitcnt lgkmcnt(12)
    v_exp_f32 v85, v85
    v_mfma_f32_16x16x32_bf16 v[16:19], a[132:135], a[68:71], v[16:19]
    s_waitcnt lgkmcnt(11)
    v_exp_f32 v86, v86
    v_mfma_f32_16x16x32_bf16 v[16:19], a[136:139], a[72:75], v[16:19]
    s_waitcnt lgkmcnt(10)
    v_exp_f32 v87, v87
    v_mfma_f32_16x16x32_bf16 v[16:19], a[140:143], a[76:79], v[16:19]
    s_add_u32 m0, s60, 0
    v_exp_f32 v88, v88
    v_mfma_f32_16x16x32_bf16 v[32:35], a[140:143], a[92:95], v[240:243]
    s_add_u32 s62, s8, 32768
    ds_read_b128 a[176:179], v173 offset:45056
    ds_read_b128 v[252:255], v174 offset:192
    v_mfma_f32_16x16x32_bf16 v[32:35], a[136:139], a[88:91], v[32:35]
    s_addc_u32 s63, s9, 0
    ds_read_b128 a[180:183], v173 offset:46080
    v_cvt_pk_bf16_f32 v99, v102, v103
    v_mfma_f32_16x16x32_bf16 v[32:35], a[132:135], a[84:87], v[32:35]
    global_load_lds_dwordx4 v4, s[62:63] offset:0 sc1
    v_mfma_f32_16x16x32_bf16 v[32:35], a[128:131], a[80:83], v[32:35]
    s_waitcnt lgkmcnt(11)
    ds_read_b128 a[184:187], v173 offset:47104
    ds_read_b128 a[188:191], v173 offset:48128
    v_mfma_f32_16x16x32_bf16 v[36:39], a[144:147], a[80:83], v[244:247]
    s_waitcnt lgkmcnt(12)
    v_exp_f32 v89, v89
    v_mfma_f32_16x16x32_bf16 v[36:39], a[148:151], a[84:87], v[36:39]
    s_waitcnt lgkmcnt(11)
    v_exp_f32 v90, v90
    v_mfma_f32_16x16x32_bf16 v[36:39], a[152:155], a[88:91], v[36:39]
    s_waitcnt lgkmcnt(10)
    global_load_lds_dwordx4 v4, s[62:63] offset:1024 sc1
    v_mfma_f32_16x16x32_bf16 v[36:39], a[156:159], a[92:95], v[36:39]
    v_exp_f32 v91, v91
    v_mfma_f32_16x16x32_bf16 v[20:23], a[156:159], a[76:79], v[244:247]
    s_nop 0
    ds_read_b128 a[96:99], v8 offset:16384
    ds_read_b128 a[100:103], v9 offset:16384
    v_mfma_f32_16x16x32_bf16 v[20:23], a[152:155], a[72:75], v[20:23]
    s_nop 0
    ds_read_b128 a[104:107], v10 offset:16384
    ds_read_b128 a[108:111], v11 offset:16384
    v_mfma_f32_16x16x32_bf16 v[20:23], a[148:151], a[68:71], v[20:23]
    global_load_lds_dwordx4 v4, s[62:63] offset:2048 sc1
    v_mfma_f32_16x16x32_bf16 v[20:23], a[144:147], a[64:67], v[20:23]
    s_waitcnt lgkmcnt(12)
    v_exp_f32 v104, v104
    v_mfma_f32_16x16x32_bf16 v[24:27], a[160:163], a[64:67], v[248:251]
    s_waitcnt lgkmcnt(11)
    v_exp_f32 v105, v105
    v_mfma_f32_16x16x32_bf16 v[24:27], a[164:167], a[68:71], v[24:27]
    s_waitcnt lgkmcnt(10)
    v_exp_f32 v106, v106
    v_mfma_f32_16x16x32_bf16 v[24:27], a[168:171], a[72:75], v[24:27]
    s_waitcnt lgkmcnt(9)
    global_load_lds_dwordx4 v4, s[62:63] offset:3072 sc1
    v_mfma_f32_16x16x32_bf16 v[24:27], a[172:175], a[76:79], v[24:27]
    v_exp_f32 v107, v107
    v_mfma_f32_16x16x32_bf16 v[40:43], a[172:175], a[92:95], v[248:251]
    v_exp_f32 v108, v108
    v_mfma_f32_16x16x32_bf16 v[40:43], a[168:171], a[88:91], v[40:43]
    s_waitcnt lgkmcnt(0)
    s_add_u32 m0, s60, 16384
    s_add_u32 s62, s8, 16384
    s_addc_u32 s63, s9, 0
    v_exp_f32 v109, v109
    v_mfma_f32_16x16x32_bf16 v[40:43], a[164:167], a[84:87], v[40:43]
    global_load_lds_dwordx4 v4, s[62:63] offset:0 sc1
    v_mfma_f32_16x16x32_bf16 v[40:43], a[160:163], a[80:83], v[40:43]
    v_exp_f32 v110, v110
    v_mfma_f32_16x16x32_bf16 v[44:47], a[176:179], a[80:83], v[252:255]
    v_exp_f32 v111, v111
    v_mfma_f32_16x16x32_bf16 v[44:47], a[180:183], a[84:87], v[44:47]
    v_cvt_pk_bf16_f32 v82, v84, v85
    v_cvt_pk_bf16_f32 v83, v86, v87
    v_mfma_f32_16x16x32_bf16 v[44:47], a[184:187], a[88:91], v[44:47]
    global_load_lds_dwordx4 v4, s[62:63] offset:1024 sc1
    v_mfma_f32_16x16x32_bf16 v[44:47], a[188:191], a[92:95], v[44:47]
    v_exp_f32 v92, v92
    v_mfma_f32_16x16x32_bf16 v[28:31], a[188:191], a[76:79], v[252:255]
    v_cvt_pk_bf16_f32 v84, v88, v89
    v_cvt_pk_bf16_f32 v85, v90, v91
    v_mfma_f32_16x16x32_bf16 v[28:31], a[184:187], a[72:75], v[28:31]
    v_exp_f32 v93, v93
    v_mfma_f32_16x16x32_bf16 v[28:31], a[180:183], a[68:71], v[28:31]
    global_load_lds_dwordx4 v4, s[62:63] offset:2048 sc1
    v_mfma_f32_16x16x32_bf16 v[28:31], a[176:179], a[64:67], v[28:31]
    v_cvt_pk_bf16_f32 v100, v104, v105
    v_cvt_pk_bf16_f32 v101, v106, v107
    v_mfma_f32_16x16x32_bf16 v[48:51], a[128:131], a[96:99], v[240:243]
    v_exp_f32 v94, v94
    v_mfma_f32_16x16x32_bf16 v[48:51], a[132:135], a[100:103], v[48:51]
    v_cvt_pk_bf16_f32 v102, v108, v109
    v_cvt_pk_bf16_f32 v103, v110, v111
    v_mfma_f32_16x16x32_bf16 v[48:51], a[136:139], a[104:107], v[48:51]
    global_load_lds_dwordx4 v4, s[62:63] offset:3072 sc1
    v_mfma_f32_16x16x32_bf16 v[48:51], a[140:143], a[108:111], v[48:51]
    s_waitcnt vmcnt(8)
    v_exp_f32 v95, v95
    v_mfma_f32_16x16x32_bf16 v[52:55], a[156:159], a[108:111], v[244:247]
    s_nop 0
    ds_read_b128 a[112:115], v8 offset:32768
    ds_read_b128 a[116:119], v9 offset:32768
    v_mfma_f32_16x16x32_bf16 v[52:55], a[152:155], a[104:107], v[52:55]
    s_nop 0
    ds_read_b128 a[120:123], v10 offset:32768
    ds_read_b128 a[124:127], v11 offset:32768
    v_mfma_f32_16x16x32_bf16 v[52:55], a[148:151], a[100:103], v[52:55]
    v_cvt_pk_bf16_f32 v86, v92, v93
    v_cvt_pk_bf16_f32 v87, v94, v95
    v_mfma_f32_16x16x32_bf16 v[52:55], a[144:147], a[96:99], v[52:55]
    v_exp_f32 v16, v16
    v_mfma_f32_16x16x32_bf16 v[56:59], a[160:163], a[96:99], v[248:251]
    v_exp_f32 v17, v17
    v_mfma_f32_16x16x32_bf16 v[56:59], a[164:167], a[100:103], v[56:59]
    s_add_u32 m0, s60, 32768
    v_exp_f32 v18, v18
    v_mfma_f32_16x16x32_bf16 v[56:59], a[168:171], a[104:107], v[56:59]
    s_add_u32 s62, s8, 65536
    v_exp_f32 v19, v19
    v_mfma_f32_16x16x32_bf16 v[56:59], a[172:175], a[108:111], v[56:59]
    s_addc_u32 s63, s9, 0
    v_exp_f32 v32, v32
    v_mfma_f32_16x16x32_bf16 v[60:63], a[188:191], a[108:111], v[252:255]
    s_waitcnt lgkmcnt(0)
    v_exp_f32 v33, v33
    v_mfma_f32_16x16x32_bf16 v[60:63], a[184:187], a[104:107], v[60:63]
    global_load_lds_dwordx4 v4, s[62:63] offset:0 sc1
    v_mfma_f32_16x16x32_bf16 v[60:63], a[180:183], a[100:103], v[60:63]
    v_exp_f32 v34, v34
    v_mfma_f32_16x16x32_bf16 v[60:63], a[176:179], a[96:99], v[60:63]
    v_exp_f32 v35, v35
    v_mfma_f32_16x16x32_bf16 v[64:67], a[128:131], a[112:115], v[240:243]
    v_exp_f32 v36, v36
    v_mfma_f32_16x16x32_bf16 v[64:67], a[132:135], a[116:119], v[64:67]
    global_load_lds_dwordx4 v4, s[62:63] offset:1024 sc1
    v_mfma_f32_16x16x32_bf16 v[64:67], a[136:139], a[120:123], v[64:67]
    s_nop 0
    ds_read_b128 a[128:131], v173 offset:49152
    ds_read_b128 a[132:135], v173 offset:50176
    v_mfma_f32_16x16x32_bf16 v[64:67], a[140:143], a[124:127], v[64:67]
    ds_read_b128 a[136:139], v173 offset:51200
    v_cvt_pk_bf16_f32 v16, v16, v17
    v_mfma_f32_16x16x32_bf16 v[68:71], a[156:159], a[124:127], v[244:247]
    ds_read_b128 a[140:143], v173 offset:52224
    v_cvt_pk_bf16_f32 v17, v18, v19
    v_mfma_f32_16x16x32_bf16 v[68:71], a[152:155], a[120:123], v[68:71]
    global_load_lds_dwordx4 v4, s[62:63] offset:2048 sc1
    v_mfma_f32_16x16x32_bf16 v[68:71], a[148:151], a[116:119], v[68:71]
    v_exp_f32 v37, v37
    v_mfma_f32_16x16x32_bf16 v[68:71], a[144:147], a[112:115], v[68:71]
    v_exp_f32 v38, v38
    v_mfma_f32_16x16x32_bf16 v[72:75], a[160:163], a[112:115], v[248:251]
    s_nop 0
    ds_read_b128 a[144:147], v173 offset:53248
    ds_read_b128 a[148:151], v173 offset:54272
    v_mfma_f32_16x16x32_bf16 v[72:75], a[164:167], a[116:119], v[72:75]
    global_load_lds_dwordx4 v4, s[62:63] offset:3072 sc1
    v_mfma_f32_16x16x32_bf16 v[72:75], a[168:171], a[120:123], v[72:75]
    s_add_u32 m0, s60, 49152
    ds_read_b128 a[152:155], v173 offset:55296
    ds_read_b128 a[156:159], v173 offset:56320
    v_mfma_f32_16x16x32_bf16 v[72:75], a[172:175], a[124:127], v[72:75]
    s_add_u32 s62, s8, 49152
    v_exp_f32 v39, v39
    v_mfma_f32_16x16x32_bf16 v[76:79], a[188:191], a[124:127], v[252:255]
    s_addc_u32 s63, s9, 0
    ds_read_b128 a[160:163], v173 offset:57344
    v_cvt_pk_bf16_f32 v32, v32, v33
    v_mfma_f32_16x16x32_bf16 v[76:79], a[184:187], a[120:123], v[76:79]
    global_load_lds_dwordx4 v4, s[62:63] offset:0 sc1
    v_mfma_f32_16x16x32_bf16 v[76:79], a[180:183], a[116:119], v[76:79]
    ds_read_b128 a[164:167], v173 offset:58368
    v_cvt_pk_bf16_f32 v33, v34, v35
    v_mfma_f32_16x16x32_bf16 v[76:79], a[176:179], a[112:115], v[76:79]
    s_waitcnt lgkmcnt(9)
    v_exp_f32 v20, v20
    v_mfma_f32_16x16x32_bf16 v[176:179], a[128:131], v[80:83], v[176:179]
    s_waitcnt lgkmcnt(8)
    ds_read_b128 a[168:171], v173 offset:59392
    v_cvt_pk_bf16_f32 v34, v36, v37
    v_mfma_f32_16x16x32_bf16 v[176:179], a[132:135], v[84:87], v[176:179]
    global_load_lds_dwordx4 v4, s[62:63] offset:1024 sc1
    v_mfma_f32_16x16x32_bf16 v[208:211], a[132:135], v[100:103], v[208:211]
    ds_read_b128 a[172:175], v173 offset:60416
    v_cvt_pk_bf16_f32 v35, v38, v39
    v_mfma_f32_16x16x32_bf16 v[208:211], a[128:131], v[96:99], v[208:211]
    s_waitcnt lgkmcnt(9)
    v_exp_f32 v21, v21
    v_mfma_f32_16x16x32_bf16 v[212:215], a[136:139], v[96:99], v[212:215]
    s_waitcnt lgkmcnt(8)
    ds_read_b128 a[176:179], v173 offset:61440
    v_cvt_pk_bf16_f32 v18, v20, v21
    v_mfma_f32_16x16x32_bf16 v[212:215], a[140:143], v[100:103], v[212:215]
    global_load_lds_dwordx4 v4, s[62:63] offset:2048 sc1
    v_mfma_f32_16x16x32_bf16 v[180:183], a[140:143], v[84:87], v[180:183]
    ds_read_b128 a[180:183], v173 offset:62464
    v_mfma_f32_16x16x32_bf16 v[180:183], a[136:139], v[80:83], v[180:183]
    s_waitcnt lgkmcnt(9)
    v_exp_f32 v22, v22
    v_mfma_f32_16x16x32_bf16 v[184:187], a[144:147], v[80:83], v[184:187]
    s_waitcnt lgkmcnt(8)
    ds_read_b128 a[184:187], v173 offset:63488
    v_mfma_f32_16x16x32_bf16 v[184:187], a[148:151], v[84:87], v[184:187]
    global_load_lds_dwordx4 v4, s[62:63] offset:3072 sc1
    v_mfma_f32_16x16x32_bf16 v[216:219], a[148:151], v[100:103], v[216:219]
    ds_read_b128 a[188:191], v173 offset:64512
    v_mfma_f32_16x16x32_bf16 v[216:219], a[144:147], v[96:99], v[216:219]
    s_waitcnt lgkmcnt(9)
    v_exp_f32 v23, v23
    v_mfma_f32_16x16x32_bf16 v[220:223], a[152:155], v[96:99], v[220:223]
    s_waitcnt lgkmcnt(8)
    s_add_u32 m0, s60, 65536
    s_add_u32 s62, s8, 98304
    s_addc_u32 s63, s9, 0
    ds_read_b128 v[168:171], v175 offset:15872
    v_cvt_pk_bf16_f32 v19, v22, v23
    v_mfma_f32_16x16x32_bf16 v[220:223], a[156:159], v[100:103], v[220:223]
    global_load_lds_dwordx4 v4, s[62:63] offset:0 sc1
    v_mfma_f32_16x16x32_bf16 v[188:191], a[156:159], v[84:87], v[188:191]
    ds_read_b128 v[144:147], v174 offset:256
    v_mfma_f32_16x16x32_bf16 v[188:191], a[152:155], v[80:83], v[188:191]
    s_waitcnt lgkmcnt(9)
    v_exp_f32 v24, v24
    v_mfma_f32_16x16x32_bf16 v[192:195], a[160:163], v[80:83], v[192:195]
    s_waitcnt lgkmcnt(8)
    v_exp_f32 v25, v25
    v_mfma_f32_16x16x32_bf16 v[192:195], a[164:167], v[84:87], v[192:195]
    s_waitcnt vmcnt(9)
    global_load_lds_dwordx4 v4, s[62:63] offset:1024 sc1
    v_mfma_f32_16x16x32_bf16 v[224:227], a[164:167], v[100:103], v[224:227]
    s_barrier
    v_mfma_f32_16x16x32_bf16 v[224:227], a[160:163], v[96:99], v[224:227]
    s_waitcnt lgkmcnt(7)
    ds_read_b128 a[128:131], v2 offset:0
    ds_read_b128 a[132:135], v2 offset:1024
    v_mfma_f32_16x16x32_bf16 v[228:231], a[168:171], v[96:99], v[228:231]
    s_waitcnt lgkmcnt(8)
    ds_read_b128 a[136:139], v2 offset:2048
    ds_read_b128 a[140:143], v2 offset:3072
    v_mfma_f32_16x16x32_bf16 v[228:231], a[172:175], v[100:103], v[228:231]
    global_load_lds_dwordx4 v4, s[62:63] offset:2048 sc1
    v_mfma_f32_16x16x32_bf16 v[196:199], a[172:175], v[84:87], v[196:199]
    v_exp_f32 v26, v26
    v_mfma_f32_16x16x32_bf16 v[196:199], a[168:171], v[80:83], v[196:199]
    s_waitcnt lgkmcnt(9)
    v_exp_f32 v27, v27
    v_mfma_f32_16x16x32_bf16 v[200:203], a[176:179], v[80:83], v[200:203]
    s_waitcnt lgkmcnt(8)
    v_exp_f32 v40, v40
    v_mfma_f32_16x16x32_bf16 v[200:203], a[180:183], v[84:87], v[200:203]
    global_load_lds_dwordx4 v4, s[62:63] offset:3072 sc1
    v_mfma_f32_16x16x32_bf16 v[232:235], a[180:183], v[100:103], v[232:235]
    v_exp_f32 v41, v41
    v_mfma_f32_16x16x32_bf16 v[232:235], a[176:179], v[96:99], v[232:235]
    s_waitcnt lgkmcnt(7)
    v_exp_f32 v42, v42
    v_mfma_f32_16x16x32_bf16 v[236:239], a[184:187], v[96:99], v[236:239]
    s_waitcnt lgkmcnt(6)
    s_add_u32 m0, s60, 81920
    s_add_u32 s62, s8, 81920
    s_addc_u32 s63, s9, 0
    v_exp_f32 v43, v43
    v_mfma_f32_16x16x32_bf16 v[236:239], a[188:191], v[100:103], v[236:239]
    global_load_lds_dwordx4 v4, s[62:63] offset:0 sc1
    v_mfma_f32_16x16x32_bf16 v[204:207], a[188:191], v[84:87], v[204:207]
    s_nop 0
    ds_read_b128 a[144:147], v2 offset:4096
    ds_read_b128 v[148:151], v174 offset:320
    v_mfma_f32_16x16x32_bf16 v[204:207], a[184:187], v[80:83], v[204:207]
    s_waitcnt lgkmcnt(7)
    ds_read_b128 a[148:151], v2 offset:5120
    v_cvt_pk_bf16_f32 v20, v24, v25
    v_smfmac_f32_16x16x64_bf16 v[152:155], v[168:171], v[80:87], v172
    ds_read_b128 a[152:155], v2 offset:6144
    v_smfmac_f32_16x16x64_bf16 v[156:159], v[168:171], v[96:103], v172
    s_waitcnt lgkmcnt(7)
    ds_read_b128 a[156:159], v2 offset:7168
    v_mfma_f32_16x16x32_bf16 v[80:83], a[128:131], a[64:67], v[144:147]
    s_waitcnt lgkmcnt(7)
    global_load_lds_dwordx4 v4, s[62:63] offset:1024 sc1
    v_mfma_f32_16x16x32_bf16 v[80:83], a[132:135], a[68:71], v[80:83]
    s_waitcnt lgkmcnt(6)
    v_exp_f32 v44, v44
    v_mfma_f32_16x16x32_bf16 v[80:83], a[136:139], a[72:75], v[80:83]
    s_waitcnt lgkmcnt(5)
    v_exp_f32 v45, v45
    v_mfma_f32_16x16x32_bf16 v[80:83], a[140:143], a[76:79], v[80:83]
    v_exp_f32 v46, v46
    v_mfma_f32_16x16x32_bf16 v[96:99], a[140:143], a[92:95], v[144:147]
    global_load_lds_dwordx4 v4, s[62:63] offset:2048 sc1
    v_mfma_f32_16x16x32_bf16 v[96:99], a[136:139], a[88:91], v[96:99]
    v_exp_f32 v47, v47
    v_mfma_f32_16x16x32_bf16 v[96:99], a[132:135], a[84:87], v[96:99]
    v_exp_f32 v28, v28
    v_mfma_f32_16x16x32_bf16 v[96:99], a[128:131], a[80:83], v[96:99]
    v_exp_f32 v29, v29
    v_mfma_f32_16x16x32_bf16 v[112:115], a[128:131], a[96:99], v[144:147]
    global_load_lds_dwordx4 v4, s[62:63] offset:3072 sc1
    v_mfma_f32_16x16x32_bf16 v[112:115], a[132:135], a[100:103], v[112:115]
    v_exp_f32 v30, v30
    v_mfma_f32_16x16x32_bf16 v[112:115], a[136:139], a[104:107], v[112:115]
    v_exp_f32 v31, v31
    v_mfma_f32_16x16x32_bf16 v[112:115], a[140:143], a[108:111], v[112:115]
    s_add_u32 m0, s60, 98304
    v_exp_f32 v48, v48
    v_mfma_f32_16x16x32_bf16 v[128:131], a[140:143], a[124:127], v[144:147]
    s_add_u32 s62, s8, 131072
    ds_read_b128 a[160:163], v2 offset:8192
    v_cvt_pk_bf16_f32 v21, v26, v27
    v_mfma_f32_16x16x32_bf16 v[128:131], a[136:139], a[120:123], v[128:131]
    s_addc_u32 s63, s9, 0
    ds_read_b128 v[144:147], v174 offset:384
    ds_read_b128 a[164:167], v2 offset:9216
    v_mfma_f32_16x16x32_bf16 v[128:131], a[132:135], a[116:119], v[128:131]
    global_load_lds_dwordx4 v4, s[62:63] offset:0 sc1
    v_mfma_f32_16x16x32_bf16 v[128:131], a[128:131], a[112:115], v[128:131]
    s_waitcnt lgkmcnt(6)
    ds_read_b128 a[168:171], v2 offset:10240
    ds_read_b128 a[172:175], v2 offset:11264
    v_mfma_f32_16x16x32_bf16 v[132:135], a[144:147], a[112:115], v[148:151]
    s_waitcnt lgkmcnt(7)
    v_exp_f32 v49, v49
    v_mfma_f32_16x16x32_bf16 v[132:135], a[148:151], a[116:119], v[132:135]
    s_waitcnt lgkmcnt(6)
    v_exp_f32 v50, v50
    v_mfma_f32_16x16x32_bf16 v[132:135], a[152:155], a[120:123], v[132:135]
    s_waitcnt lgkmcnt(5)
    global_load_lds_dwordx4 v4, s[62:63] offset:1024 sc1
    v_mfma_f32_16x16x32_bf16 v[132:135], a[156:159], a[124:127], v[132:135]
    v_exp_f32 v51, v51
    v_mfma_f32_16x16x32_bf16 v[116:119], a[156:159], a[108:111], v[148:151]
    v_exp_f32 v52, v52
    v_mfma_f32_16x16x32_bf16 v[116:119], a[152:155], a[104:107], v[116:119]
    v_exp_f32 v53, v53
    v_mfma_f32_16x16x32_bf16 v[116:119], a[148:151], a[100:103], v[116:119]
    global_load_lds_dwordx4 v4, s[62:63] offset:2048 sc1
    v_mfma_f32_16x16x32_bf16 v[116:119], a[144:147], a[96:99], v[116:119]
    v_exp_f32 v54, v54
    v_mfma_f32_16x16x32_bf16 v[100:103], a[144:147], a[80:83], v[148:151]
    v_exp_f32 v55, v55
    v_mfma_f32_16x16x32_bf16 v[100:103], a[148:151], a[84:87], v[100:103]
    v_exp_f32 v56, v56
    v_mfma_f32_16x16x32_bf16 v[100:103], a[152:155], a[88:91], v[100:103]
    global_load_lds_dwordx4 v4, s[62:63] offset:3072 sc1
    v_mfma_f32_16x16x32_bf16 v[100:103], a[156:159], a[92:95], v[100:103]
    v_exp_f32 v57, v57
    v_mfma_f32_16x16x32_bf16 v[84:87], a[156:159], a[76:79], v[148:151]
    ds_read_b128 a[176:179], v2 offset:12288
    v_cvt_pk_bf16_f32 v36, v40, v41
    v_mfma_f32_16x16x32_bf16 v[84:87], a[152:155], a[72:75], v[84:87]
    s_nop 0
    ds_read_b128 v[148:151], v174 offset:448
    ds_read_b128 a[180:183], v2 offset:13312
    v_mfma_f32_16x16x32_bf16 v[84:87], a[148:151], a[68:71], v[84:87]
    v_accvgpr_read_b32 v8, a204
    v_accvgpr_read_b32 v9, a205
    v_mfma_f32_16x16x32_bf16 v[84:87], a[144:147], a[64:67], v[84:87]
    s_waitcnt lgkmcnt(6)
    v_accvgpr_read_b32 v10, a206
    v_accvgpr_read_b32 v12, a207
    v_mfma_f32_16x16x32_bf16 v[88:91], a[160:163], a[64:67], v[144:147]
    s_waitcnt lgkmcnt(5)
    ds_read_b128 a[184:187], v2 offset:14336
    v_add_u32 v11, 0x2000, v10
    v_mfma_f32_16x16x32_bf16 v[88:91], a[164:167], a[68:71], v[88:91]
    s_waitcnt lgkmcnt(5)
    global_load_dwordx4 v[240:243], v8, s[38:39] offset:0
    v_mfma_f32_16x16x32_bf16 v[88:91], a[168:171], a[72:75], v[88:91]
    s_waitcnt lgkmcnt(4)
    ds_read_b128 a[188:191], v2 offset:15360
    v_cvt_pk_bf16_f32 v37, v42, v43
    v_mfma_f32_16x16x32_bf16 v[88:91], a[172:175], a[76:79], v[88:91]
    v_exp_f32 v58, v58
    v_mfma_f32_16x16x32_bf16 v[104:107], a[172:175], a[92:95], v[144:147]
    v_exp_f32 v59, v59
    v_mfma_f32_16x16x32_bf16 v[104:107], a[168:171], a[88:91], v[104:107]
    global_load_dwordx4 v[244:247], v8, s[38:39] offset:16
    v_mfma_f32_16x16x32_bf16 v[104:107], a[164:167], a[84:87], v[104:107]
    v_exp_f32 v60, v60
    v_mfma_f32_16x16x32_bf16 v[104:107], a[160:163], a[80:83], v[104:107]
    v_exp_f32 v61, v61
    v_mfma_f32_16x16x32_bf16 v[120:123], a[160:163], a[96:99], v[144:147]
    v_exp_f32 v62, v62
    v_mfma_f32_16x16x32_bf16 v[120:123], a[164:167], a[100:103], v[120:123]
    v_exp_f32 v63, v63
    v_mfma_f32_16x16x32_bf16 v[120:123], a[168:171], a[104:107], v[120:123]
    v_exp_f32 v64, v64
    v_mfma_f32_16x16x32_bf16 v[120:123], a[172:175], a[108:111], v[120:123]
    v_exp_f32 v65, v65
    v_mfma_f32_16x16x32_bf16 v[136:139], a[172:175], a[124:127], v[144:147]
    global_load_dwordx4 v[248:251], v9, s[42:43]
    v_mfma_f32_16x16x32_bf16 v[136:139], a[168:171], a[120:123], v[136:139]
    v_exp_f32 v66, v66
    v_mfma_f32_16x16x32_bf16 v[136:139], a[164:167], a[116:119], v[136:139]
    v_exp_f32 v67, v67
    v_mfma_f32_16x16x32_bf16 v[136:139], a[160:163], a[112:115], v[136:139]
    s_waitcnt lgkmcnt(3)
    v_exp_f32 v68, v68
    v_mfma_f32_16x16x32_bf16 v[140:143], a[176:179], a[112:115], v[148:151]
    s_waitcnt lgkmcnt(2)
    ds_read_b128 a[128:131], v2 offset:16384
    ds_read_b128 a[132:135], v2 offset:17408
    v_mfma_f32_16x16x32_bf16 v[140:143], a[180:183], a[116:119], v[140:143]
    s_waitcnt lgkmcnt(3)
    v_exp_f32 v69, v69
    v_mfma_f32_16x16x32_bf16 v[140:143], a[184:187], a[120:123], v[140:143]
    s_waitcnt lgkmcnt(2)
    v_exp_f32 v70, v70
    v_mfma_f32_16x16x32_bf16 v[140:143], a[188:191], a[124:127], v[140:143]
    v_cvt_pk_bf16_f32 v38, v44, v45
    v_cvt_pk_bf16_f32 v39, v46, v47
    v_mfma_f32_16x16x32_bf16 v[124:127], a[188:191], a[108:111], v[148:151]
    v_exp_f32 v71, v71
    v_mfma_f32_16x16x32_bf16 v[124:127], a[184:187], a[104:107], v[124:127]
    v_cvt_pk_bf16_f32 v22, v28, v29
    v_cvt_pk_bf16_f32 v23, v30, v31
    v_mfma_f32_16x16x32_bf16 v[124:127], a[180:183], a[100:103], v[124:127]
    global_load_dwordx4 v[252:255], v9, s[44:45]
    v_mfma_f32_16x16x32_bf16 v[124:127], a[176:179], a[96:99], v[124:127]
    v_exp_f32 v72, v72
    v_mfma_f32_16x16x32_bf16 v[108:111], a[176:179], a[80:83], v[148:151]
    v_cvt_pk_bf16_f32 v48, v48, v49
    v_cvt_pk_bf16_f32 v49, v50, v51
    v_mfma_f32_16x16x32_bf16 v[108:111], a[180:183], a[84:87], v[108:111]
    v_exp_f32 v73, v73
    v_mfma_f32_16x16x32_bf16 v[108:111], a[184:187], a[88:91], v[108:111]
    v_cvt_pk_bf16_f32 v50, v52, v53
    v_cvt_pk_bf16_f32 v51, v54, v55
    v_mfma_f32_16x16x32_bf16 v[108:111], a[188:191], a[92:95], v[108:111]
    v_exp_f32 v74, v74
    v_mfma_f32_16x16x32_bf16 v[92:95], a[188:191], a[76:79], v[148:151]
    v_cvt_pk_bf16_f32 v52, v56, v57
    v_cvt_pk_bf16_f32 v53, v58, v59
    v_mfma_f32_16x16x32_bf16 v[92:95], a[184:187], a[72:75], v[92:95]
    v_exp_f32 v75, v75
    v_mfma_f32_16x16x32_bf16 v[92:95], a[180:183], a[68:71], v[92:95]
    v_cvt_pk_bf16_f32 v54, v60, v61
    v_cvt_pk_bf16_f32 v55, v62, v63
    v_mfma_f32_16x16x32_bf16 v[92:95], a[176:179], a[64:67], v[92:95]
    s_waitcnt lgkmcnt(1)
    v_exp_f32 v76, v76
    v_mfma_f32_16x16x32_bf16 v[176:179], a[128:131], v[16:19], v[176:179]
    s_waitcnt lgkmcnt(0)
    ds_read_b128 a[136:139], v2 offset:18432
    v_cvt_pk_bf16_f32 v64, v64, v65
    v_mfma_f32_16x16x32_bf16 v[176:179], a[132:135], v[20:23], v[176:179]
    ds_read_b128 a[140:143], v2 offset:19456
    v_cvt_pk_bf16_f32 v65, v66, v67
    v_mfma_f32_16x16x32_bf16 v[208:211], a[132:135], v[36:39], v[208:211]
    global_load_dwordx2 a[200:201], v12, s[46:47]
    v_exp_f32 v77, v77
    v_mfma_f32_16x16x32_bf16 v[208:211], a[128:131], v[32:35], v[208:211]
    v_cvt_pk_bf16_f32 v66, v68, v69
    v_cvt_pk_bf16_f32 v67, v70, v71
    v_exp_f32 v78, v78
    v_exp_f32 v79, v79
    v_mfma_f32_16x16x32_bf16 a[0:3], a[128:131], v[48:51], 0
    v_cvt_pk_bf16_f32 v68, v72, v73
    v_cvt_pk_bf16_f32 v69, v74, v75
    v_cvt_pk_bf16_f32 v70, v76, v77
    v_cvt_pk_bf16_f32 v71, v78, v79
    v_mfma_f32_16x16x32_bf16 a[0:3], a[132:135], v[52:55], a[0:3]
    s_nop 0
    ds_read_b128 a[144:147], v2 offset:20480
    ds_read_b128 a[148:151], v2 offset:21504
    v_mfma_f32_16x16x32_bf16 a[32:35], a[132:135], v[68:71], 0
    global_load_dwordx2 a[202:203], v12, s[46:47] offset:32
    v_mfma_f32_16x16x32_bf16 a[32:35], a[128:131], v[64:67], a[32:35]
    s_waitcnt lgkmcnt(3)
    ds_read_b128 a[152:155], v2 offset:22528
    ds_read_b128 a[156:159], v2 offset:23552
    v_mfma_f32_16x16x32_bf16 a[36:39], a[136:139], v[64:67], 0
    s_waitcnt lgkmcnt(4)
    v_exp_f32 v80, v80
    v_mfma_f32_16x16x32_bf16 a[36:39], a[140:143], v[68:71], a[36:39]
    v_exp_f32 v81, v81
    v_mfma_f32_16x16x32_bf16 a[4:7], a[140:143], v[52:55], 0
    global_load_dword a192, v10, s[40:41] offset:0
    v_mfma_f32_16x16x32_bf16 a[4:7], a[136:139], v[48:51], a[4:7]
    v_exp_f32 v82, v82
    v_mfma_f32_16x16x32_bf16 v[212:215], a[136:139], v[32:35], v[212:215]
    ds_read_b128 a[160:163], v2 offset:24576
    v_cvt_pk_bf16_f32 v80, v80, v81
    v_mfma_f32_16x16x32_bf16 v[212:215], a[140:143], v[36:39], v[212:215]
Lpad1:
    s_cbranch_execz Lpad4
    ds_read_b128 a[164:167], v2 offset:25600
    v_mfma_f32_16x16x32_bf16 v[180:183], a[140:143], v[20:23], v[180:183]
    global_load_dword a193, v10, s[40:41] offset:512
    v_mfma_f32_16x16x32_bf16 v[180:183], a[136:139], v[16:19], v[180:183]
    s_waitcnt lgkmcnt(5)
    v_exp_f32 v83, v83
    v_mfma_f32_16x16x32_bf16 v[184:187], a[144:147], v[16:19], v[184:187]
    s_waitcnt lgkmcnt(4)
    v_exp_f32 v96, v96
    v_mfma_f32_16x16x32_bf16 v[184:187], a[148:151], v[20:23], v[184:187]
    v_exp_f32 v97, v97
    v_mfma_f32_16x16x32_bf16 v[216:219], a[148:151], v[36:39], v[216:219]
    global_load_dword a194, v10, s[40:41] offset:1024
    v_mfma_f32_16x16x32_bf16 v[216:219], a[144:147], v[32:35], v[216:219]
    v_exp_f32 v98, v98
    v_mfma_f32_16x16x32_bf16 a[8:11], a[144:147], v[48:51], 0
    ds_read_b128 a[168:171], v2 offset:26624
    v_cvt_pk_bf16_f32 v81, v82, v83
    v_mfma_f32_16x16x32_bf16 a[8:11], a[148:151], v[52:55], a[8:11]
    ds_read_b128 a[172:175], v2 offset:27648
    v_cvt_pk_bf16_f32 v96, v96, v97
    v_mfma_f32_16x16x32_bf16 a[40:43], a[148:151], v[68:71], 0
    global_load_dword a195, v10, s[40:41] offset:1536
    v_mfma_f32_16x16x32_bf16 a[40:43], a[144:147], v[64:67], a[40:43]
    s_waitcnt lgkmcnt(5)
    v_exp_f32 v99, v99
    v_mfma_f32_16x16x32_bf16 a[44:47], a[152:155], v[64:67], 0
    s_waitcnt lgkmcnt(4)
    v_exp_f32 v112, v112
    v_mfma_f32_16x16x32_bf16 a[44:47], a[156:159], v[68:71], a[44:47]
    v_exp_f32 v113, v113
    v_mfma_f32_16x16x32_bf16 a[12:15], a[156:159], v[52:55], 0
    global_load_dword a196, v11, s[40:41] offset:0
    v_mfma_f32_16x16x32_bf16 a[12:15], a[152:155], v[48:51], a[12:15]
    v_exp_f32 v114, v114
    v_mfma_f32_16x16x32_bf16 v[220:223], a[152:155], v[32:35], v[220:223]
    ds_read_b128 a[176:179], v2 offset:28672
    v_cvt_pk_bf16_f32 v97, v98, v99
    v_mfma_f32_16x16x32_bf16 v[220:223], a[156:159], v[36:39], v[220:223]
    ds_read_b128 a[180:183], v2 offset:29696
    v_cvt_pk_bf16_f32 v112, v112, v113
    v_mfma_f32_16x16x32_bf16 v[188:191], a[156:159], v[20:23], v[188:191]
    global_load_dword a197, v11, s[40:41] offset:512
    v_mfma_f32_16x16x32_bf16 v[188:191], a[152:155], v[16:19], v[188:191]
    s_waitcnt lgkmcnt(5)
    v_exp_f32 v115, v115
    v_mfma_f32_16x16x32_bf16 v[192:195], a[160:163], v[16:19], v[192:195]
    s_waitcnt lgkmcnt(4)
    v_exp_f32 v128, v128
    v_mfma_f32_16x16x32_bf16 v[192:195], a[164:167], v[20:23], v[192:195]
    v_exp_f32 v129, v129
    v_mfma_f32_16x16x32_bf16 v[224:227], a[164:167], v[36:39], v[224:227]
    global_load_dword a198, v11, s[40:41] offset:1024
    v_mfma_f32_16x16x32_bf16 v[224:227], a[160:163], v[32:35], v[224:227]
    v_exp_f32 v130, v130
    v_mfma_f32_16x16x32_bf16 a[16:19], a[160:163], v[48:51], 0
    ds_read_b128 a[184:187], v2 offset:30720
    v_cvt_pk_bf16_f32 v113, v114, v115
    v_mfma_f32_16x16x32_bf16 a[16:19], a[164:167], v[52:55], a[16:19]
    ds_read_b128 a[188:191], v2 offset:31744
    v_cvt_pk_bf16_f32 v128, v128, v129
    v_mfma_f32_16x16x32_bf16 a[48:51], a[164:167], v[68:71], 0
    global_load_dword a199, v11, s[40:41] offset:1536
    v_mfma_f32_16x16x32_bf16 a[48:51], a[160:163], v[64:67], a[48:51]
    s_waitcnt lgkmcnt(5)
    v_exp_f32 v131, v131
    v_mfma_f32_16x16x32_bf16 a[52:55], a[168:171], v[64:67], 0
    s_waitcnt lgkmcnt(4)
    v_exp_f32 v132, v132
    v_mfma_f32_16x16x32_bf16 a[52:55], a[172:175], v[68:71], a[52:55]
    v_exp_f32 v133, v133
    v_mfma_f32_16x16x32_bf16 a[20:23], a[172:175], v[52:55], 0
    v_exp_f32 v134, v134
    v_mfma_f32_16x16x32_bf16 a[20:23], a[168:171], v[48:51], a[20:23]
    v_exp_f32 v135, v135
    v_mfma_f32_16x16x32_bf16 v[228:231], a[168:171], v[32:35], v[228:231]
    ds_read_b128 v[168:171], v175 offset:0
    v_cvt_pk_bf16_f32 v129, v130, v131
    v_mfma_f32_16x16x32_bf16 v[228:231], a[172:175], v[36:39], v[228:231]
    v_exp_f32 v116, v116
    v_mfma_f32_16x16x32_bf16 v[196:199], a[172:175], v[20:23], v[196:199]
    v_exp_f32 v117, v117
    v_mfma_f32_16x16x32_bf16 v[196:199], a[168:171], v[16:19], v[196:199]
    s_waitcnt lgkmcnt(4)
    v_exp_f32 v118, v118
    v_mfma_f32_16x16x32_bf16 v[200:203], a[176:179], v[16:19], v[200:203]
    s_waitcnt lgkmcnt(3)
    ds_read_b128 v[144:147], v174 offset:512
    v_cvt_pk_bf16_f32 v130, v132, v133
    v_mfma_f32_16x16x32_bf16 v[200:203], a[180:183], v[20:23], v[200:203]
    v_exp_f32 v119, v119
    v_mfma_f32_16x16x32_bf16 v[232:235], a[180:183], v[36:39], v[232:235]
    s_add_u32 m0, s60, 114688
    v_exp_f32 v100, v100
    v_mfma_f32_16x16x32_bf16 v[232:235], a[176:179], v[32:35], v[232:235]
    s_waitcnt vmcnt(26)
    v_exp_f32 v101, v101
    v_mfma_f32_16x16x32_bf16 a[24:27], a[176:179], v[48:51], 0
    s_barrier
    v_mfma_f32_16x16x32_bf16 a[24:27], a[180:183], v[52:55], a[24:27]
    s_add_u32 s62, s8, 114688
    ds_read_b128 a[128:131], v2 offset:32768
    ds_read_b128 a[132:135], v2 offset:33792
    v_mfma_f32_16x16x32_bf16 a[56:59], a[180:183], v[68:71], 0
    s_addc_u32 s63, s9, 0
    ds_read_b128 a[136:139], v2 offset:34816
    ds_read_b128 a[140:143], v2 offset:35840
    v_mfma_f32_16x16x32_bf16 a[56:59], a[176:179], v[64:67], a[56:59]
    s_waitcnt lgkmcnt(7)
    global_load_lds_dwordx4 v4, s[62:63] offset:0 sc1
    v_mfma_f32_16x16x32_bf16 a[60:63], a[184:187], v[64:67], 0
    s_waitcnt lgkmcnt(6)
    v_exp_f32 v102, v102
    v_mfma_f32_16x16x32_bf16 a[60:63], a[188:191], v[68:71], a[60:63]
    v_exp_f32 v103, v103
    v_mfma_f32_16x16x32_bf16 a[28:31], a[188:191], v[52:55], 0
    v_exp_f32 v84, v84
    v_mfma_f32_16x16x32_bf16 a[28:31], a[184:187], v[48:51], a[28:31]
    global_load_lds_dwordx4 v4, s[62:63] offset:1024 sc1
    v_mfma_f32_16x16x32_bf16 v[236:239], a[184:187], v[32:35], v[236:239]
    v_exp_f32 v85, v85
    v_mfma_f32_16x16x32_bf16 v[236:239], a[188:191], v[36:39], v[236:239]
    v_exp_f32 v86, v86
    v_mfma_f32_16x16x32_bf16 v[204:207], a[188:191], v[20:23], v[204:207]
    v_exp_f32 v87, v87
    v_mfma_f32_16x16x32_bf16 v[204:207], a[184:187], v[16:19], v[204:207]
    s_waitcnt lgkmcnt(5)
    global_load_lds_dwordx4 v4, s[62:63] offset:2048 sc1
    v_smfmac_f32_16x16x64_bf16 v[152:155], v[168:171], v[16:23], v172
    ds_read_b128 a[144:147], v2 offset:36864
    v_smfmac_f32_16x16x64_bf16 v[156:159], v[168:171], v[32:39], v172
    ds_read_b128 v[148:151], v174 offset:576
    v_smfmac_f32_16x16x64_bf16 v[160:163], v[168:171], v[48:55], v172
    ds_read_b128 a[148:151], v2 offset:37888
    v_smfmac_f32_16x16x64_bf16 v[164:167], v[168:171], v[64:71], v172
    s_waitcnt lgkmcnt(6)
    ds_read_b128 a[152:155], v2 offset:38912
    v_mfma_f32_16x16x32_bf16 v[16:19], a[128:131], a[64:67], v[144:147]
    s_waitcnt lgkmcnt(6)
    ds_read_b128 a[156:159], v2 offset:39936
    v_cvt_pk_bf16_f32 v131, v134, v135
    v_mfma_f32_16x16x32_bf16 v[16:19], a[132:135], a[68:71], v[16:19]
    s_waitcnt lgkmcnt(6)
    global_load_lds_dwordx4 v4, s[62:63] offset:3072 sc1
    v_mfma_f32_16x16x32_bf16 v[16:19], a[136:139], a[72:75], v[16:19]
    s_waitcnt lgkmcnt(5)
    v_exp_f32 v88, v88
    v_mfma_f32_16x16x32_bf16 v[16:19], a[140:143], a[76:79], v[16:19]
    v_exp_f32 v89, v89
    v_mfma_f32_16x16x32_bf16 v[32:35], a[140:143], a[92:95], v[144:147]
    s_add_u32 m0, s60, 0
    s_add_u32 s62, s8, 163840
    s_addc_u32 s63, s9, 0
    v_exp_f32 v90, v90
    v_mfma_f32_16x16x32_bf16 v[32:35], a[136:139], a[88:91], v[32:35]
    global_load_lds_dwordx4 v4, s[62:63] offset:0 sc1
    v_mfma_f32_16x16x32_bf16 v[32:35], a[132:135], a[84:87], v[32:35]
    v_exp_f32 v91, v91
    v_mfma_f32_16x16x32_bf16 v[32:35], a[128:131], a[80:83], v[32:35]
    v_exp_f32 v104, v104
    v_mfma_f32_16x16x32_bf16 v[48:51], a[128:131], a[96:99], v[144:147]
    v_exp_f32 v105, v105
    v_mfma_f32_16x16x32_bf16 v[48:51], a[132:135], a[100:103], v[48:51]
    global_load_lds_dwordx4 v4, s[62:63] offset:1024 sc1
    v_mfma_f32_16x16x32_bf16 v[48:51], a[136:139], a[104:107], v[48:51]
    v_exp_f32 v106, v106
    v_mfma_f32_16x16x32_bf16 v[48:51], a[140:143], a[108:111], v[48:51]
    v_exp_f32 v107, v107
    v_mfma_f32_16x16x32_bf16 v[64:67], a[140:143], a[124:127], v[144:147]
    ds_read_b128 a[160:163], v2 offset:40960
    v_cvt_pk_bf16_f32 v114, v116, v117
    v_mfma_f32_16x16x32_bf16 v[64:67], a[136:139], a[120:123], v[64:67]
    s_nop 0
    ds_read_b128 v[144:147], v174 offset:640
    ds_read_b128 a[164:167], v2 offset:41984
    v_mfma_f32_16x16x32_bf16 v[64:67], a[132:135], a[116:119], v[64:67]
    ds_read_b128 a[168:171], v2 offset:43008
    v_cvt_pk_bf16_f32 v115, v118, v119
    v_mfma_f32_16x16x32_bf16 v[64:67], a[128:131], a[112:115], v[64:67]
    s_waitcnt lgkmcnt(7)
    ds_read_b128 a[172:175], v2 offset:44032
    v_cvt_pk_bf16_f32 v98, v100, v101
    v_mfma_f32_16x16x32_bf16 v[68:71], a[144:147], a[112:115], v[148:151]
    s_waitcnt lgkmcnt(7)
    global_load_lds_dwordx4 v4, s[62:63] offset:2048 sc1
    v_mfma_f32_16x16x32_bf16 v[68:71], a[148:151], a[116:119], v[68:71]
    s_waitcnt lgkmcnt(6)
    v_exp_f32 v120, v120
    v_mfma_f32_16x16x32_bf16 v[68:71], a[152:155], a[120:123], v[68:71]
    s_waitcnt lgkmcnt(5)
    v_exp_f32 v121, v121
    v_mfma_f32_16x16x32_bf16 v[68:71], a[156:159], a[124:127], v[68:71]
    v_exp_f32 v122, v122
    v_mfma_f32_16x16x32_bf16 v[52:55], a[156:159], a[108:111], v[148:151]
    global_load_lds_dwordx4 v4, s[62:63] offset:3072 sc1
    v_mfma_f32_16x16x32_bf16 v[52:55], a[152:155], a[104:107], v[52:55]
    v_exp_f32 v123, v123
    v_mfma_f32_16x16x32_bf16 v[52:55], a[148:151], a[100:103], v[52:55]
    v_exp_f32 v136, v136
    v_mfma_f32_16x16x32_bf16 v[52:55], a[144:147], a[96:99], v[52:55]
    v_exp_f32 v137, v137
    v_mfma_f32_16x16x32_bf16 v[36:39], a[144:147], a[80:83], v[148:151]
    v_exp_f32 v138, v138
    v_mfma_f32_16x16x32_bf16 v[36:39], a[148:151], a[84:87], v[36:39]
    v_exp_f32 v139, v139
    v_mfma_f32_16x16x32_bf16 v[36:39], a[152:155], a[88:91], v[36:39]
    v_exp_f32 v140, v140
    v_mfma_f32_16x16x32_bf16 v[36:39], a[156:159], a[92:95], v[36:39]
    v_exp_f32 v141, v141
    v_mfma_f32_16x16x32_bf16 v[20:23], a[156:159], a[76:79], v[148:151]
    ds_read_b128 a[176:179], v2 offset:45056
    v_cvt_pk_bf16_f32 v99, v102, v103
    v_mfma_f32_16x16x32_bf16 v[20:23], a[152:155], a[72:75], v[20:23]
    s_nop 0
    ds_read_b128 v[148:151], v174 offset:704
    ds_read_b128 a[180:183], v2 offset:46080
    v_mfma_f32_16x16x32_bf16 v[20:23], a[148:151], a[68:71], v[20:23]
    ds_read_b128 a[184:187], v2 offset:47104
    v_cvt_pk_bf16_f32 v82, v84, v85
    v_mfma_f32_16x16x32_bf16 v[20:23], a[144:147], a[64:67], v[20:23]
    s_waitcnt lgkmcnt(7)
    ds_read_b128 a[188:191], v2 offset:48128
    v_cvt_pk_bf16_f32 v83, v86, v87
    v_mfma_f32_16x16x32_bf16 v[24:27], a[160:163], a[64:67], v[144:147]
    s_waitcnt lgkmcnt(7)
    v_exp_f32 v142, v142
    v_mfma_f32_16x16x32_bf16 v[24:27], a[164:167], a[68:71], v[24:27]
    s_waitcnt lgkmcnt(6)
    v_exp_f32 v143, v143
    v_mfma_f32_16x16x32_bf16 v[24:27], a[168:171], a[72:75], v[24:27]
    s_waitcnt lgkmcnt(5)
    v_exp_f32 v124, v124
    v_mfma_f32_16x16x32_bf16 v[24:27], a[172:175], a[76:79], v[24:27]
    v_exp_f32 v125, v125
    v_mfma_f32_16x16x32_bf16 v[40:43], a[172:175], a[92:95], v[144:147]
    v_exp_f32 v126, v126
    v_mfma_f32_16x16x32_bf16 v[40:43], a[168:171], a[88:91], v[40:43]
    v_exp_f32 v127, v127
    v_mfma_f32_16x16x32_bf16 v[40:43], a[164:167], a[84:87], v[40:43]
    v_exp_f32 v108, v108
    v_mfma_f32_16x16x32_bf16 v[40:43], a[160:163], a[80:83], v[40:43]
    v_cvt_pk_bf16_f32 v84, v88, v89
    v_cvt_pk_bf16_f32 v85, v90, v91
    v_mfma_f32_16x16x32_bf16 v[56:59], a[160:163], a[96:99], v[144:147]
    v_exp_f32 v109, v109
    v_mfma_f32_16x16x32_bf16 v[56:59], a[164:167], a[100:103], v[56:59]
    v_cvt_pk_bf16_f32 v100, v104, v105
    v_cvt_pk_bf16_f32 v101, v106, v107
    v_mfma_f32_16x16x32_bf16 v[56:59], a[168:171], a[104:107], v[56:59]
    v_exp_f32 v110, v110
    v_mfma_f32_16x16x32_bf16 v[56:59], a[172:175], a[108:111], v[56:59]
    v_cvt_pk_bf16_f32 v116, v120, v121
    v_cvt_pk_bf16_f32 v117, v122, v123
    v_mfma_f32_16x16x32_bf16 v[72:75], a[172:175], a[124:127], v[144:147]
    ds_read_b128 a[128:131], v2 offset:49152
    v_cvt_pk_bf16_f32 v132, v136, v137
    v_mfma_f32_16x16x32_bf16 v[72:75], a[168:171], a[120:123], v[72:75]
    ds_read_b128 a[132:135], v2 offset:50176
    v_cvt_pk_bf16_f32 v133, v138, v139
    v_mfma_f32_16x16x32_bf16 v[72:75], a[164:167], a[116:119], v[72:75]
    v_exp_f32 v111, v111
    v_mfma_f32_16x16x32_bf16 v[72:75], a[160:163], a[112:115], v[72:75]
    s_waitcnt lgkmcnt(5)
    v_exp_f32 v92, v92
    v_mfma_f32_16x16x32_bf16 v[76:79], a[176:179], a[112:115], v[148:151]
    s_waitcnt lgkmcnt(4)
    v_cvt_pk_bf16_f32 v134, v140, v141
    v_cvt_pk_bf16_f32 v135, v142, v143
    v_mfma_f32_16x16x32_bf16 v[76:79], a[180:183], a[116:119], v[76:79]
    s_waitcnt lgkmcnt(3)
    v_exp_f32 v93, v93
    v_mfma_f32_16x16x32_bf16 v[76:79], a[184:187], a[120:123], v[76:79]
    s_waitcnt lgkmcnt(2)
    v_cvt_pk_bf16_f32 v118, v124, v125
    v_cvt_pk_bf16_f32 v119, v126, v127
    v_mfma_f32_16x16x32_bf16 v[76:79], a[188:191], a[124:127], v[76:79]
    v_exp_f32 v94, v94
    v_mfma_f32_16x16x32_bf16 v[60:63], a[188:191], a[108:111], v[148:151]
    v_cvt_pk_bf16_f32 v102, v108, v109
    v_cvt_pk_bf16_f32 v103, v110, v111
    v_mfma_f32_16x16x32_bf16 v[60:63], a[184:187], a[104:107], v[60:63]
    v_exp_f32 v95, v95
    v_mfma_f32_16x16x32_bf16 v[60:63], a[180:183], a[100:103], v[60:63]
    v_cvt_pk_bf16_f32 v86, v92, v93
    v_cvt_pk_bf16_f32 v87, v94, v95
    v_mfma_f32_16x16x32_bf16 v[60:63], a[176:179], a[96:99], v[60:63]
    s_waitcnt vmcnt(18)
    ds_read_b128 a[136:139], v2 offset:51200
    ds_read_b128 a[140:143], v2 offset:52224
    v_mfma_f32_16x16x32_bf16 v[44:47], a[176:179], a[80:83], v[148:151]
    v_lshlrev_b32 v8, 16, v248
    v_and_b32 v248, s29, v248
    v_mfma_f32_16x16x32_bf16 v[44:47], a[180:183], a[84:87], v[44:47]
    v_lshlrev_b32 v9, 16, v252
    v_and_b32 v252, s29, v252
    v_mfma_f32_16x16x32_bf16 v[44:47], a[184:187], a[88:91], v[44:47]
    v_cvt_f32_i32 v240, v240
    v_cvt_f32_i32 v241, v241
    v_mfma_f32_16x16x32_bf16 v[44:47], a[188:191], a[92:95], v[44:47]
    v_mul_f32 v8, s28, v8
    v_mul_f32 v248, s28, v248
    v_mfma_f32_16x16x32_bf16 v[28:31], a[188:191], a[76:79], v[148:151]
    ds_read_b128 a[144:147], v2 offset:53248
    v_sub_f32 v240, v240, v9
    v_mfma_f32_16x16x32_bf16 v[28:31], a[184:187], a[72:75], v[28:31]
    ds_read_b128 a[148:151], v2 offset:54272
    v_sub_f32 v241, v241, v252
    v_mfma_f32_16x16x32_bf16 v[28:31], a[180:183], a[68:71], v[28:31]
    v_mul_f32 v240, v240, v8
    v_mul_f32 v241, v241, v248
    v_mfma_f32_16x16x32_bf16 v[28:31], a[176:179], a[64:67], v[28:31]
    s_waitcnt lgkmcnt(5)
    v_cvt_pk_bf16_f32 v240, v240, v241
    v_lshlrev_b32 v8, 16, v249
    v_mfma_f32_16x16x32_bf16 v[176:179], a[128:131], v[80:83], v[176:179]
    s_waitcnt lgkmcnt(4)
    v_and_b32 v249, s29, v249
    v_lshlrev_b32 v9, 16, v253
    v_mfma_f32_16x16x32_bf16 v[176:179], a[132:135], v[84:87], v[176:179]
    v_and_b32 v253, s29, v253
    v_cvt_f32_i32 v242, v242
    v_mfma_f32_16x16x32_bf16 v[208:211], a[132:135], v[100:103], v[208:211]
    v_cvt_f32_i32 v243, v243
    v_mul_f32 v8, s28, v8
    v_mfma_f32_16x16x32_bf16 v[208:211], a[128:131], v[96:99], v[208:211]
    v_mul_f32 v249, s28, v249
    v_sub_f32 v242, v242, v9
    v_mfma_f32_16x16x32_bf16 a[0:3], a[128:131], v[112:115], a[0:3]
    ds_read_b128 a[152:155], v2 offset:55296
    v_sub_f32 v243, v243, v253
    v_mfma_f32_16x16x32_bf16 a[0:3], a[132:135], v[116:119], a[0:3]
    ds_read_b128 a[156:159], v2 offset:56320
    v_mul_f32 v242, v242, v8
    v_mfma_f32_16x16x32_bf16 a[32:35], a[132:135], v[132:135], a[32:35]
    v_mul_f32 v243, v243, v249
    v_cvt_pk_bf16_f32 v241, v242, v243
    v_mfma_f32_16x16x32_bf16 a[32:35], a[128:131], v[128:131], a[32:35]
    s_waitcnt lgkmcnt(5)
    v_exp_f32 v16, v16
    v_mfma_f32_16x16x32_bf16 a[36:39], a[136:139], v[128:131], a[36:39]
    s_waitcnt lgkmcnt(4)
    v_exp_f32 v17, v17
    v_mfma_f32_16x16x32_bf16 a[36:39], a[140:143], v[132:135], a[36:39]
    v_exp_f32 v18, v18
    v_mfma_f32_16x16x32_bf16 a[4:7], a[140:143], v[116:119], a[4:7]
    v_exp_f32 v19, v19
    v_mfma_f32_16x16x32_bf16 a[4:7], a[136:139], v[112:115], a[4:7]
    v_exp_f32 v32, v32
    v_mfma_f32_16x16x32_bf16 v[212:215], a[136:139], v[96:99], v[212:215]
    ds_read_b128 a[160:163], v2 offset:57344
    v_lshlrev_b32 v8, 16, v250
    v_mfma_f32_16x16x32_bf16 v[212:215], a[140:143], v[100:103], v[212:215]
    ds_read_b128 a[164:167], v2 offset:58368
    v_and_b32 v250, s29, v250
    v_mfma_f32_16x16x32_bf16 v[180:183], a[140:143], v[84:87], v[180:183]
    v_exp_f32 v33, v33
    v_mfma_f32_16x16x32_bf16 v[180:183], a[136:139], v[80:83], v[180:183]
    s_waitcnt lgkmcnt(5)
    v_exp_f32 v34, v34
    v_mfma_f32_16x16x32_bf16 v[184:187], a[144:147], v[80:83], v[184:187]
    s_waitcnt lgkmcnt(4)
    v_lshlrev_b32 v9, 16, v254
    v_and_b32 v254, s29, v254
    v_mfma_f32_16x16x32_bf16 v[184:187], a[148:151], v[84:87], v[184:187]
    v_exp_f32 v35, v35
    v_mfma_f32_16x16x32_bf16 v[216:219], a[148:151], v[100:103], v[216:219]
    v_cvt_f32_i32 v244, v244
    v_cvt_f32_i32 v245, v245
    v_mfma_f32_16x16x32_bf16 v[216:219], a[144:147], v[96:99], v[216:219]
    v_exp_f32 v48, v48
    v_mfma_f32_16x16x32_bf16 a[8:11], a[144:147], v[112:115], a[8:11]
    ds_read_b128 a[168:171], v2 offset:59392
    v_mul_f32 v8, s28, v8
    v_mfma_f32_16x16x32_bf16 a[8:11], a[148:151], v[116:119], a[8:11]
    ds_read_b128 a[172:175], v2 offset:60416
    v_mul_f32 v250, s28, v250
    v_mfma_f32_16x16x32_bf16 a[40:43], a[148:151], v[132:135], a[40:43]
    v_exp_f32 v49, v49
    v_mfma_f32_16x16x32_bf16 a[40:43], a[144:147], v[128:131], a[40:43]
    s_waitcnt lgkmcnt(5)
    v_sub_f32 v244, v244, v9
    v_sub_f32 v245, v245, v254
    v_mfma_f32_16x16x32_bf16 a[44:47], a[152:155], v[128:131], a[44:47]
    s_waitcnt lgkmcnt(4)
    v_exp_f32 v50, v50
    v_mfma_f32_16x16x32_bf16 a[44:47], a[156:159], v[132:135], a[44:47]
    v_mul_f32 v244, v244, v8
    v_mul_f32 v245, v245, v250
    v_mfma_f32_16x16x32_bf16 a[12:15], a[156:159], v[116:119], a[12:15]
    v_exp_f32 v51, v51
    v_mfma_f32_16x16x32_bf16 a[12:15], a[152:155], v[112:115], a[12:15]
    v_cvt_pk_bf16_f32 v242, v244, v245
    v_lshlrev_b32 v8, 16, v251
    v_mfma_f32_16x16x32_bf16 v[220:223], a[152:155], v[96:99], v[220:223]
    ds_read_b128 a[176:179], v2 offset:61440
    v_and_b32 v251, s29, v251
    v_mfma_f32_16x16x32_bf16 v[220:223], a[156:159], v[100:103], v[220:223]
    ds_read_b128 a[180:183], v2 offset:62464
    v_lshlrev_b32 v9, 16, v255
    v_mfma_f32_16x16x32_bf16 v[188:191], a[156:159], v[84:87], v[188:191]
    v_exp_f32 v64, v64
    v_mfma_f32_16x16x32_bf16 v[188:191], a[152:155], v[80:83], v[188:191]
    s_waitcnt lgkmcnt(5)
    v_exp_f32 v65, v65
    v_mfma_f32_16x16x32_bf16 v[192:195], a[160:163], v[80:83], v[192:195]
    s_waitcnt lgkmcnt(4)
    v_and_b32 v255, s29, v255
    v_cvt_f32_i32 v246, v246
    v_mfma_f32_16x16x32_bf16 v[192:195], a[164:167], v[84:87], v[192:195]
    v_exp_f32 v66, v66
    v_mfma_f32_16x16x32_bf16 v[224:227], a[164:167], v[100:103], v[224:227]
    v_cvt_f32_i32 v247, v247
    v_mul_f32 v8, s28, v8
    v_mfma_f32_16x16x32_bf16 v[224:227], a[160:163], v[96:99], v[224:227]
    v_exp_f32 v67, v67
    v_mfma_f32_16x16x32_bf16 a[16:19], a[160:163], v[112:115], a[16:19]
    ds_read_b128 a[184:187], v2 offset:63488
    v_mul_f32 v251, s28, v251
    v_mfma_f32_16x16x32_bf16 a[16:19], a[164:167], v[116:119], a[16:19]
    ds_read_b128 a[188:191], v2 offset:64512
    v_sub_f32 v246, v246, v9
    v_mfma_f32_16x16x32_bf16 a[48:51], a[164:167], v[132:135], a[48:51]
    v_exp_f32 v68, v68
    v_mfma_f32_16x16x32_bf16 a[48:51], a[160:163], v[128:131], a[48:51]
    s_waitcnt lgkmcnt(5)
    v_sub_f32 v247, v247, v255
    v_mul_f32 v246, v246, v8
    v_mfma_f32_16x16x32_bf16 a[52:55], a[168:171], v[128:131], a[52:55]
    s_waitcnt lgkmcnt(4)
    v_exp_f32 v69, v69
    v_mfma_f32_16x16x32_bf16 a[52:55], a[172:175], v[132:135], a[52:55]
    v_mul_f32 v247, v247, v251
    v_cvt_pk_bf16_f32 v243, v246, v247
    v_mfma_f32_16x16x32_bf16 a[20:23], a[172:175], v[116:119], a[20:23]
    v_exp_f32 v70, v70
    v_mfma_f32_16x16x32_bf16 a[20:23], a[168:171], v[112:115], a[20:23]
    global_store_dwordx4 v2, v[240:243], s[64:65] sc1
    v_mfma_f32_16x16x32_bf16 v[228:231], a[168:171], v[96:99], v[228:231]
    ds_read_b128 v[168:171], v175 offset:512
    v_cvt_pk_bf16_f32 v16, v16, v17
    v_mfma_f32_16x16x32_bf16 v[228:231], a[172:175], v[100:103], v[228:231]
    v_exp_f32 v71, v71
    v_mfma_f32_16x16x32_bf16 v[196:199], a[172:175], v[84:87], v[196:199]
    v_exp_f32 v52, v52
    v_mfma_f32_16x16x32_bf16 v[196:199], a[168:171], v[80:83], v[196:199]
    s_waitcnt lgkmcnt(4)
    v_exp_f32 v53, v53
    v_mfma_f32_16x16x32_bf16 v[200:203], a[176:179], v[80:83], v[200:203]
    s_waitcnt lgkmcnt(3)
    ds_read_b128 v[144:147], v174 offset:768
    v_cvt_pk_bf16_f32 v17, v18, v19
    v_mfma_f32_16x16x32_bf16 v[200:203], a[180:183], v[84:87], v[200:203]
    v_exp_f32 v54, v54
    v_mfma_f32_16x16x32_bf16 v[232:235], a[180:183], v[100:103], v[232:235]
    s_add_u32 m0, s60, 16384
    v_exp_f32 v55, v55
    v_mfma_f32_16x16x32_bf16 v[232:235], a[176:179], v[96:99], v[232:235]
    v_exp_f32 v36, v36
    v_mfma_f32_16x16x32_bf16 a[24:27], a[176:179], v[112:115], a[24:27]
    s_barrier
    v_mfma_f32_16x16x32_bf16 a[24:27], a[180:183], v[116:119], a[24:27]
    s_add_u32 s62, s8, 147456
    ds_read_b128 a[128:131], v173 offset:0
    ds_read_b128 a[132:135], v173 offset:1024
    v_mfma_f32_16x16x32_bf16 a[56:59], a[180:183], v[132:135], a[56:59]
    s_addc_u32 s63, s9, 0
    ds_read_b128 a[136:139], v173 offset:2048
    ds_read_b128 a[140:143], v173 offset:3072
    v_mfma_f32_16x16x32_bf16 a[56:59], a[176:179], v[128:131], a[56:59]
    s_waitcnt lgkmcnt(7)
    global_load_lds_dwordx4 v4, s[62:63] offset:0 sc1
    v_mfma_f32_16x16x32_bf16 a[60:63], a[184:187], v[128:131], a[60:63]
    s_waitcnt lgkmcnt(6)
    v_exp_f32 v37, v37
    v_mfma_f32_16x16x32_bf16 a[60:63], a[188:191], v[132:135], a[60:63]
    v_exp_f32 v38, v38
    v_mfma_f32_16x16x32_bf16 a[28:31], a[188:191], v[116:119], a[28:31]
    v_exp_f32 v39, v39
    v_mfma_f32_16x16x32_bf16 a[28:31], a[184:187], v[112:115], a[28:31]
    global_load_lds_dwordx4 v4, s[62:63] offset:1024 sc1
    v_mfma_f32_16x16x32_bf16 v[236:239], a[184:187], v[96:99], v[236:239]
    v_exp_f32 v20, v20
    v_mfma_f32_16x16x32_bf16 v[236:239], a[188:191], v[100:103], v[236:239]
    v_exp_f32 v21, v21
    v_mfma_f32_16x16x32_bf16 v[204:207], a[188:191], v[84:87], v[204:207]
    v_exp_f32 v22, v22
    v_mfma_f32_16x16x32_bf16 v[204:207], a[184:187], v[80:83], v[204:207]
    s_waitcnt lgkmcnt(5)
    global_load_lds_dwordx4 v4, s[62:63] offset:2048 sc1
    v_smfmac_f32_16x16x64_bf16 v[152:155], v[168:171], v[80:87], v172
    ds_read_b128 a[144:147], v173 offset:4096
    v_smfmac_f32_16x16x64_bf16 v[156:159], v[168:171], v[96:103], v172
    ds_read_b128 v[148:151], v174 offset:832
    v_smfmac_f32_16x16x64_bf16 v[160:163], v[168:171], v[112:119], v172
    ds_read_b128 a[148:151], v173 offset:5120
    v_smfmac_f32_16x16x64_bf16 v[164:167], v[168:171], v[128:135], v172
    s_waitcnt lgkmcnt(6)
    ds_read_b128 a[152:155], v173 offset:6144
    v_mfma_f32_16x16x32_bf16 v[80:83], a[128:131], a[64:67], v[144:147]
    s_waitcnt lgkmcnt(6)
    ds_read_b128 a[156:159], v173 offset:7168
    v_cvt_pk_bf16_f32 v32, v32, v33
    v_mfma_f32_16x16x32_bf16 v[80:83], a[132:135], a[68:71], v[80:83]
    s_waitcnt lgkmcnt(6)
    global_load_lds_dwordx4 v4, s[62:63] offset:3072 sc1
    v_mfma_f32_16x16x32_bf16 v[80:83], a[136:139], a[72:75], v[80:83]
    s_waitcnt lgkmcnt(5)
    v_exp_f32 v23, v23
    v_mfma_f32_16x16x32_bf16 v[80:83], a[140:143], a[76:79], v[80:83]
    v_exp_f32 v24, v24
    v_mfma_f32_16x16x32_bf16 v[96:99], a[140:143], a[92:95], v[144:147]
    s_add_u32 m0, s60, 32768
    s_add_u32 s62, s8, 196608
    s_addc_u32 s63, s9, 0
    v_exp_f32 v25, v25
    v_mfma_f32_16x16x32_bf16 v[96:99], a[136:139], a[88:91], v[96:99]
    global_load_lds_dwordx4 v4, s[62:63] offset:0 sc1
    v_mfma_f32_16x16x32_bf16 v[96:99], a[132:135], a[84:87], v[96:99]
    v_exp_f32 v26, v26
    v_mfma_f32_16x16x32_bf16 v[96:99], a[128:131], a[80:83], v[96:99]
    v_exp_f32 v27, v27
    v_mfma_f32_16x16x32_bf16 v[112:115], a[128:131], a[96:99], v[144:147]
    v_exp_f32 v40, v40
    v_mfma_f32_16x16x32_bf16 v[112:115], a[132:135], a[100:103], v[112:115]
    global_load_lds_dwordx4 v4, s[62:63] offset:1024 sc1
    v_mfma_f32_16x16x32_bf16 v[112:115], a[136:139], a[104:107], v[112:115]
    v_exp_f32 v41, v41
    v_mfma_f32_16x16x32_bf16 v[112:115], a[140:143], a[108:111], v[112:115]
    v_exp_f32 v42, v42
    v_mfma_f32_16x16x32_bf16 v[128:131], a[140:143], a[124:127], v[144:147]
    ds_read_b128 a[160:163], v173 offset:8192
    v_cvt_pk_bf16_f32 v33, v34, v35
    v_mfma_f32_16x16x32_bf16 v[128:131], a[136:139], a[120:123], v[128:131]
    s_nop 0
    ds_read_b128 v[144:147], v174 offset:896
    ds_read_b128 a[164:167], v173 offset:9216
    v_mfma_f32_16x16x32_bf16 v[128:131], a[132:135], a[116:119], v[128:131]
    ds_read_b128 a[168:171], v173 offset:10240
    v_cvt_pk_bf16_f32 v48, v48, v49
    v_mfma_f32_16x16x32_bf16 v[128:131], a[128:131], a[112:115], v[128:131]
    s_waitcnt lgkmcnt(7)
    ds_read_b128 a[172:175], v173 offset:11264
    v_cvt_pk_bf16_f32 v49, v50, v51
    v_mfma_f32_16x16x32_bf16 v[132:135], a[144:147], a[112:115], v[148:151]
    s_waitcnt lgkmcnt(7)
    global_load_lds_dwordx4 v4, s[62:63] offset:2048 sc1
    v_mfma_f32_16x16x32_bf16 v[132:135], a[148:151], a[116:119], v[132:135]
    s_waitcnt lgkmcnt(6)
    v_exp_f32 v43, v43
    v_mfma_f32_16x16x32_bf16 v[132:135], a[152:155], a[120:123], v[132:135]
    s_waitcnt lgkmcnt(5)
    v_exp_f32 v56, v56
    v_mfma_f32_16x16x32_bf16 v[132:135], a[156:159], a[124:127], v[132:135]
    v_exp_f32 v57, v57
    v_mfma_f32_16x16x32_bf16 v[116:119], a[156:159], a[108:111], v[148:151]
    global_load_lds_dwordx4 v4, s[62:63] offset:3072 sc1
    v_mfma_f32_16x16x32_bf16 v[116:119], a[152:155], a[104:107], v[116:119]
    v_exp_f32 v58, v58
    v_mfma_f32_16x16x32_bf16 v[116:119], a[148:151], a[100:103], v[116:119]
    v_exp_f32 v59, v59
    v_mfma_f32_16x16x32_bf16 v[116:119], a[144:147], a[96:99], v[116:119]
    v_exp_f32 v72, v72
    v_mfma_f32_16x16x32_bf16 v[100:103], a[144:147], a[80:83], v[148:151]
    v_exp_f32 v73, v73
    v_mfma_f32_16x16x32_bf16 v[100:103], a[148:151], a[84:87], v[100:103]
    v_exp_f32 v74, v74
    v_mfma_f32_16x16x32_bf16 v[100:103], a[152:155], a[88:91], v[100:103]
    v_exp_f32 v75, v75
    v_mfma_f32_16x16x32_bf16 v[100:103], a[156:159], a[92:95], v[100:103]
    v_exp_f32 v76, v76
    v_mfma_f32_16x16x32_bf16 v[84:87], a[156:159], a[76:79], v[148:151]
    ds_read_b128 a[176:179], v173 offset:12288
    v_cvt_pk_bf16_f32 v64, v64, v65
    v_mfma_f32_16x16x32_bf16 v[84:87], a[152:155], a[72:75], v[84:87]
    s_nop 0
    ds_read_b128 v[148:151], v174 offset:960
    ds_read_b128 a[180:183], v173 offset:13312
    v_mfma_f32_16x16x32_bf16 v[84:87], a[148:151], a[68:71], v[84:87]
    ds_read_b128 a[184:187], v173 offset:14336
    v_cvt_pk_bf16_f32 v65, v66, v67
    v_mfma_f32_16x16x32_bf16 v[84:87], a[144:147], a[64:67], v[84:87]
    s_waitcnt lgkmcnt(7)
    ds_read_b128 a[188:191], v173 offset:15360
    v_cvt_pk_bf16_f32 v66, v68, v69
    v_mfma_f32_16x16x32_bf16 v[88:91], a[160:163], a[64:67], v[144:147]
    s_waitcnt lgkmcnt(7)
    v_exp_f32 v77, v77
    v_mfma_f32_16x16x32_bf16 v[88:91], a[164:167], a[68:71], v[88:91]
    s_waitcnt lgkmcnt(6)
    v_exp_f32 v78, v78
    v_mfma_f32_16x16x32_bf16 v[88:91], a[168:171], a[72:75], v[88:91]
    s_waitcnt lgkmcnt(5)
    v_exp_f32 v79, v79
    v_mfma_f32_16x16x32_bf16 v[88:91], a[172:175], a[76:79], v[88:91]
    v_exp_f32 v60, v60
    v_mfma_f32_16x16x32_bf16 v[104:107], a[172:175], a[92:95], v[144:147]
    v_cvt_pk_bf16_f32 v67, v70, v71
    v_cvt_pk_bf16_f32 v50, v52, v53
    v_mfma_f32_16x16x32_bf16 v[104:107], a[168:171], a[88:91], v[104:107]
    v_exp_f32 v61, v61
    v_mfma_f32_16x16x32_bf16 v[104:107], a[164:167], a[84:87], v[104:107]
    v_cvt_pk_bf16_f32 v51, v54, v55
    v_cvt_pk_bf16_f32 v34, v36, v37
    v_mfma_f32_16x16x32_bf16 v[104:107], a[160:163], a[80:83], v[104:107]
    v_exp_f32 v62, v62
    v_mfma_f32_16x16x32_bf16 v[120:123], a[160:163], a[96:99], v[144:147]
    v_cvt_pk_bf16_f32 v35, v38, v39
    v_cvt_pk_bf16_f32 v18, v20, v21
    v_mfma_f32_16x16x32_bf16 v[120:123], a[164:167], a[100:103], v[120:123]
    v_exp_f32 v63, v63
    v_mfma_f32_16x16x32_bf16 v[120:123], a[168:171], a[104:107], v[120:123]
    v_cvt_pk_bf16_f32 v19, v22, v23
    v_cvt_pk_bf16_f32 v20, v24, v25
    v_mfma_f32_16x16x32_bf16 v[120:123], a[172:175], a[108:111], v[120:123]
    v_exp_f32 v44, v44
    v_mfma_f32_16x16x32_bf16 v[136:139], a[172:175], a[124:127], v[144:147]
    ds_read_b128 a[128:131], v173 offset:16384
    v_cvt_pk_bf16_f32 v21, v26, v27
    v_mfma_f32_16x16x32_bf16 v[136:139], a[168:171], a[120:123], v[136:139]
    v_exp_f32 v45, v45
    v_mfma_f32_16x16x32_bf16 v[136:139], a[164:167], a[116:119], v[136:139]
    v_cvt_pk_bf16_f32 v36, v40, v41
    v_cvt_pk_bf16_f32 v37, v42, v43
    v_mfma_f32_16x16x32_bf16 v[136:139], a[160:163], a[112:115], v[136:139]
    s_waitcnt lgkmcnt(4)
    v_exp_f32 v46, v46
    v_mfma_f32_16x16x32_bf16 v[140:143], a[176:179], a[112:115], v[148:151]
    s_waitcnt lgkmcnt(3)
    ds_read_b128 a[132:135], v173 offset:17408
    v_cvt_pk_bf16_f32 v52, v56, v57
    v_mfma_f32_16x16x32_bf16 v[140:143], a[180:183], a[116:119], v[140:143]
    s_waitcnt lgkmcnt(3)
    v_cvt_pk_bf16_f32 v53, v58, v59
    v_cvt_pk_bf16_f32 v68, v72, v73
    v_mfma_f32_16x16x32_bf16 v[140:143], a[184:187], a[120:123], v[140:143]
    s_waitcnt lgkmcnt(2)
    v_exp_f32 v47, v47
    v_mfma_f32_16x16x32_bf16 v[140:143], a[188:191], a[124:127], v[140:143]
Lpad2:
    s_cbranch_execz Lpad5
    v_cvt_pk_bf16_f32 v69, v74, v75
    v_cvt_pk_bf16_f32 v70, v76, v77
    v_mfma_f32_16x16x32_bf16 v[124:127], a[188:191], a[108:111], v[148:151]
    v_exp_f32 v28, v28
    v_mfma_f32_16x16x32_bf16 v[124:127], a[184:187], a[104:107], v[124:127]
    v_cvt_pk_bf16_f32 v71, v78, v79
    v_cvt_pk_bf16_f32 v54, v60, v61
    v_mfma_f32_16x16x32_bf16 v[124:127], a[180:183], a[100:103], v[124:127]
    v_exp_f32 v29, v29
    v_mfma_f32_16x16x32_bf16 v[124:127], a[176:179], a[96:99], v[124:127]
    v_cvt_pk_bf16_f32 v55, v62, v63
    v_cvt_pk_bf16_f32 v38, v44, v45
    v_mfma_f32_16x16x32_bf16 v[108:111], a[176:179], a[80:83], v[148:151]
    v_exp_f32 v30, v30
    v_mfma_f32_16x16x32_bf16 v[108:111], a[180:183], a[84:87], v[108:111]
    v_cvt_pk_bf16_f32 v39, v46, v47
    v_cvt_pk_bf16_f32 v22, v28, v29
    v_mfma_f32_16x16x32_bf16 v[108:111], a[184:187], a[88:91], v[108:111]
    v_exp_f32 v31, v31
    v_mfma_f32_16x16x32_bf16 v[108:111], a[188:191], a[92:95], v[108:111]
    ds_read_b128 a[136:139], v173 offset:18432
    v_cvt_pk_bf16_f32 v23, v30, v31
    v_mfma_f32_16x16x32_bf16 v[92:95], a[188:191], a[76:79], v[148:151]
    s_waitcnt vmcnt(17)
    ds_read_b128 a[140:143], v173 offset:19456
    ds_read_b128 a[144:147], v173 offset:20480
    v_mfma_f32_16x16x32_bf16 v[92:95], a[184:187], a[72:75], v[92:95]
    ds_read_b128 a[148:151], v173 offset:21504
    v_accvgpr_read_b32 v9, a200
    v_mfma_f32_16x16x32_bf16 v[92:95], a[180:183], a[68:71], v[92:95]
    v_accvgpr_read_b32 v244, a192
    v_accvgpr_read_b32 v245, a193
    v_mfma_f32_16x16x32_bf16 v[92:95], a[176:179], a[64:67], v[92:95]
    s_waitcnt lgkmcnt(5)
    v_lshlrev_b32 v8, 16, v9
    v_and_b32 v9, s30, v9
    v_mfma_f32_16x16x32_bf16 v[176:179], a[128:131], v[16:19], v[176:179]
    s_waitcnt lgkmcnt(4)
    v_cvt_f32_i32 v244, v244
    v_cvt_f32_i32 v245, v245
    v_mfma_f32_16x16x32_bf16 v[176:179], a[132:135], v[20:23], v[176:179]
    v_and_b32 v8, s30, v8
    v_add_f32 v244, s22, v244
    v_mfma_f32_16x16x32_bf16 v[208:211], a[132:135], v[36:39], v[208:211]
    v_add_f32 v245, s22, v245
    v_mul_f32 v244, v244, v8
    v_mfma_f32_16x16x32_bf16 v[208:211], a[128:131], v[32:35], v[208:211]
    v_mul_f32 v245, v245, v9
    v_cvt_pk_bf16_f32 v244, v244, v245
    v_mfma_f32_16x16x32_bf16 a[0:3], a[128:131], v[48:51], a[0:3]
    ds_read_b128 a[152:155], v173 offset:22528
    v_accvgpr_read_b32 v9, a201
    v_mfma_f32_16x16x32_bf16 a[0:3], a[132:135], v[52:55], a[0:3]
    ds_read_b128 a[156:159], v173 offset:23552
    v_accvgpr_read_b32 v246, a194
    v_mfma_f32_16x16x32_bf16 a[32:35], a[132:135], v[68:71], a[32:35]
    v_accvgpr_read_b32 v247, a195
    v_lshlrev_b32 v8, 16, v9
    v_mfma_f32_16x16x32_bf16 a[32:35], a[128:131], v[64:67], a[32:35]
    s_waitcnt lgkmcnt(5)
    v_and_b32 v9, s30, v9
    v_cvt_f32_i32 v246, v246
    v_mfma_f32_16x16x32_bf16 a[36:39], a[136:139], v[64:67], a[36:39]
    s_waitcnt lgkmcnt(4)
    v_cvt_f32_i32 v247, v247
    v_and_b32 v8, s30, v8
    v_mfma_f32_16x16x32_bf16 a[36:39], a[140:143], v[68:71], a[36:39]
    v_add_f32 v246, s22, v246
    v_add_f32 v247, s22, v247
    v_mfma_f32_16x16x32_bf16 a[4:7], a[140:143], v[52:55], a[4:7]
    v_mul_f32 v246, v246, v8
    v_mul_f32 v247, v247, v9
    v_mfma_f32_16x16x32_bf16 a[4:7], a[136:139], v[48:51], a[4:7]
    v_cvt_pk_bf16_f32 v245, v246, v247
    v_accvgpr_read_b32 v9, a202
    v_mfma_f32_16x16x32_bf16 v[212:215], a[136:139], v[32:35], v[212:215]
    ds_read_b128 a[160:163], v173 offset:24576
    v_accvgpr_read_b32 v248, a196
    v_mfma_f32_16x16x32_bf16 v[212:215], a[140:143], v[36:39], v[212:215]
    ds_read_b128 a[164:167], v173 offset:25600
    v_accvgpr_read_b32 v249, a197
    v_mfma_f32_16x16x32_bf16 v[180:183], a[140:143], v[20:23], v[180:183]
    v_lshlrev_b32 v8, 16, v9
    v_and_b32 v9, s30, v9
    v_mfma_f32_16x16x32_bf16 v[180:183], a[136:139], v[16:19], v[180:183]
    s_waitcnt lgkmcnt(5)
    v_cvt_f32_i32 v248, v248
    v_cvt_f32_i32 v249, v249
    v_mfma_f32_16x16x32_bf16 v[184:187], a[144:147], v[16:19], v[184:187]
    s_waitcnt lgkmcnt(4)
    v_and_b32 v8, s30, v8
    v_add_f32 v248, s22, v248
    v_mfma_f32_16x16x32_bf16 v[184:187], a[148:151], v[20:23], v[184:187]
    v_add_f32 v249, s22, v249
    v_mul_f32 v248, v248, v8
    v_mfma_f32_16x16x32_bf16 v[216:219], a[148:151], v[36:39], v[216:219]
    v_mul_f32 v249, v249, v9
    v_cvt_pk_bf16_f32 v246, v248, v249
    v_mfma_f32_16x16x32_bf16 v[216:219], a[144:147], v[32:35], v[216:219]
    v_accvgpr_read_b32 v9, a203
    v_accvgpr_read_b32 v250, a198
    v_mfma_f32_16x16x32_bf16 a[8:11], a[144:147], v[48:51], a[8:11]
    ds_read_b128 a[168:171], v173 offset:26624
    v_accvgpr_read_b32 v251, a199
    v_mfma_f32_16x16x32_bf16 a[8:11], a[148:151], v[52:55], a[8:11]
    ds_read_b128 a[172:175], v173 offset:27648
    v_lshlrev_b32 v8, 16, v9
    v_mfma_f32_16x16x32_bf16 a[40:43], a[148:151], v[68:71], a[40:43]
    v_and_b32 v9, s30, v9
    v_cvt_f32_i32 v250, v250
    v_mfma_f32_16x16x32_bf16 a[40:43], a[144:147], v[64:67], a[40:43]
    s_waitcnt lgkmcnt(5)
    v_cvt_f32_i32 v251, v251
    v_and_b32 v8, s30, v8
    v_mfma_f32_16x16x32_bf16 a[44:47], a[152:155], v[64:67], a[44:47]
    s_waitcnt lgkmcnt(4)
    v_add_f32 v250, s22, v250
    v_add_f32 v251, s22, v251
    v_mfma_f32_16x16x32_bf16 a[44:47], a[156:159], v[68:71], a[44:47]
    v_exp_f32 v80, v80
    v_mfma_f32_16x16x32_bf16 a[12:15], a[156:159], v[52:55], a[12:15]
    v_exp_f32 v81, v81
    v_mfma_f32_16x16x32_bf16 a[12:15], a[152:155], v[48:51], a[12:15]
    v_exp_f32 v82, v82
    v_mfma_f32_16x16x32_bf16 v[220:223], a[152:155], v[32:35], v[220:223]
    ds_read_b128 a[176:179], v173 offset:28672
    v_mul_f32 v250, v250, v8
    v_mfma_f32_16x16x32_bf16 v[220:223], a[156:159], v[36:39], v[220:223]
    ds_read_b128 a[180:183], v173 offset:29696
    v_mul_f32 v251, v251, v9
    v_mfma_f32_16x16x32_bf16 v[188:191], a[156:159], v[20:23], v[188:191]
    v_exp_f32 v83, v83
    v_mfma_f32_16x16x32_bf16 v[188:191], a[152:155], v[16:19], v[188:191]
    s_waitcnt lgkmcnt(5)
    v_exp_f32 v96, v96
    v_mfma_f32_16x16x32_bf16 v[192:195], a[160:163], v[16:19], v[192:195]
    s_waitcnt lgkmcnt(4)
    v_exp_f32 v97, v97
    v_mfma_f32_16x16x32_bf16 v[192:195], a[164:167], v[20:23], v[192:195]
    v_exp_f32 v98, v98
    v_mfma_f32_16x16x32_bf16 v[224:227], a[164:167], v[36:39], v[224:227]
    v_cvt_pk_bf16_f32 v247, v250, v251
    v_cvt_pk_bf16_f32 v80, v80, v81
    v_mfma_f32_16x16x32_bf16 v[224:227], a[160:163], v[32:35], v[224:227]
    global_store_dwordx4 v2, v[244:247], s[66:67] sc1
    v_mfma_f32_16x16x32_bf16 a[16:19], a[160:163], v[48:51], a[16:19]
    ds_read_b128 a[184:187], v173 offset:30720
    v_cvt_pk_bf16_f32 v81, v82, v83
    v_mfma_f32_16x16x32_bf16 a[16:19], a[164:167], v[52:55], a[16:19]
    ds_read_b128 a[188:191], v173 offset:31744
    v_cvt_pk_bf16_f32 v96, v96, v97
    v_mfma_f32_16x16x32_bf16 a[48:51], a[164:167], v[68:71], a[48:51]
    v_exp_f32 v99, v99
    v_mfma_f32_16x16x32_bf16 a[48:51], a[160:163], v[64:67], a[48:51]
    s_waitcnt lgkmcnt(5)
    v_exp_f32 v112, v112
    v_mfma_f32_16x16x32_bf16 a[52:55], a[168:171], v[64:67], a[52:55]
    s_waitcnt lgkmcnt(4)
    v_exp_f32 v113, v113
    v_mfma_f32_16x16x32_bf16 a[52:55], a[172:175], v[68:71], a[52:55]
    v_exp_f32 v114, v114
    v_mfma_f32_16x16x32_bf16 a[20:23], a[172:175], v[52:55], a[20:23]
    v_exp_f32 v115, v115
    v_mfma_f32_16x16x32_bf16 a[20:23], a[168:171], v[48:51], a[20:23]
    v_exp_f32 v128, v128
    v_mfma_f32_16x16x32_bf16 v[228:231], a[168:171], v[32:35], v[228:231]
    ds_read_b128 v[168:171], v175 offset:1024
    v_cvt_pk_bf16_f32 v97, v98, v99
    v_mfma_f32_16x16x32_bf16 v[228:231], a[172:175], v[36:39], v[228:231]
    v_exp_f32 v129, v129
    v_mfma_f32_16x16x32_bf16 v[196:199], a[172:175], v[20:23], v[196:199]
    v_exp_f32 v130, v130
    v_mfma_f32_16x16x32_bf16 v[196:199], a[168:171], v[16:19], v[196:199]
    s_waitcnt lgkmcnt(4)
    v_exp_f32 v131, v131
    v_mfma_f32_16x16x32_bf16 v[200:203], a[176:179], v[16:19], v[200:203]
    s_waitcnt lgkmcnt(3)
    ds_read_b128 v[144:147], v174 offset:1024
    v_cvt_pk_bf16_f32 v112, v112, v113
    v_mfma_f32_16x16x32_bf16 v[200:203], a[180:183], v[20:23], v[200:203]
    v_exp_f32 v132, v132
    v_mfma_f32_16x16x32_bf16 v[232:235], a[180:183], v[36:39], v[232:235]
    s_add_u32 m0, s60, 49152
    v_exp_f32 v133, v133
    v_mfma_f32_16x16x32_bf16 v[232:235], a[176:179], v[32:35], v[232:235]
    s_waitcnt vmcnt(14)
    v_exp_f32 v134, v134
    v_mfma_f32_16x16x32_bf16 a[24:27], a[176:179], v[48:51], a[24:27]
    s_barrier
    v_mfma_f32_16x16x32_bf16 a[24:27], a[180:183], v[52:55], a[24:27]
    s_add_u32 s62, s8, 180224
    ds_read_b128 a[128:131], v173 offset:32768
    ds_read_b128 a[132:135], v173 offset:33792
    v_mfma_f32_16x16x32_bf16 a[56:59], a[180:183], v[68:71], a[56:59]
    s_addc_u32 s63, s9, 0
    ds_read_b128 a[136:139], v173 offset:34816
    ds_read_b128 a[140:143], v173 offset:35840
    v_mfma_f32_16x16x32_bf16 a[56:59], a[176:179], v[64:67], a[56:59]
    s_waitcnt lgkmcnt(7)
    global_load_lds_dwordx4 v4, s[62:63] offset:0 sc1
    v_mfma_f32_16x16x32_bf16 a[60:63], a[184:187], v[64:67], a[60:63]
    s_waitcnt lgkmcnt(6)
    v_exp_f32 v135, v135
    v_mfma_f32_16x16x32_bf16 a[60:63], a[188:191], v[68:71], a[60:63]
    v_exp_f32 v116, v116
    v_mfma_f32_16x16x32_bf16 a[28:31], a[188:191], v[52:55], a[28:31]
    v_exp_f32 v117, v117
    v_mfma_f32_16x16x32_bf16 a[28:31], a[184:187], v[48:51], a[28:31]
    global_load_lds_dwordx4 v4, s[62:63] offset:1024 sc1
    v_mfma_f32_16x16x32_bf16 v[236:239], a[184:187], v[32:35], v[236:239]
    v_exp_f32 v118, v118
    v_mfma_f32_16x16x32_bf16 v[236:239], a[188:191], v[36:39], v[236:239]
    v_exp_f32 v119, v119
    v_mfma_f32_16x16x32_bf16 v[204:207], a[188:191], v[20:23], v[204:207]
    v_exp_f32 v100, v100
    v_mfma_f32_16x16x32_bf16 v[204:207], a[184:187], v[16:19], v[204:207]
    s_waitcnt lgkmcnt(5)
    global_load_lds_dwordx4 v4, s[62:63] offset:2048 sc1
    v_smfmac_f32_16x16x64_bf16 v[152:155], v[168:171], v[16:23], v172
    ds_read_b128 a[144:147], v173 offset:36864
    v_smfmac_f32_16x16x64_bf16 v[156:159], v[168:171], v[32:39], v172
    ds_read_b128 v[148:151], v174 offset:1088
    v_smfmac_f32_16x16x64_bf16 v[160:163], v[168:171], v[48:55], v172
    ds_read_b128 a[148:151], v173 offset:37888
    v_smfmac_f32_16x16x64_bf16 v[164:167], v[168:171], v[64:71], v172
    s_waitcnt lgkmcnt(6)
    ds_read_b128 a[152:155], v173 offset:38912
    v_mfma_f32_16x16x32_bf16 v[16:19], a[128:131], a[64:67], v[144:147]
    s_waitcnt lgkmcnt(6)
    ds_read_b128 a[156:159], v173 offset:39936
    v_cvt_pk_bf16_f32 v113, v114, v115
    v_mfma_f32_16x16x32_bf16 v[16:19], a[132:135], a[68:71], v[16:19]
    s_waitcnt lgkmcnt(6)
    global_load_lds_dwordx4 v4, s[62:63] offset:3072 sc1
    v_mfma_f32_16x16x32_bf16 v[16:19], a[136:139], a[72:75], v[16:19]
    s_waitcnt lgkmcnt(5)
    v_exp_f32 v101, v101
    v_mfma_f32_16x16x32_bf16 v[16:19], a[140:143], a[76:79], v[16:19]
    v_exp_f32 v102, v102
    v_mfma_f32_16x16x32_bf16 v[32:35], a[140:143], a[92:95], v[144:147]
    s_add_u32 m0, s60, 65536
    s_add_u32 s62, s8, 229376
    s_addc_u32 s63, s9, 0
    v_exp_f32 v103, v103
    v_mfma_f32_16x16x32_bf16 v[32:35], a[136:139], a[88:91], v[32:35]
    global_load_lds_dwordx4 v4, s[62:63] offset:0 sc1
    v_mfma_f32_16x16x32_bf16 v[32:35], a[132:135], a[84:87], v[32:35]
    v_exp_f32 v84, v84
    v_mfma_f32_16x16x32_bf16 v[32:35], a[128:131], a[80:83], v[32:35]
    v_exp_f32 v85, v85
    v_mfma_f32_16x16x32_bf16 v[48:51], a[128:131], a[96:99], v[144:147]
    v_exp_f32 v86, v86
    v_mfma_f32_16x16x32_bf16 v[48:51], a[132:135], a[100:103], v[48:51]
    global_load_lds_dwordx4 v4, s[62:63] offset:1024 sc1
    v_mfma_f32_16x16x32_bf16 v[48:51], a[136:139], a[104:107], v[48:51]
    v_exp_f32 v87, v87
    v_mfma_f32_16x16x32_bf16 v[48:51], a[140:143], a[108:111], v[48:51]
    v_exp_f32 v88, v88
    v_mfma_f32_16x16x32_bf16 v[64:67], a[140:143], a[124:127], v[144:147]
    ds_read_b128 a[160:163], v173 offset:40960
    v_cvt_pk_bf16_f32 v128, v128, v129
    v_mfma_f32_16x16x32_bf16 v[64:67], a[136:139], a[120:123], v[64:67]
    s_nop 0
    ds_read_b128 v[144:147], v174 offset:1152
    ds_read_b128 a[164:167], v173 offset:41984
    v_mfma_f32_16x16x32_bf16 v[64:67], a[132:135], a[116:119], v[64:67]
    ds_read_b128 a[168:171], v173 offset:43008
    v_cvt_pk_bf16_f32 v129, v130, v131
    v_mfma_f32_16x16x32_bf16 v[64:67], a[128:131], a[112:115], v[64:67]
    s_waitcnt lgkmcnt(7)
    ds_read_b128 a[172:175], v173 offset:44032
    v_cvt_pk_bf16_f32 v130, v132, v133
    v_mfma_f32_16x16x32_bf16 v[68:71], a[144:147], a[112:115], v[148:151]
    s_waitcnt lgkmcnt(7)
    v_exp_f32 v89, v89
    v_mfma_f32_16x16x32_bf16 v[68:71], a[148:151], a[116:119], v[68:71]
    s_waitcnt lgkmcnt(6)
    v_exp_f32 v90, v90
    v_mfma_f32_16x16x32_bf16 v[68:71], a[152:155], a[120:123], v[68:71]
    s_waitcnt lgkmcnt(5)
    global_load_lds_dwordx4 v4, s[62:63] offset:2048 sc1
    v_mfma_f32_16x16x32_bf16 v[68:71], a[156:159], a[124:127], v[68:71]
    v_exp_f32 v91, v91
    v_mfma_f32_16x16x32_bf16 v[52:55], a[156:159], a[108:111], v[148:151]
    v_exp_f32 v104, v104
    v_mfma_f32_16x16x32_bf16 v[52:55], a[152:155], a[104:107], v[52:55]
    v_exp_f32 v105, v105
    v_mfma_f32_16x16x32_bf16 v[52:55], a[148:151], a[100:103], v[52:55]
    v_exp_f32 v106, v106
    v_mfma_f32_16x16x32_bf16 v[52:55], a[144:147], a[96:99], v[52:55]
    global_load_lds_dwordx4 v4, s[62:63] offset:3072 sc1
    v_mfma_f32_16x16x32_bf16 v[36:39], a[144:147], a[80:83], v[148:151]
    v_exp_f32 v107, v107
    v_mfma_f32_16x16x32_bf16 v[36:39], a[148:151], a[84:87], v[36:39]
    v_exp_f32 v120, v120
    v_mfma_f32_16x16x32_bf16 v[36:39], a[152:155], a[88:91], v[36:39]
    v_exp_f32 v121, v121
    v_mfma_f32_16x16x32_bf16 v[36:39], a[156:159], a[92:95], v[36:39]
    v_exp_f32 v122, v122
    v_mfma_f32_16x16x32_bf16 v[20:23], a[156:159], a[76:79], v[148:151]
    ds_read_b128 a[176:179], v173 offset:45056
    v_cvt_pk_bf16_f32 v131, v134, v135
    v_mfma_f32_16x16x32_bf16 v[20:23], a[152:155], a[72:75], v[20:23]
    s_nop 0
    ds_read_b128 v[148:151], v174 offset:1216
    ds_read_b128 a[180:183], v173 offset:46080
    v_mfma_f32_16x16x32_bf16 v[20:23], a[148:151], a[68:71], v[20:23]
    v_exp_f32 v123, v123
    v_mfma_f32_16x16x32_bf16 v[20:23], a[144:147], a[64:67], v[20:23]
    s_waitcnt lgkmcnt(6)
    ds_read_b128 a[184:187], v173 offset:47104
    ds_read_b128 a[188:191], v173 offset:48128
    v_mfma_f32_16x16x32_bf16 v[24:27], a[160:163], a[64:67], v[144:147]
    s_waitcnt lgkmcnt(7)
    v_exp_f32 v136, v136
    v_mfma_f32_16x16x32_bf16 v[24:27], a[164:167], a[68:71], v[24:27]
    s_waitcnt lgkmcnt(6)
    v_exp_f32 v137, v137
    v_mfma_f32_16x16x32_bf16 v[24:27], a[168:171], a[72:75], v[24:27]
    s_waitcnt lgkmcnt(5)
    v_exp_f32 v138, v138
    v_mfma_f32_16x16x32_bf16 v[24:27], a[172:175], a[76:79], v[24:27]
    v_exp_f32 v139, v139
    v_mfma_f32_16x16x32_bf16 v[40:43], a[172:175], a[92:95], v[144:147]
    v_exp_f32 v140, v140
    v_mfma_f32_16x16x32_bf16 v[40:43], a[168:171], a[88:91], v[40:43]
    v_exp_f32 v141, v141
    v_mfma_f32_16x16x32_bf16 v[40:43], a[164:167], a[84:87], v[40:43]
    v_exp_f32 v142, v142
    v_mfma_f32_16x16x32_bf16 v[40:43], a[160:163], a[80:83], v[40:43]
    v_exp_f32 v143, v143
    v_mfma_f32_16x16x32_bf16 v[56:59], a[160:163], a[96:99], v[144:147]
    v_exp_f32 v124, v124
    v_mfma_f32_16x16x32_bf16 v[56:59], a[164:167], a[100:103], v[56:59]
    v_exp_f32 v125, v125
    v_mfma_f32_16x16x32_bf16 v[56:59], a[168:171], a[104:107], v[56:59]
    v_cvt_pk_bf16_f32 v114, v116, v117
    v_cvt_pk_bf16_f32 v115, v118, v119
    v_mfma_f32_16x16x32_bf16 v[56:59], a[172:175], a[108:111], v[56:59]
    v_exp_f32 v126, v126
    v_mfma_f32_16x16x32_bf16 v[72:75], a[172:175], a[124:127], v[144:147]
    v_cvt_pk_bf16_f32 v98, v100, v101
    v_cvt_pk_bf16_f32 v99, v102, v103
    v_mfma_f32_16x16x32_bf16 v[72:75], a[168:171], a[120:123], v[72:75]
    v_exp_f32 v127, v127
    v_mfma_f32_16x16x32_bf16 v[72:75], a[164:167], a[116:119], v[72:75]
    v_cvt_pk_bf16_f32 v82, v84, v85
    v_cvt_pk_bf16_f32 v83, v86, v87
    v_mfma_f32_16x16x32_bf16 v[72:75], a[160:163], a[112:115], v[72:75]
    s_waitcnt lgkmcnt(3)
    v_exp_f32 v108, v108
    v_mfma_f32_16x16x32_bf16 v[76:79], a[176:179], a[112:115], v[148:151]
    s_waitcnt lgkmcnt(2)
    v_cvt_pk_bf16_f32 v84, v88, v89
    v_cvt_pk_bf16_f32 v85, v90, v91
    v_mfma_f32_16x16x32_bf16 v[76:79], a[180:183], a[116:119], v[76:79]
    s_waitcnt lgkmcnt(1)
    v_exp_f32 v109, v109
    v_mfma_f32_16x16x32_bf16 v[76:79], a[184:187], a[120:123], v[76:79]
    s_waitcnt lgkmcnt(0)
    ds_read_b128 a[128:131], v173 offset:49152
    v_cvt_pk_bf16_f32 v100, v104, v105
    v_mfma_f32_16x16x32_bf16 v[76:79], a[188:191], a[124:127], v[76:79]
    ds_read_b128 a[132:135], v173 offset:50176
    v_cvt_pk_bf16_f32 v101, v106, v107
    v_mfma_f32_16x16x32_bf16 v[60:63], a[188:191], a[108:111], v[148:151]
    v_exp_f32 v110, v110
    v_mfma_f32_16x16x32_bf16 v[60:63], a[184:187], a[104:107], v[60:63]
    v_cvt_pk_bf16_f32 v116, v120, v121
    v_cvt_pk_bf16_f32 v117, v122, v123
    v_mfma_f32_16x16x32_bf16 v[60:63], a[180:183], a[100:103], v[60:63]
    v_exp_f32 v111, v111
    v_mfma_f32_16x16x32_bf16 v[60:63], a[176:179], a[96:99], v[60:63]
    v_cvt_pk_bf16_f32 v132, v136, v137
    v_cvt_pk_bf16_f32 v133, v138, v139
    v_mfma_f32_16x16x32_bf16 v[44:47], a[176:179], a[80:83], v[148:151]
    v_exp_f32 v92, v92
    v_mfma_f32_16x16x32_bf16 v[44:47], a[180:183], a[84:87], v[44:47]
    v_cvt_pk_bf16_f32 v134, v140, v141
    v_cvt_pk_bf16_f32 v135, v142, v143
    v_mfma_f32_16x16x32_bf16 v[44:47], a[184:187], a[88:91], v[44:47]
    v_exp_f32 v93, v93
    v_mfma_f32_16x16x32_bf16 v[44:47], a[188:191], a[92:95], v[44:47]
    v_cvt_pk_bf16_f32 v118, v124, v125
    v_cvt_pk_bf16_f32 v119, v126, v127
    v_mfma_f32_16x16x32_bf16 v[28:31], a[188:191], a[76:79], v[148:151]
    v_exp_f32 v94, v94
    v_mfma_f32_16x16x32_bf16 v[28:31], a[184:187], a[72:75], v[28:31]
    v_cvt_pk_bf16_f32 v102, v108, v109
    v_cvt_pk_bf16_f32 v103, v110, v111
    v_mfma_f32_16x16x32_bf16 v[28:31], a[180:183], a[68:71], v[28:31]
    v_exp_f32 v95, v95
    v_mfma_f32_16x16x32_bf16 v[28:31], a[176:179], a[64:67], v[28:31]
    s_waitcnt lgkmcnt(1)
    v_cvt_pk_bf16_f32 v86, v92, v93
    v_cvt_pk_bf16_f32 v87, v94, v95
    v_mfma_f32_16x16x32_bf16 v[176:179], a[128:131], v[80:83], v[176:179]
    s_waitcnt lgkmcnt(0)
    ds_read_b128 a[136:139], v173 offset:51200
    ds_read_b128 a[140:143], v173 offset:52224
    v_mfma_f32_16x16x32_bf16 v[176:179], a[132:135], v[84:87], v[176:179]
    s_nop 0
    ds_read_b128 a[144:147], v173 offset:53248
    ds_read_b128 a[148:151], v173 offset:54272
    v_mfma_f32_16x16x32_bf16 v[208:211], a[132:135], v[100:103], v[208:211]
    v_lshlrev_b32 v8, 7, v15
    v_lshlrev_b32 v12, 5, v0
    v_mfma_f32_16x16x32_bf16 v[208:211], a[128:131], v[96:99], v[208:211]
    v_exp_f32 v16, v16
    v_mfma_f32_16x16x32_bf16 a[0:3], a[128:131], v[112:115], a[0:3]
    ds_read_b128 a[152:155], v173 offset:55296
    v_mfma_f32_16x16x32_bf16 a[0:3], a[132:135], v[116:119], a[0:3]
    ds_read_b128 a[156:159], v173 offset:56320
    v_mfma_f32_16x16x32_bf16 a[32:35], a[132:135], v[132:135], a[32:35]
    v_exp_f32 v17, v17
    v_mfma_f32_16x16x32_bf16 a[32:35], a[128:131], v[128:131], a[32:35]
    s_waitcnt lgkmcnt(5)
    v_exp_f32 v18, v18
    v_mfma_f32_16x16x32_bf16 a[36:39], a[136:139], v[128:131], a[36:39]
    s_waitcnt lgkmcnt(4)
    v_exp_f32 v19, v19
    v_mfma_f32_16x16x32_bf16 a[36:39], a[140:143], v[132:135], a[36:39]
    v_exp_f32 v32, v32
    v_mfma_f32_16x16x32_bf16 a[4:7], a[140:143], v[116:119], a[4:7]
    v_exp_f32 v33, v33
    v_mfma_f32_16x16x32_bf16 a[4:7], a[136:139], v[112:115], a[4:7]
    v_exp_f32 v34, v34
    v_mfma_f32_16x16x32_bf16 v[212:215], a[136:139], v[96:99], v[212:215]
    ds_read_b128 a[160:163], v173 offset:57344
    v_cvt_pk_bf16_f32 v16, v16, v17
    v_mfma_f32_16x16x32_bf16 v[212:215], a[140:143], v[100:103], v[212:215]
    ds_read_b128 a[164:167], v173 offset:58368
    v_cvt_pk_bf16_f32 v17, v18, v19
    v_mfma_f32_16x16x32_bf16 v[180:183], a[140:143], v[84:87], v[180:183]
    v_exp_f32 v35, v35
    v_mfma_f32_16x16x32_bf16 v[180:183], a[136:139], v[80:83], v[180:183]
    s_waitcnt lgkmcnt(5)
    v_exp_f32 v48, v48
    v_mfma_f32_16x16x32_bf16 v[184:187], a[144:147], v[80:83], v[184:187]
    s_waitcnt lgkmcnt(4)
    v_exp_f32 v49, v49
    v_mfma_f32_16x16x32_bf16 v[184:187], a[148:151], v[84:87], v[184:187]
    v_exp_f32 v50, v50
    v_mfma_f32_16x16x32_bf16 v[216:219], a[148:151], v[100:103], v[216:219]
    v_exp_f32 v51, v51
    v_mfma_f32_16x16x32_bf16 v[216:219], a[144:147], v[96:99], v[216:219]
    v_exp_f32 v64, v64
    v_mfma_f32_16x16x32_bf16 a[8:11], a[144:147], v[112:115], a[8:11]
    ds_read_b128 a[168:171], v173 offset:59392
    v_cvt_pk_bf16_f32 v32, v32, v33
    v_mfma_f32_16x16x32_bf16 a[8:11], a[148:151], v[116:119], a[8:11]
    ds_read_b128 a[172:175], v173 offset:60416
    v_cvt_pk_bf16_f32 v33, v34, v35
    v_mfma_f32_16x16x32_bf16 a[40:43], a[148:151], v[132:135], a[40:43]
    v_exp_f32 v65, v65
    v_mfma_f32_16x16x32_bf16 a[40:43], a[144:147], v[128:131], a[40:43]
    s_waitcnt lgkmcnt(5)
    v_exp_f32 v66, v66
    v_mfma_f32_16x16x32_bf16 a[44:47], a[152:155], v[128:131], a[44:47]
    s_waitcnt lgkmcnt(4)
    v_exp_f32 v67, v67
    v_mfma_f32_16x16x32_bf16 a[44:47], a[156:159], v[132:135], a[44:47]
    v_exp_f32 v68, v68
    v_mfma_f32_16x16x32_bf16 a[12:15], a[156:159], v[116:119], a[12:15]
    v_exp_f32 v69, v69
    v_mfma_f32_16x16x32_bf16 a[12:15], a[152:155], v[112:115], a[12:15]
    v_exp_f32 v70, v70
    v_mfma_f32_16x16x32_bf16 v[220:223], a[152:155], v[96:99], v[220:223]
    ds_read_b128 a[176:179], v173 offset:61440
    v_cvt_pk_bf16_f32 v48, v48, v49
    v_mfma_f32_16x16x32_bf16 v[220:223], a[156:159], v[100:103], v[220:223]
    ds_read_b128 a[180:183], v173 offset:62464
    v_cvt_pk_bf16_f32 v49, v50, v51
    v_mfma_f32_16x16x32_bf16 v[188:191], a[156:159], v[84:87], v[188:191]
    v_exp_f32 v71, v71
    v_mfma_f32_16x16x32_bf16 v[188:191], a[152:155], v[80:83], v[188:191]
    s_waitcnt lgkmcnt(5)
    v_exp_f32 v52, v52
    v_mfma_f32_16x16x32_bf16 v[192:195], a[160:163], v[80:83], v[192:195]
    s_waitcnt lgkmcnt(4)
    v_exp_f32 v53, v53
    v_mfma_f32_16x16x32_bf16 v[192:195], a[164:167], v[84:87], v[192:195]
    v_exp_f32 v54, v54
    v_mfma_f32_16x16x32_bf16 v[224:227], a[164:167], v[100:103], v[224:227]
    v_exp_f32 v55, v55
    v_mfma_f32_16x16x32_bf16 v[224:227], a[160:163], v[96:99], v[224:227]
    v_exp_f32 v36, v36
    v_mfma_f32_16x16x32_bf16 a[16:19], a[160:163], v[112:115], a[16:19]
    ds_read_b128 a[184:187], v173 offset:63488
    v_cvt_pk_bf16_f32 v64, v64, v65
    v_mfma_f32_16x16x32_bf16 a[16:19], a[164:167], v[116:119], a[16:19]
    ds_read_b128 a[188:191], v173 offset:64512
    v_cvt_pk_bf16_f32 v65, v66, v67
    v_mfma_f32_16x16x32_bf16 a[48:51], a[164:167], v[132:135], a[48:51]
    v_exp_f32 v37, v37
    v_mfma_f32_16x16x32_bf16 a[48:51], a[160:163], v[128:131], a[48:51]
    s_waitcnt lgkmcnt(5)
    v_exp_f32 v38, v38
    v_mfma_f32_16x16x32_bf16 a[52:55], a[168:171], v[128:131], a[52:55]
    s_waitcnt lgkmcnt(4)
    v_exp_f32 v39, v39
    v_mfma_f32_16x16x32_bf16 a[52:55], a[172:175], v[132:135], a[52:55]
    v_exp_f32 v20, v20
    v_mfma_f32_16x16x32_bf16 a[20:23], a[172:175], v[116:119], a[20:23]
    v_exp_f32 v21, v21
    v_mfma_f32_16x16x32_bf16 a[20:23], a[168:171], v[112:115], a[20:23]
    v_exp_f32 v22, v22
    v_mfma_f32_16x16x32_bf16 v[228:231], a[168:171], v[96:99], v[228:231]
    ds_read_b128 v[168:171], v175 offset:1536
    v_cvt_pk_bf16_f32 v66, v68, v69
    v_mfma_f32_16x16x32_bf16 v[228:231], a[172:175], v[100:103], v[228:231]
    v_exp_f32 v23, v23
    v_mfma_f32_16x16x32_bf16 v[196:199], a[172:175], v[84:87], v[196:199]
    v_exp_f32 v24, v24
    v_mfma_f32_16x16x32_bf16 v[196:199], a[168:171], v[80:83], v[196:199]
    s_waitcnt lgkmcnt(4)
    v_exp_f32 v25, v25
    v_mfma_f32_16x16x32_bf16 v[200:203], a[176:179], v[80:83], v[200:203]
    s_waitcnt lgkmcnt(3)
    ds_read_b128 v[144:147], v174 offset:1280
    v_cvt_pk_bf16_f32 v67, v70, v71
    v_mfma_f32_16x16x32_bf16 v[200:203], a[180:183], v[84:87], v[200:203]
    v_exp_f32 v26, v26
    v_mfma_f32_16x16x32_bf16 v[232:235], a[180:183], v[100:103], v[232:235]
    s_add_u32 m0, s60, 81920
    v_exp_f32 v27, v27
    v_mfma_f32_16x16x32_bf16 v[232:235], a[176:179], v[96:99], v[232:235]
    s_waitcnt vmcnt(8)
    v_exp_f32 v40, v40
    v_mfma_f32_16x16x32_bf16 a[24:27], a[176:179], v[112:115], a[24:27]
    s_barrier
    v_mfma_f32_16x16x32_bf16 a[24:27], a[180:183], v[116:119], a[24:27]
    s_add_u32 s62, s8, 212992
    global_store_dword v14, a208, s[54:55] sc1
    v_mfma_f32_16x16x32_bf16 a[56:59], a[180:183], v[132:135], a[56:59]
    s_addc_u32 s63, s9, 0
    ds_read_b128 a[128:131], v2 offset:0
    ds_read_b128 a[132:135], v2 offset:1024
    v_mfma_f32_16x16x32_bf16 a[56:59], a[176:179], v[128:131], a[56:59]
    s_waitcnt lgkmcnt(5)
    ds_read_b128 a[136:139], v2 offset:2048
    ds_read_b128 a[140:143], v2 offset:3072
    v_mfma_f32_16x16x32_bf16 a[60:63], a[184:187], v[128:131], a[60:63]
    s_waitcnt lgkmcnt(6)
    v_exp_f32 v41, v41
    v_mfma_f32_16x16x32_bf16 a[60:63], a[188:191], v[132:135], a[60:63]
    global_load_lds_dwordx4 v4, s[62:63] offset:0 sc1
    v_mfma_f32_16x16x32_bf16 a[28:31], a[188:191], v[116:119], a[28:31]
    v_exp_f32 v42, v42
    v_mfma_f32_16x16x32_bf16 a[28:31], a[184:187], v[112:115], a[28:31]
    v_exp_f32 v43, v43
    v_mfma_f32_16x16x32_bf16 v[236:239], a[184:187], v[96:99], v[236:239]
    v_exp_f32 v56, v56
    v_mfma_f32_16x16x32_bf16 v[236:239], a[188:191], v[100:103], v[236:239]
    global_load_lds_dwordx4 v4, s[62:63] offset:1024 sc1
    v_mfma_f32_16x16x32_bf16 v[204:207], a[188:191], v[84:87], v[204:207]
    v_exp_f32 v57, v57
    v_mfma_f32_16x16x32_bf16 v[204:207], a[184:187], v[80:83], v[204:207]
    s_waitcnt lgkmcnt(5)
    v_exp_f32 v58, v58
    v_smfmac_f32_16x16x64_bf16 v[152:155], v[168:171], v[80:87], v172
    ds_read_b128 a[144:147], v2 offset:4096
    v_smfmac_f32_16x16x64_bf16 v[156:159], v[168:171], v[96:103], v172
    ds_read_b128 v[148:151], v174 offset:1344
    v_smfmac_f32_16x16x64_bf16 v[160:163], v[168:171], v[112:119], v172
    ds_read_b128 a[148:151], v2 offset:5120
    v_smfmac_f32_16x16x64_bf16 v[164:167], v[168:171], v[128:135], v172
    s_waitcnt lgkmcnt(6)
    ds_read_b128 a[152:155], v2 offset:6144
    v_mfma_f32_16x16x32_bf16 v[80:83], a[128:131], a[64:67], v[144:147]
    s_waitcnt lgkmcnt(6)
    ds_read_b128 a[156:159], v2 offset:7168
    v_cvt_pk_bf16_f32 v50, v52, v53
    v_mfma_f32_16x16x32_bf16 v[80:83], a[132:135], a[68:71], v[80:83]
    s_waitcnt lgkmcnt(6)
    global_load_lds_dwordx4 v4, s[62:63] offset:2048 sc1
    v_mfma_f32_16x16x32_bf16 v[80:83], a[136:139], a[72:75], v[80:83]
    s_waitcnt lgkmcnt(5)
    v_exp_f32 v59, v59
    v_mfma_f32_16x16x32_bf16 v[80:83], a[140:143], a[76:79], v[80:83]
    v_exp_f32 v72, v72
    v_mfma_f32_16x16x32_bf16 v[96:99], a[140:143], a[92:95], v[144:147]
    v_exp_f32 v73, v73
    v_mfma_f32_16x16x32_bf16 v[96:99], a[136:139], a[88:91], v[96:99]
    global_load_lds_dwordx4 v4, s[62:63] offset:3072 sc1
    v_mfma_f32_16x16x32_bf16 v[96:99], a[132:135], a[84:87], v[96:99]
    v_exp_f32 v74, v74
    v_mfma_f32_16x16x32_bf16 v[96:99], a[128:131], a[80:83], v[96:99]
    v_exp_f32 v75, v75
    v_mfma_f32_16x16x32_bf16 v[112:115], a[128:131], a[96:99], v[144:147]
    v_exp_f32 v76, v76
    v_mfma_f32_16x16x32_bf16 v[112:115], a[132:135], a[100:103], v[112:115]
    global_load_dword v13, v12, s[10:11]
    v_mfma_f32_16x16x32_bf16 v[112:115], a[136:139], a[104:107], v[112:115]
    v_exp_f32 v77, v77
    v_mfma_f32_16x16x32_bf16 v[112:115], a[140:143], a[108:111], v[112:115]
    s_add_u32 m0, s60, 98304
    v_exp_f32 v78, v78
    v_mfma_f32_16x16x32_bf16 v[128:131], a[140:143], a[124:127], v[144:147]
    s_add_u32 s62, s8, 262144
    ds_read_b128 a[160:163], v2 offset:8192
    v_cvt_pk_bf16_f32 v51, v54, v55
    v_mfma_f32_16x16x32_bf16 v[128:131], a[136:139], a[120:123], v[128:131]
    s_addc_u32 s63, s9, 0
    ds_read_b128 v[144:147], v174 offset:1408
    ds_read_b128 a[164:167], v2 offset:9216
    v_mfma_f32_16x16x32_bf16 v[128:131], a[132:135], a[116:119], v[128:131]
    global_load_lds_dwordx4 v4, s[62:63] offset:0 sc1
    v_mfma_f32_16x16x32_bf16 v[128:131], a[128:131], a[112:115], v[128:131]
    s_waitcnt lgkmcnt(6)
    ds_read_b128 a[168:171], v2 offset:10240
    ds_read_b128 a[172:175], v2 offset:11264
    v_mfma_f32_16x16x32_bf16 v[132:135], a[144:147], a[112:115], v[148:151]
    s_waitcnt lgkmcnt(7)
    v_exp_f32 v79, v79
    v_mfma_f32_16x16x32_bf16 v[132:135], a[148:151], a[116:119], v[132:135]
    s_waitcnt lgkmcnt(6)
    v_exp_f32 v60, v60
    v_mfma_f32_16x16x32_bf16 v[132:135], a[152:155], a[120:123], v[132:135]
    s_waitcnt lgkmcnt(5)
    global_load_lds_dwordx4 v4, s[62:63] offset:1024 sc1
    v_mfma_f32_16x16x32_bf16 v[132:135], a[156:159], a[124:127], v[132:135]
Lpad3:
    s_cbranch_execz Lpad6
    v_exp_f32 v61, v61
    v_mfma_f32_16x16x32_bf16 v[116:119], a[156:159], a[108:111], v[148:151]
    v_exp_f32 v62, v62
    v_mfma_f32_16x16x32_bf16 v[116:119], a[152:155], a[104:107], v[116:119]
    v_cvt_pk_bf16_f32 v34, v36, v37
    v_cvt_pk_bf16_f32 v35, v38, v39
    v_mfma_f32_16x16x32_bf16 v[116:119], a[148:151], a[100:103], v[116:119]
    global_load_lds_dwordx4 v4, s[62:63] offset:2048 sc1
    v_mfma_f32_16x16x32_bf16 v[116:119], a[144:147], a[96:99], v[116:119]
    v_exp_f32 v63, v63
    v_mfma_f32_16x16x32_bf16 v[100:103], a[144:147], a[80:83], v[148:151]
    v_cvt_pk_bf16_f32 v18, v20, v21
    v_cvt_pk_bf16_f32 v19, v22, v23
    v_mfma_f32_16x16x32_bf16 v[100:103], a[148:151], a[84:87], v[100:103]
    v_exp_f32 v44, v44
    v_mfma_f32_16x16x32_bf16 v[100:103], a[152:155], a[88:91], v[100:103]
    global_load_lds_dwordx4 v4, s[62:63] offset:3072 sc1
    v_mfma_f32_16x16x32_bf16 v[100:103], a[156:159], a[92:95], v[100:103]
    v_cvt_pk_bf16_f32 v20, v24, v25
    v_cvt_pk_bf16_f32 v21, v26, v27
    v_mfma_f32_16x16x32_bf16 v[84:87], a[156:159], a[76:79], v[148:151]
    ds_read_b128 a[176:179], v2 offset:12288
    v_cvt_pk_bf16_f32 v36, v40, v41
    v_mfma_f32_16x16x32_bf16 v[84:87], a[152:155], a[72:75], v[84:87]
    s_nop 0
    ds_read_b128 v[148:151], v174 offset:1472
    ds_read_b128 a[180:183], v2 offset:13312
    v_mfma_f32_16x16x32_bf16 v[84:87], a[148:151], a[68:71], v[84:87]
    ds_read_b128 a[184:187], v2 offset:14336
    v_cvt_pk_bf16_f32 v37, v42, v43
    v_mfma_f32_16x16x32_bf16 v[84:87], a[144:147], a[64:67], v[84:87]
    s_waitcnt lgkmcnt(7)
    ds_read_b128 a[188:191], v2 offset:15360
    v_cvt_pk_bf16_f32 v52, v56, v57
    v_mfma_f32_16x16x32_bf16 v[88:91], a[160:163], a[64:67], v[144:147]
    s_waitcnt lgkmcnt(7)
    v_exp_f32 v45, v45
    v_mfma_f32_16x16x32_bf16 v[88:91], a[164:167], a[68:71], v[88:91]
    s_waitcnt lgkmcnt(6)
    v_exp_f32 v46, v46
    v_mfma_f32_16x16x32_bf16 v[88:91], a[168:171], a[72:75], v[88:91]
    s_waitcnt lgkmcnt(5)
    v_cvt_pk_bf16_f32 v53, v58, v59
    v_cvt_pk_bf16_f32 v68, v72, v73
    v_mfma_f32_16x16x32_bf16 v[88:91], a[172:175], a[76:79], v[88:91]
    v_exp_f32 v47, v47
    v_mfma_f32_16x16x32_bf16 v[104:107], a[172:175], a[92:95], v[144:147]
    v_cvt_pk_bf16_f32 v69, v74, v75
    v_cvt_pk_bf16_f32 v70, v76, v77
    v_mfma_f32_16x16x32_bf16 v[104:107], a[168:171], a[88:91], v[104:107]
    v_exp_f32 v28, v28
    v_mfma_f32_16x16x32_bf16 v[104:107], a[164:167], a[84:87], v[104:107]
    v_cvt_pk_bf16_f32 v71, v78, v79
    v_cvt_pk_bf16_f32 v54, v60, v61
    v_mfma_f32_16x16x32_bf16 v[104:107], a[160:163], a[80:83], v[104:107]
    v_exp_f32 v29, v29
    v_mfma_f32_16x16x32_bf16 v[120:123], a[160:163], a[96:99], v[144:147]
    v_cvt_pk_bf16_f32 v55, v62, v63
    v_cvt_pk_bf16_f32 v38, v44, v45
    v_mfma_f32_16x16x32_bf16 v[120:123], a[164:167], a[100:103], v[120:123]
    v_exp_f32 v30, v30
    v_mfma_f32_16x16x32_bf16 v[120:123], a[168:171], a[104:107], v[120:123]
    v_cvt_pk_bf16_f32 v39, v46, v47
    v_cvt_pk_bf16_f32 v22, v28, v29
    v_mfma_f32_16x16x32_bf16 v[120:123], a[172:175], a[108:111], v[120:123]
    v_exp_f32 v31, v31
    v_mfma_f32_16x16x32_bf16 v[136:139], a[172:175], a[124:127], v[144:147]
    ds_read_b128 a[128:131], v2 offset:16384
    v_cvt_pk_bf16_f32 v23, v30, v31
    v_mfma_f32_16x16x32_bf16 v[136:139], a[168:171], a[120:123], v[136:139]
    ds_read_b128 a[132:135], v2 offset:17408
    v_mfma_f32_16x16x32_bf16 v[136:139], a[164:167], a[116:119], v[136:139]
    v_exp_f32 v80, v80
    v_mfma_f32_16x16x32_bf16 v[136:139], a[160:163], a[112:115], v[136:139]
    s_waitcnt lgkmcnt(5)
    v_exp_f32 v81, v81
    v_mfma_f32_16x16x32_bf16 v[140:143], a[176:179], a[112:115], v[148:151]
    s_waitcnt lgkmcnt(4)
    v_exp_f32 v82, v82
    v_mfma_f32_16x16x32_bf16 v[140:143], a[180:183], a[116:119], v[140:143]
    s_waitcnt lgkmcnt(3)
    v_exp_f32 v83, v83
    v_mfma_f32_16x16x32_bf16 v[140:143], a[184:187], a[120:123], v[140:143]
    s_waitcnt lgkmcnt(2)
    v_exp_f32 v96, v96
    v_mfma_f32_16x16x32_bf16 v[140:143], a[188:191], a[124:127], v[140:143]
    v_exp_f32 v97, v97
    v_mfma_f32_16x16x32_bf16 v[124:127], a[188:191], a[108:111], v[148:151]
    ds_read_b128 a[136:139], v2 offset:18432
    v_cvt_pk_bf16_f32 v80, v80, v81
    v_mfma_f32_16x16x32_bf16 v[124:127], a[184:187], a[104:107], v[124:127]
    ds_read_b128 a[140:143], v2 offset:19456
    v_cvt_pk_bf16_f32 v81, v82, v83
    v_mfma_f32_16x16x32_bf16 v[124:127], a[180:183], a[100:103], v[124:127]
    v_exp_f32 v98, v98
    v_mfma_f32_16x16x32_bf16 v[124:127], a[176:179], a[96:99], v[124:127]
    v_exp_f32 v99, v99
    v_mfma_f32_16x16x32_bf16 v[108:111], a[176:179], a[80:83], v[148:151]
    v_exp_f32 v112, v112
    v_mfma_f32_16x16x32_bf16 v[108:111], a[180:183], a[84:87], v[108:111]
    v_exp_f32 v113, v113
    v_mfma_f32_16x16x32_bf16 v[108:111], a[184:187], a[88:91], v[108:111]
    v_exp_f32 v114, v114
    v_mfma_f32_16x16x32_bf16 v[108:111], a[188:191], a[92:95], v[108:111]
    v_exp_f32 v115, v115
    v_mfma_f32_16x16x32_bf16 v[92:95], a[188:191], a[76:79], v[148:151]
    ds_read_b128 a[144:147], v2 offset:20480
    v_cvt_pk_bf16_f32 v96, v96, v97
    v_mfma_f32_16x16x32_bf16 v[92:95], a[184:187], a[72:75], v[92:95]
    ds_read_b128 a[148:151], v2 offset:21504
    v_cvt_pk_bf16_f32 v97, v98, v99
    v_mfma_f32_16x16x32_bf16 v[92:95], a[180:183], a[68:71], v[92:95]
    v_exp_f32 v128, v128
    v_mfma_f32_16x16x32_bf16 v[92:95], a[176:179], a[64:67], v[92:95]
    s_waitcnt lgkmcnt(5)
    v_exp_f32 v129, v129
    v_mfma_f32_16x16x32_bf16 v[176:179], a[128:131], v[16:19], v[176:179]
    s_waitcnt lgkmcnt(4)
    v_exp_f32 v130, v130
    v_mfma_f32_16x16x32_bf16 v[176:179], a[132:135], v[20:23], v[176:179]
    v_exp_f32 v131, v131
    v_mfma_f32_16x16x32_bf16 v[208:211], a[132:135], v[36:39], v[208:211]
    v_exp_f32 v132, v132
    v_mfma_f32_16x16x32_bf16 v[208:211], a[128:131], v[32:35], v[208:211]
    v_exp_f32 v133, v133
    v_mfma_f32_16x16x32_bf16 a[0:3], a[128:131], v[48:51], a[0:3]
    ds_read_b128 a[152:155], v2 offset:22528
    v_cvt_pk_bf16_f32 v112, v112, v113
    v_mfma_f32_16x16x32_bf16 a[0:3], a[132:135], v[52:55], a[0:3]
    ds_read_b128 a[156:159], v2 offset:23552
    v_cvt_pk_bf16_f32 v113, v114, v115
    v_mfma_f32_16x16x32_bf16 a[32:35], a[132:135], v[68:71], a[32:35]
    v_exp_f32 v134, v134
    v_mfma_f32_16x16x32_bf16 a[32:35], a[128:131], v[64:67], a[32:35]
    s_waitcnt lgkmcnt(5)
    v_exp_f32 v135, v135
    v_mfma_f32_16x16x32_bf16 a[36:39], a[136:139], v[64:67], a[36:39]
    s_waitcnt lgkmcnt(4)
    v_exp_f32 v116, v116
    v_mfma_f32_16x16x32_bf16 a[36:39], a[140:143], v[68:71], a[36:39]
    v_exp_f32 v117, v117
    v_mfma_f32_16x16x32_bf16 a[4:7], a[140:143], v[52:55], a[4:7]
    v_exp_f32 v118, v118
    v_mfma_f32_16x16x32_bf16 a[4:7], a[136:139], v[48:51], a[4:7]
    v_exp_f32 v119, v119
    v_mfma_f32_16x16x32_bf16 v[212:215], a[136:139], v[32:35], v[212:215]
    ds_read_b128 a[160:163], v2 offset:24576
    v_cvt_pk_bf16_f32 v128, v128, v129
    v_mfma_f32_16x16x32_bf16 v[212:215], a[140:143], v[36:39], v[212:215]
    ds_read_b128 a[164:167], v2 offset:25600
    v_cvt_pk_bf16_f32 v129, v130, v131
    v_mfma_f32_16x16x32_bf16 v[180:183], a[140:143], v[20:23], v[180:183]
    v_exp_f32 v100, v100
    v_mfma_f32_16x16x32_bf16 v[180:183], a[136:139], v[16:19], v[180:183]
    s_waitcnt lgkmcnt(5)
    v_exp_f32 v101, v101
    v_mfma_f32_16x16x32_bf16 v[184:187], a[144:147], v[16:19], v[184:187]
    s_waitcnt lgkmcnt(4)
    v_exp_f32 v102, v102
    v_mfma_f32_16x16x32_bf16 v[184:187], a[148:151], v[20:23], v[184:187]
    v_exp_f32 v103, v103
    v_mfma_f32_16x16x32_bf16 v[216:219], a[148:151], v[36:39], v[216:219]
    v_exp_f32 v84, v84
    v_mfma_f32_16x16x32_bf16 v[216:219], a[144:147], v[32:35], v[216:219]
    v_exp_f32 v85, v85
    v_mfma_f32_16x16x32_bf16 a[8:11], a[144:147], v[48:51], a[8:11]
    ds_read_b128 a[168:171], v2 offset:26624
    v_cvt_pk_bf16_f32 v130, v132, v133
    v_mfma_f32_16x16x32_bf16 a[8:11], a[148:151], v[52:55], a[8:11]
    ds_read_b128 a[172:175], v2 offset:27648
    v_cvt_pk_bf16_f32 v131, v134, v135
    v_mfma_f32_16x16x32_bf16 a[40:43], a[148:151], v[68:71], a[40:43]
    v_exp_f32 v86, v86
    v_mfma_f32_16x16x32_bf16 a[40:43], a[144:147], v[64:67], a[40:43]
    s_waitcnt lgkmcnt(5)
    v_exp_f32 v87, v87
    v_mfma_f32_16x16x32_bf16 a[44:47], a[152:155], v[64:67], a[44:47]
    s_waitcnt lgkmcnt(4)
    v_exp_f32 v88, v88
    v_mfma_f32_16x16x32_bf16 a[44:47], a[156:159], v[68:71], a[44:47]
    v_exp_f32 v89, v89
    v_mfma_f32_16x16x32_bf16 a[12:15], a[156:159], v[52:55], a[12:15]
    v_exp_f32 v90, v90
    v_mfma_f32_16x16x32_bf16 a[12:15], a[152:155], v[48:51], a[12:15]
    v_exp_f32 v91, v91
    v_mfma_f32_16x16x32_bf16 v[220:223], a[152:155], v[32:35], v[220:223]
    ds_read_b128 a[176:179], v2 offset:28672
    v_cvt_pk_bf16_f32 v114, v116, v117
    v_mfma_f32_16x16x32_bf16 v[220:223], a[156:159], v[36:39], v[220:223]
    ds_read_b128 a[180:183], v2 offset:29696
    v_cvt_pk_bf16_f32 v115, v118, v119
    v_mfma_f32_16x16x32_bf16 v[188:191], a[156:159], v[20:23], v[188:191]
    v_exp_f32 v104, v104
    v_mfma_f32_16x16x32_bf16 v[188:191], a[152:155], v[16:19], v[188:191]
    s_waitcnt lgkmcnt(5)
    v_exp_f32 v105, v105
    v_mfma_f32_16x16x32_bf16 v[192:195], a[160:163], v[16:19], v[192:195]
    s_waitcnt lgkmcnt(4)
    v_exp_f32 v106, v106
    v_mfma_f32_16x16x32_bf16 v[192:195], a[164:167], v[20:23], v[192:195]
    v_exp_f32 v107, v107
    v_mfma_f32_16x16x32_bf16 v[224:227], a[164:167], v[36:39], v[224:227]
    v_exp_f32 v120, v120
    v_mfma_f32_16x16x32_bf16 v[224:227], a[160:163], v[32:35], v[224:227]
    v_exp_f32 v121, v121
    v_mfma_f32_16x16x32_bf16 a[16:19], a[160:163], v[48:51], a[16:19]
    ds_read_b128 a[184:187], v2 offset:30720
    v_cvt_pk_bf16_f32 v98, v100, v101
    v_mfma_f32_16x16x32_bf16 a[16:19], a[164:167], v[52:55], a[16:19]
    ds_read_b128 a[188:191], v2 offset:31744
    v_cvt_pk_bf16_f32 v99, v102, v103
    v_mfma_f32_16x16x32_bf16 a[48:51], a[164:167], v[68:71], a[48:51]
    v_exp_f32 v122, v122
    v_mfma_f32_16x16x32_bf16 a[48:51], a[160:163], v[64:67], a[48:51]
    s_waitcnt lgkmcnt(5)
    v_exp_f32 v123, v123
    v_mfma_f32_16x16x32_bf16 a[52:55], a[168:171], v[64:67], a[52:55]
    s_waitcnt lgkmcnt(4)
    v_exp_f32 v136, v136
    v_mfma_f32_16x16x32_bf16 a[52:55], a[172:175], v[68:71], a[52:55]
    v_exp_f32 v137, v137
    v_mfma_f32_16x16x32_bf16 a[20:23], a[172:175], v[52:55], a[20:23]
    v_exp_f32 v138, v138
    v_mfma_f32_16x16x32_bf16 a[20:23], a[168:171], v[48:51], a[20:23]
    v_exp_f32 v139, v139
    v_mfma_f32_16x16x32_bf16 v[228:231], a[168:171], v[32:35], v[228:231]
    ds_read_b128 v[168:171], v175 offset:2048
    v_cvt_pk_bf16_f32 v82, v84, v85
    v_mfma_f32_16x16x32_bf16 v[228:231], a[172:175], v[36:39], v[228:231]
    v_exp_f32 v140, v140
    v_mfma_f32_16x16x32_bf16 v[196:199], a[172:175], v[20:23], v[196:199]
    v_exp_f32 v141, v141
    v_mfma_f32_16x16x32_bf16 v[196:199], a[168:171], v[16:19], v[196:199]
    s_waitcnt lgkmcnt(4)
    v_exp_f32 v142, v142
    v_mfma_f32_16x16x32_bf16 v[200:203], a[176:179], v[16:19], v[200:203]
    s_waitcnt lgkmcnt(3)
    ds_read_b128 v[144:147], v174 offset:1536
    v_cvt_pk_bf16_f32 v83, v86, v87
    v_mfma_f32_16x16x32_bf16 v[200:203], a[180:183], v[20:23], v[200:203]
    v_exp_f32 v143, v143
    v_mfma_f32_16x16x32_bf16 v[232:235], a[180:183], v[36:39], v[232:235]
    s_add_u32 m0, s60, 114688
    v_exp_f32 v124, v124
    v_mfma_f32_16x16x32_bf16 v[232:235], a[176:179], v[32:35], v[232:235]
    s_waitcnt vmcnt(14)
    v_exp_f32 v125, v125
    v_mfma_f32_16x16x32_bf16 a[24:27], a[176:179], v[48:51], a[24:27]
    s_barrier
    v_mfma_f32_16x16x32_bf16 a[24:27], a[180:183], v[52:55], a[24:27]
    s_add_u32 s62, s8, 245760
    ds_read_b128 a[128:131], v2 offset:32768
    ds_read_b128 a[132:135], v2 offset:33792
    v_mfma_f32_16x16x32_bf16 a[56:59], a[180:183], v[68:71], a[56:59]
    s_addc_u32 s63, s9, 0
    ds_read_b128 a[136:139], v2 offset:34816
    ds_read_b128 a[140:143], v2 offset:35840
    v_mfma_f32_16x16x32_bf16 a[56:59], a[176:179], v[64:67], a[56:59]
    s_waitcnt lgkmcnt(7)
    global_load_lds_dwordx4 v4, s[62:63] offset:0 sc1
    v_mfma_f32_16x16x32_bf16 a[60:63], a[184:187], v[64:67], a[60:63]
    s_waitcnt lgkmcnt(6)
    v_exp_f32 v126, v126
    v_mfma_f32_16x16x32_bf16 a[60:63], a[188:191], v[68:71], a[60:63]
    v_exp_f32 v127, v127
    v_mfma_f32_16x16x32_bf16 a[28:31], a[188:191], v[52:55], a[28:31]
    v_exp_f32 v108, v108
    v_mfma_f32_16x16x32_bf16 a[28:31], a[184:187], v[48:51], a[28:31]
    global_load_lds_dwordx4 v4, s[62:63] offset:1024 sc1
    v_mfma_f32_16x16x32_bf16 v[236:239], a[184:187], v[32:35], v[236:239]
    v_cvt_pk_bf16_f32 v84, v88, v89
    v_cvt_pk_bf16_f32 v85, v90, v91
    v_mfma_f32_16x16x32_bf16 v[236:239], a[188:191], v[36:39], v[236:239]
    v_exp_f32 v109, v109
    v_mfma_f32_16x16x32_bf16 v[204:207], a[188:191], v[20:23], v[204:207]
    v_cvt_pk_bf16_f32 v100, v104, v105
    v_cvt_pk_bf16_f32 v101, v106, v107
    v_mfma_f32_16x16x32_bf16 v[204:207], a[184:187], v[16:19], v[204:207]
    s_waitcnt lgkmcnt(5)
    global_load_lds_dwordx4 v4, s[62:63] offset:2048 sc1
    v_smfmac_f32_16x16x64_bf16 v[152:155], v[168:171], v[16:23], v172
    ds_read_b128 a[144:147], v2 offset:36864
    v_smfmac_f32_16x16x64_bf16 v[156:159], v[168:171], v[32:39], v172
    ds_read_b128 v[148:151], v174 offset:1600
    v_smfmac_f32_16x16x64_bf16 v[160:163], v[168:171], v[48:55], v172
    ds_read_b128 a[148:151], v2 offset:37888
    v_smfmac_f32_16x16x64_bf16 v[164:167], v[168:171], v[64:71], v172
    s_waitcnt lgkmcnt(6)
    ds_read_b128 a[152:155], v2 offset:38912
    v_mfma_f32_16x16x32_bf16 v[16:19], a[128:131], a[64:67], v[144:147]
    s_waitcnt lgkmcnt(6)
    ds_read_b128 a[156:159], v2 offset:39936
    v_cvt_pk_bf16_f32 v116, v120, v121
    v_mfma_f32_16x16x32_bf16 v[16:19], a[132:135], a[68:71], v[16:19]
    s_waitcnt lgkmcnt(6)
    global_load_lds_dwordx4 v4, s[62:63] offset:3072 sc1
    v_mfma_f32_16x16x32_bf16 v[16:19], a[136:139], a[72:75], v[16:19]
    s_waitcnt lgkmcnt(5)
    v_exp_f32 v110, v110
    v_mfma_f32_16x16x32_bf16 v[16:19], a[140:143], a[76:79], v[16:19]
    v_cvt_pk_bf16_f32 v117, v122, v123
    v_cvt_pk_bf16_f32 v132, v136, v137
    v_mfma_f32_16x16x32_bf16 v[32:35], a[140:143], a[92:95], v[144:147]
    s_add_u32 m0, s60, 0
    s_add_u32 s62, s8, 294912
    s_addc_u32 s63, s9, 0
    v_exp_f32 v111, v111
    v_mfma_f32_16x16x32_bf16 v[32:35], a[136:139], a[88:91], v[32:35]
    global_load_lds_dwordx4 v4, s[62:63] offset:0 sc1
    v_mfma_f32_16x16x32_bf16 v[32:35], a[132:135], a[84:87], v[32:35]
    v_cvt_pk_bf16_f32 v133, v138, v139
    v_cvt_pk_bf16_f32 v134, v140, v141
    v_mfma_f32_16x16x32_bf16 v[32:35], a[128:131], a[80:83], v[32:35]
    v_exp_f32 v92, v92
    v_mfma_f32_16x16x32_bf16 v[48:51], a[128:131], a[96:99], v[144:147]
    v_cvt_pk_bf16_f32 v135, v142, v143
    v_cvt_pk_bf16_f32 v118, v124, v125
    v_mfma_f32_16x16x32_bf16 v[48:51], a[132:135], a[100:103], v[48:51]
    global_load_lds_dwordx4 v4, s[62:63] offset:1024 sc1
    v_mfma_f32_16x16x32_bf16 v[48:51], a[136:139], a[104:107], v[48:51]
    v_exp_f32 v93, v93
    v_mfma_f32_16x16x32_bf16 v[48:51], a[140:143], a[108:111], v[48:51]
    v_cvt_pk_bf16_f32 v119, v126, v127
    v_cvt_pk_bf16_f32 v102, v108, v109
    v_mfma_f32_16x16x32_bf16 v[64:67], a[140:143], a[124:127], v[144:147]
    ds_read_b128 a[160:163], v2 offset:40960
    v_cvt_pk_bf16_f32 v103, v110, v111
    v_mfma_f32_16x16x32_bf16 v[64:67], a[136:139], a[120:123], v[64:67]
    s_nop 0
    ds_read_b128 v[144:147], v174 offset:1664
    ds_read_b128 a[164:167], v2 offset:41984
    v_mfma_f32_16x16x32_bf16 v[64:67], a[132:135], a[116:119], v[64:67]
    ds_read_b128 a[168:171], v2 offset:43008
    v_cvt_pk_bf16_f32 v86, v92, v93
    v_mfma_f32_16x16x32_bf16 v[64:67], a[128:131], a[112:115], v[64:67]
    s_waitcnt lgkmcnt(7)
    ds_read_b128 a[172:175], v2 offset:44032
    v_mfma_f32_16x16x32_bf16 v[68:71], a[144:147], a[112:115], v[148:151]
    s_waitcnt lgkmcnt(7)
    global_load_lds_dwordx4 v4, s[62:63] offset:2048 sc1
    v_mfma_f32_16x16x32_bf16 v[68:71], a[148:151], a[116:119], v[68:71]
    s_waitcnt lgkmcnt(6)
    v_exp_f32 v94, v94
    v_mfma_f32_16x16x32_bf16 v[68:71], a[152:155], a[120:123], v[68:71]
    s_waitcnt lgkmcnt(5)
    v_exp_f32 v95, v95
    v_mfma_f32_16x16x32_bf16 v[68:71], a[156:159], a[124:127], v[68:71]
    v_cvt_pk_bf16_f32 v87, v94, v95
    v_mfma_f32_16x16x32_bf16 v[52:55], a[156:159], a[108:111], v[148:151]
    global_load_lds_dwordx4 v4, s[62:63] offset:3072 sc1
    v_mfma_f32_16x16x32_bf16 v[52:55], a[152:155], a[104:107], v[52:55]
    v_exp_f32 v16, v16
    v_mfma_f32_16x16x32_bf16 v[52:55], a[148:151], a[100:103], v[52:55]
    v_exp_f32 v17, v17
    v_mfma_f32_16x16x32_bf16 v[52:55], a[144:147], a[96:99], v[52:55]
    v_exp_f32 v18, v18
    v_mfma_f32_16x16x32_bf16 v[36:39], a[144:147], a[80:83], v[148:151]
    v_exp_f32 v19, v19
    v_mfma_f32_16x16x32_bf16 v[36:39], a[148:151], a[84:87], v[36:39]
    v_exp_f32 v32, v32
    v_mfma_f32_16x16x32_bf16 v[36:39], a[152:155], a[88:91], v[36:39]
    v_exp_f32 v33, v33
    v_mfma_f32_16x16x32_bf16 v[36:39], a[156:159], a[92:95], v[36:39]
    v_exp_f32 v34, v34
    v_mfma_f32_16x16x32_bf16 v[20:23], a[156:159], a[76:79], v[148:151]
    ds_read_b128 a[176:179], v2 offset:45056
    v_cvt_pk_bf16_f32 v16, v16, v17
    v_mfma_f32_16x16x32_bf16 v[20:23], a[152:155], a[72:75], v[20:23]
    s_nop 0
    ds_read_b128 v[148:151], v174 offset:1728
    ds_read_b128 a[180:183], v2 offset:46080
    v_mfma_f32_16x16x32_bf16 v[20:23], a[148:151], a[68:71], v[20:23]
    ds_read_b128 a[184:187], v2 offset:47104
    v_cvt_pk_bf16_f32 v17, v18, v19
    v_mfma_f32_16x16x32_bf16 v[20:23], a[144:147], a[64:67], v[20:23]
    s_waitcnt lgkmcnt(7)
    ds_read_b128 a[188:191], v2 offset:48128
    v_cvt_pk_bf16_f32 v32, v32, v33
    v_mfma_f32_16x16x32_bf16 v[24:27], a[160:163], a[64:67], v[144:147]
    s_waitcnt lgkmcnt(7)
    v_exp_f32 v35, v35
    v_mfma_f32_16x16x32_bf16 v[24:27], a[164:167], a[68:71], v[24:27]
    s_waitcnt lgkmcnt(6)
    v_exp_f32 v48, v48
    v_mfma_f32_16x16x32_bf16 v[24:27], a[168:171], a[72:75], v[24:27]
    s_waitcnt lgkmcnt(5)
    v_exp_f32 v49, v49
    v_mfma_f32_16x16x32_bf16 v[24:27], a[172:175], a[76:79], v[24:27]
    v_exp_f32 v50, v50
    v_mfma_f32_16x16x32_bf16 v[40:43], a[172:175], a[92:95], v[144:147]
    global_load_ubyte v9, v15, s[6:7] sc1
    v_mfma_f32_16x16x32_bf16 v[40:43], a[168:171], a[88:91], v[40:43]
    v_exp_f32 v51, v51
    v_mfma_f32_16x16x32_bf16 v[40:43], a[164:167], a[84:87], v[40:43]
    v_exp_f32 v64, v64
    v_mfma_f32_16x16x32_bf16 v[40:43], a[160:163], a[80:83], v[40:43]
    v_exp_f32 v65, v65
    v_mfma_f32_16x16x32_bf16 v[56:59], a[160:163], a[96:99], v[144:147]
    global_load_dword v10, v8, s[70:71] sc1
    v_mfma_f32_16x16x32_bf16 v[56:59], a[164:167], a[100:103], v[56:59]
    v_exp_f32 v66, v66
    v_mfma_f32_16x16x32_bf16 v[56:59], a[168:171], a[104:107], v[56:59]
    v_exp_f32 v67, v67
    v_mfma_f32_16x16x32_bf16 v[56:59], a[172:175], a[108:111], v[56:59]
    v_exp_f32 v68, v68
    v_mfma_f32_16x16x32_bf16 v[72:75], a[172:175], a[124:127], v[144:147]
    ds_read_b128 a[128:131], v2 offset:49152
    v_cvt_pk_bf16_f32 v33, v34, v35
    v_mfma_f32_16x16x32_bf16 v[72:75], a[168:171], a[120:123], v[72:75]
    ds_read_b128 a[132:135], v2 offset:50176
    v_cvt_pk_bf16_f32 v48, v48, v49
    v_mfma_f32_16x16x32_bf16 v[72:75], a[164:167], a[116:119], v[72:75]
    v_exp_f32 v69, v69
    v_mfma_f32_16x16x32_bf16 v[72:75], a[160:163], a[112:115], v[72:75]
    s_waitcnt lgkmcnt(5)
    v_exp_f32 v70, v70
    v_mfma_f32_16x16x32_bf16 v[76:79], a[176:179], a[112:115], v[148:151]
    s_waitcnt lgkmcnt(4)
    v_exp_f32 v71, v71
    v_mfma_f32_16x16x32_bf16 v[76:79], a[180:183], a[116:119], v[76:79]
    s_waitcnt lgkmcnt(3)
    v_exp_f32 v52, v52
    v_mfma_f32_16x16x32_bf16 v[76:79], a[184:187], a[120:123], v[76:79]
    s_waitcnt lgkmcnt(2)
    v_exp_f32 v53, v53
    v_mfma_f32_16x16x32_bf16 v[76:79], a[188:191], a[124:127], v[76:79]
    v_exp_f32 v54, v54
    v_mfma_f32_16x16x32_bf16 v[60:63], a[188:191], a[108:111], v[148:151]
    ds_read_b128 a[136:139], v2 offset:51200
    v_cvt_pk_bf16_f32 v49, v50, v51
    v_mfma_f32_16x16x32_bf16 v[60:63], a[184:187], a[104:107], v[60:63]
    ds_read_b128 a[140:143], v2 offset:52224
    v_cvt_pk_bf16_f32 v64, v64, v65
    v_mfma_f32_16x16x32_bf16 v[60:63], a[180:183], a[100:103], v[60:63]
    v_exp_f32 v55, v55
    v_mfma_f32_16x16x32_bf16 v[60:63], a[176:179], a[96:99], v[60:63]
    v_exp_f32 v36, v36
    v_mfma_f32_16x16x32_bf16 v[44:47], a[176:179], a[80:83], v[148:151]
    v_exp_f32 v37, v37
    v_mfma_f32_16x16x32_bf16 v[44:47], a[180:183], a[84:87], v[44:47]
    v_exp_f32 v38, v38
    v_mfma_f32_16x16x32_bf16 v[44:47], a[184:187], a[88:91], v[44:47]
    v_exp_f32 v39, v39
    v_mfma_f32_16x16x32_bf16 v[44:47], a[188:191], a[92:95], v[44:47]
    v_exp_f32 v20, v20
    v_mfma_f32_16x16x32_bf16 v[28:31], a[188:191], a[76:79], v[148:151]
    ds_read_b128 a[144:147], v2 offset:53248
    v_cvt_pk_bf16_f32 v65, v66, v67
    v_mfma_f32_16x16x32_bf16 v[28:31], a[184:187], a[72:75], v[28:31]
    ds_read_b128 a[148:151], v2 offset:54272
    v_cvt_pk_bf16_f32 v66, v68, v69
    v_mfma_f32_16x16x32_bf16 v[28:31], a[180:183], a[68:71], v[28:31]
    v_exp_f32 v21, v21
    v_mfma_f32_16x16x32_bf16 v[28:31], a[176:179], a[64:67], v[28:31]
    s_waitcnt lgkmcnt(5)
    v_exp_f32 v22, v22
    v_mfma_f32_16x16x32_bf16 v[176:179], a[128:131], v[80:83], v[176:179]
    s_waitcnt lgkmcnt(4)
    v_exp_f32 v23, v23
    v_mfma_f32_16x16x32_bf16 v[176:179], a[132:135], v[84:87], v[176:179]
    v_exp_f32 v24, v24
    v_mfma_f32_16x16x32_bf16 v[208:211], a[132:135], v[100:103], v[208:211]
    v_exp_f32 v25, v25
    v_mfma_f32_16x16x32_bf16 v[208:211], a[128:131], v[96:99], v[208:211]
    v_exp_f32 v26, v26
    v_mfma_f32_16x16x32_bf16 a[0:3], a[128:131], v[112:115], a[0:3]
    ds_read_b128 a[152:155], v2 offset:55296
    v_cvt_pk_bf16_f32 v67, v70, v71
    v_mfma_f32_16x16x32_bf16 a[0:3], a[132:135], v[116:119], a[0:3]
    ds_read_b128 a[156:159], v2 offset:56320
    v_cvt_pk_bf16_f32 v50, v52, v53
    v_mfma_f32_16x16x32_bf16 a[32:35], a[132:135], v[132:135], a[32:35]
    v_exp_f32 v27, v27
    v_mfma_f32_16x16x32_bf16 a[32:35], a[128:131], v[128:131], a[32:35]
    s_waitcnt lgkmcnt(5)
    v_exp_f32 v40, v40
    v_mfma_f32_16x16x32_bf16 a[36:39], a[136:139], v[128:131], a[36:39]
    s_waitcnt lgkmcnt(4)
    v_exp_f32 v41, v41
    v_mfma_f32_16x16x32_bf16 a[36:39], a[140:143], v[132:135], a[36:39]
    v_exp_f32 v42, v42
    v_mfma_f32_16x16x32_bf16 a[4:7], a[140:143], v[116:119], a[4:7]
    v_exp_f32 v43, v43
    v_mfma_f32_16x16x32_bf16 a[4:7], a[136:139], v[112:115], a[4:7]
    v_exp_f32 v56, v56
    v_mfma_f32_16x16x32_bf16 v[212:215], a[136:139], v[96:99], v[212:215]
    ds_read_b128 a[160:163], v2 offset:57344
    v_cvt_pk_bf16_f32 v51, v54, v55
    v_mfma_f32_16x16x32_bf16 v[212:215], a[140:143], v[100:103], v[212:215]
    ds_read_b128 a[164:167], v2 offset:58368
    v_cvt_pk_bf16_f32 v34, v36, v37
    v_mfma_f32_16x16x32_bf16 v[180:183], a[140:143], v[84:87], v[180:183]
    v_exp_f32 v57, v57
    v_mfma_f32_16x16x32_bf16 v[180:183], a[136:139], v[80:83], v[180:183]
    s_waitcnt lgkmcnt(5)
    v_exp_f32 v58, v58
    v_mfma_f32_16x16x32_bf16 v[184:187], a[144:147], v[80:83], v[184:187]
    s_waitcnt lgkmcnt(4)
    v_exp_f32 v59, v59
    v_mfma_f32_16x16x32_bf16 v[184:187], a[148:151], v[84:87], v[184:187]
    v_exp_f32 v72, v72
    v_mfma_f32_16x16x32_bf16 v[216:219], a[148:151], v[100:103], v[216:219]
    v_exp_f32 v73, v73
    v_mfma_f32_16x16x32_bf16 v[216:219], a[144:147], v[96:99], v[216:219]
    v_exp_f32 v74, v74
    v_mfma_f32_16x16x32_bf16 a[8:11], a[144:147], v[112:115], a[8:11]
    ds_read_b128 a[168:171], v2 offset:59392
    v_cvt_pk_bf16_f32 v35, v38, v39
    v_mfma_f32_16x16x32_bf16 a[8:11], a[148:151], v[116:119], a[8:11]
    ds_read_b128 a[172:175], v2 offset:60416
    v_cvt_pk_bf16_f32 v18, v20, v21
    v_mfma_f32_16x16x32_bf16 a[40:43], a[148:151], v[132:135], a[40:43]
    v_exp_f32 v75, v75
    v_mfma_f32_16x16x32_bf16 a[40:43], a[144:147], v[128:131], a[40:43]
    s_waitcnt lgkmcnt(5)
    v_exp_f32 v76, v76
    v_mfma_f32_16x16x32_bf16 a[44:47], a[152:155], v[128:131], a[44:47]
    s_waitcnt lgkmcnt(4)
    v_exp_f32 v77, v77
    v_mfma_f32_16x16x32_bf16 a[44:47], a[156:159], v[132:135], a[44:47]
    v_exp_f32 v78, v78
    v_mfma_f32_16x16x32_bf16 a[12:15], a[156:159], v[116:119], a[12:15]
    v_exp_f32 v79, v79
    v_mfma_f32_16x16x32_bf16 a[12:15], a[152:155], v[112:115], a[12:15]
    v_exp_f32 v60, v60
    v_mfma_f32_16x16x32_bf16 v[220:223], a[152:155], v[96:99], v[220:223]
    ds_read_b128 a[176:179], v2 offset:61440
    v_cvt_pk_bf16_f32 v19, v22, v23
    v_mfma_f32_16x16x32_bf16 v[220:223], a[156:159], v[100:103], v[220:223]
    ds_read_b128 a[180:183], v2 offset:62464
    v_cvt_pk_bf16_f32 v20, v24, v25
    v_mfma_f32_16x16x32_bf16 v[188:191], a[156:159], v[84:87], v[188:191]
    v_exp_f32 v61, v61
    v_mfma_f32_16x16x32_bf16 v[188:191], a[152:155], v[80:83], v[188:191]
    s_waitcnt lgkmcnt(5)
    v_exp_f32 v62, v62
    v_mfma_f32_16x16x32_bf16 v[192:195], a[160:163], v[80:83], v[192:195]
    s_waitcnt lgkmcnt(4)
    v_cvt_pk_bf16_f32 v21, v26, v27
    v_cvt_pk_bf16_f32 v36, v40, v41
    v_mfma_f32_16x16x32_bf16 v[192:195], a[164:167], v[84:87], v[192:195]
    v_exp_f32 v63, v63
    v_mfma_f32_16x16x32_bf16 v[224:227], a[164:167], v[100:103], v[224:227]
    v_cvt_pk_bf16_f32 v37, v42, v43
    v_cvt_pk_bf16_f32 v52, v56, v57
    v_mfma_f32_16x16x32_bf16 v[224:227], a[160:163], v[96:99], v[224:227]
    v_exp_f32 v44, v44
    v_mfma_f32_16x16x32_bf16 a[16:19], a[160:163], v[112:115], a[16:19]
    ds_read_b128 a[184:187], v2 offset:63488
    v_cvt_pk_bf16_f32 v53, v58, v59
    v_mfma_f32_16x16x32_bf16 a[16:19], a[164:167], v[116:119], a[16:19]
    ds_read_b128 a[188:191], v2 offset:64512
    v_cvt_pk_bf16_f32 v68, v72, v73
    v_mfma_f32_16x16x32_bf16 a[48:51], a[164:167], v[132:135], a[48:51]
    v_exp_f32 v45, v45
    v_mfma_f32_16x16x32_bf16 a[48:51], a[160:163], v[128:131], a[48:51]
    s_waitcnt lgkmcnt(5)
    v_cvt_pk_bf16_f32 v69, v74, v75
    v_cvt_pk_bf16_f32 v70, v76, v77
    v_mfma_f32_16x16x32_bf16 a[52:55], a[168:171], v[128:131], a[52:55]
    s_waitcnt lgkmcnt(4)
    v_exp_f32 v46, v46
    v_mfma_f32_16x16x32_bf16 a[52:55], a[172:175], v[132:135], a[52:55]
    v_cvt_pk_bf16_f32 v71, v78, v79
    v_cvt_pk_bf16_f32 v54, v60, v61
    v_mfma_f32_16x16x32_bf16 a[20:23], a[172:175], v[116:119], a[20:23]
    v_exp_f32 v47, v47
    v_mfma_f32_16x16x32_bf16 a[20:23], a[168:171], v[112:115], a[20:23]
    s_waitcnt vmcnt(0)
    v_cvt_pk_bf16_f32 v55, v62, v63
    v_cvt_pk_bf16_f32 v38, v44, v45
    v_mfma_f32_16x16x32_bf16 v[228:231], a[168:171], v[96:99], v[228:231]
    v_and_or_b32 v10, v10, 3, 4
    v_cmp_ne_u32 vcc, v9, v10
    v_mfma_f32_16x16x32_bf16 v[228:231], a[172:175], v[100:103], v[228:231]
    s_cbranch_vccnz Lrecheck
Lchecked:
    ds_read_b128 v[168:171], v175 offset:2560
    v_mfma_f32_16x16x32_bf16 v[196:199], a[172:175], v[84:87], v[196:199]
    v_mfma_f32_16x16x32_bf16 v[196:199], a[168:171], v[80:83], v[196:199]
    s_waitcnt lgkmcnt(4)
    v_mfma_f32_16x16x32_bf16 v[200:203], a[176:179], v[80:83], v[200:203]
    s_waitcnt lgkmcnt(3)
    ds_read_b128 v[144:147], v174 offset:1792
    v_mfma_f32_16x16x32_bf16 v[200:203], a[180:183], v[84:87], v[200:203]
    v_mfma_f32_16x16x32_bf16 v[232:235], a[180:183], v[100:103], v[232:235]
    v_mfma_f32_16x16x32_bf16 v[232:235], a[176:179], v[96:99], v[232:235]
    v_mfma_f32_16x16x32_bf16 a[24:27], a[176:179], v[112:115], a[24:27]
    s_barrier
    v_mfma_f32_16x16x32_bf16 a[24:27], a[180:183], v[116:119], a[24:27]
    s_nop 0
    ds_read_b128 a[128:131], v173 offset:0
    ds_read_b128 a[132:135], v173 offset:1024
    v_mfma_f32_16x16x32_bf16 a[56:59], a[180:183], v[132:135], a[56:59]
    s_nop 0
    ds_read_b128 a[136:139], v173 offset:2048
    ds_read_b128 a[140:143], v173 offset:3072
    v_mfma_f32_16x16x32_bf16 a[56:59], a[176:179], v[128:131], a[56:59]
    s_waitcnt lgkmcnt(7)
    ds_read_b128 a[144:147], v173 offset:4096
    ds_read_b128 a[148:151], v173 offset:5120
    v_mfma_f32_16x16x32_bf16 a[60:63], a[184:187], v[128:131], a[60:63]
    s_waitcnt lgkmcnt(8)
    v_mfma_f32_16x16x32_bf16 a[60:63], a[188:191], v[132:135], a[60:63]
    v_mfma_f32_16x16x32_bf16 a[28:31], a[188:191], v[116:119], a[28:31]
    v_mfma_f32_16x16x32_bf16 a[28:31], a[184:187], v[112:115], a[28:31]
    v_mfma_f32_16x16x32_bf16 v[236:239], a[184:187], v[96:99], v[236:239]
    v_mfma_f32_16x16x32_bf16 v[236:239], a[188:191], v[100:103], v[236:239]
    v_mfma_f32_16x16x32_bf16 v[204:207], a[188:191], v[84:87], v[204:207]
    v_mfma_f32_16x16x32_bf16 v[204:207], a[184:187], v[80:83], v[204:207]
    s_waitcnt lgkmcnt(7)
    v_smfmac_f32_16x16x64_bf16 v[152:155], v[168:171], v[80:87], v172
    v_smfmac_f32_16x16x64_bf16 v[156:159], v[168:171], v[96:103], v172
    v_smfmac_f32_16x16x64_bf16 v[160:163], v[168:171], v[112:119], v172
    v_smfmac_f32_16x16x64_bf16 v[164:167], v[168:171], v[128:135], v172
    s_waitcnt lgkmcnt(2)
Lpad4:
    s_cbranch_execz Lready
    s_nop 0
Lloop:
    v_mfma_f32_16x16x32_bf16 v[80:83], a[128:131], a[64:67], v[144:147]
    s_add_u32 s19, m0, s23
    v_exp_f32 v28, v28
    v_mfma_f32_16x16x32_bf16 v[80:83], a[132:135], a[68:71], v[80:83]
    s_and_b32 m0, s19, s25
    ds_read_b128 a[152:155], v3 offset:6144
    v_cvt_pk_bf16_f32 v39, v46, v47
    v_mfma_f32_16x16x32_bf16 v[80:83], a[136:139], a[72:75], v[80:83]
    s_sub_u32 s62, s62, s23
    v_exp_f32 v29, v29
    v_mfma_f32_16x16x32_bf16 v[80:83], a[140:143], a[76:79], v[80:83]
    s_subb_u32 s63, s63, 0
    v_mfma_f32_16x16x32_bf16 v[96:99], a[140:143], a[92:95], v[144:147]
    v_exp_f32 v30, v30
    v_mfma_f32_16x16x32_bf16 v[96:99], a[136:139], a[88:91], v[96:99]
    ds_read_b128 a[156:159], v3 offset:7168
    v_cvt_pk_bf16_f32 v22, v28, v29
    v_mfma_f32_16x16x32_bf16 v[96:99], a[132:135], a[84:87], v[96:99]
    v_exp_f32 v31, v31
    v_mfma_f32_16x16x32_bf16 v[96:99], a[128:131], a[80:83], v[96:99]
    ds_read_b128 v[148:151], v5 offset:64
    v_mfma_f32_16x16x32_bf16 v[112:115], a[128:131], a[96:99], v[144:147]
    v_exp_f32 v80, v80
    v_mfma_f32_16x16x32_bf16 v[112:115], a[132:135], a[100:103], v[112:115]
    ds_read_b128 a[160:163], v3 offset:8192
    v_cvt_pk_bf16_f32 v23, v30, v31
    v_mfma_f32_16x16x32_bf16 v[112:115], a[136:139], a[104:107], v[112:115]
    v_exp_f32 v81, v81
    v_mfma_f32_16x16x32_bf16 v[112:115], a[140:143], a[108:111], v[112:115]
    global_load_lds_dwordx4 v4, s[62:63] offset:0 sc1
    v_mfma_f32_16x16x32_bf16 v[128:131], a[140:143], a[124:127], v[144:147]
    v_exp_f32 v82, v82
    v_mfma_f32_16x16x32_bf16 v[128:131], a[136:139], a[120:123], v[128:131]
    ds_read_b128 a[164:167], v3 offset:9216
    v_cvt_pk_bf16_f32 v80, v80, v81
    v_mfma_f32_16x16x32_bf16 v[128:131], a[132:135], a[116:119], v[128:131]
    v_exp_f32 v83, v83
    v_mfma_f32_16x16x32_bf16 v[128:131], a[128:131], a[112:115], v[128:131]
    s_waitcnt lgkmcnt(2)
    global_load_lds_dwordx4 v4, s[62:63] offset:1024 sc1
    v_mfma_f32_16x16x32_bf16 v[132:135], a[144:147], a[112:115], v[148:151]
    v_exp_f32 v96, v96
    v_mfma_f32_16x16x32_bf16 v[132:135], a[148:151], a[116:119], v[132:135]
    ds_read_b128 a[168:171], v3 offset:10240
    v_cvt_pk_bf16_f32 v81, v82, v83
    v_mfma_f32_16x16x32_bf16 v[132:135], a[152:155], a[120:123], v[132:135]
    v_exp_f32 v97, v97
    v_mfma_f32_16x16x32_bf16 v[132:135], a[156:159], a[124:127], v[132:135]
    global_load_lds_dwordx4 v4, s[62:63] offset:2048 sc1
    v_mfma_f32_16x16x32_bf16 v[116:119], a[156:159], a[108:111], v[148:151]
    v_exp_f32 v98, v98
    v_mfma_f32_16x16x32_bf16 v[116:119], a[152:155], a[104:107], v[116:119]
    ds_read_b128 a[172:175], v3 offset:11264
    v_cvt_pk_bf16_f32 v96, v96, v97
    v_mfma_f32_16x16x32_bf16 v[116:119], a[148:151], a[100:103], v[116:119]
    v_exp_f32 v99, v99
    v_mfma_f32_16x16x32_bf16 v[116:119], a[144:147], a[96:99], v[116:119]
    ds_read_b128 v[144:147], v5 offset:128
    v_mfma_f32_16x16x32_bf16 v[100:103], a[144:147], a[80:83], v[148:151]
    v_exp_f32 v112, v112
    v_mfma_f32_16x16x32_bf16 v[100:103], a[148:151], a[84:87], v[100:103]
    ds_read_b128 a[176:179], v3 offset:12288
    v_cvt_pk_bf16_f32 v97, v98, v99
    v_mfma_f32_16x16x32_bf16 v[100:103], a[152:155], a[88:91], v[100:103]
    v_exp_f32 v113, v113
    v_mfma_f32_16x16x32_bf16 v[100:103], a[156:159], a[92:95], v[100:103]
    global_load_lds_dwordx4 v4, s[62:63] offset:3072 sc1
    v_mfma_f32_16x16x32_bf16 v[84:87], a[156:159], a[76:79], v[148:151]
    v_exp_f32 v114, v114
    v_mfma_f32_16x16x32_bf16 v[84:87], a[152:155], a[72:75], v[84:87]
    ds_read_b128 a[180:183], v3 offset:13312
    v_cvt_pk_bf16_f32 v112, v112, v113
    v_mfma_f32_16x16x32_bf16 v[84:87], a[148:151], a[68:71], v[84:87]
    v_exp_f32 v115, v115
    v_mfma_f32_16x16x32_bf16 v[84:87], a[144:147], a[64:67], v[84:87]
    s_waitcnt lgkmcnt(2)
    v_mfma_f32_16x16x32_bf16 v[88:91], a[160:163], a[64:67], v[144:147]
    v_exp_f32 v128, v128
    v_mfma_f32_16x16x32_bf16 v[88:91], a[164:167], a[68:71], v[88:91]
    ds_read_b128 a[184:187], v3 offset:14336
    v_cvt_pk_bf16_f32 v113, v114, v115
    v_mfma_f32_16x16x32_bf16 v[88:91], a[168:171], a[72:75], v[88:91]
    v_exp_f32 v129, v129
    v_mfma_f32_16x16x32_bf16 v[88:91], a[172:175], a[76:79], v[88:91]
    v_mfma_f32_16x16x32_bf16 v[104:107], a[172:175], a[92:95], v[144:147]
    v_exp_f32 v130, v130
    v_mfma_f32_16x16x32_bf16 v[104:107], a[168:171], a[88:91], v[104:107]
    ds_read_b128 a[188:191], v3 offset:15360
    v_cvt_pk_bf16_f32 v128, v128, v129
    v_mfma_f32_16x16x32_bf16 v[104:107], a[164:167], a[84:87], v[104:107]
    v_exp_f32 v131, v131
    v_mfma_f32_16x16x32_bf16 v[104:107], a[160:163], a[80:83], v[104:107]
    ds_read_b128 v[148:151], v5 offset:192
    v_mfma_f32_16x16x32_bf16 v[120:123], a[160:163], a[96:99], v[144:147]
    s_add_u32 s19, m0, s23
    v_exp_f32 v132, v132
    v_mfma_f32_16x16x32_bf16 v[120:123], a[164:167], a[100:103], v[120:123]
    s_and_b32 m0, s19, s25
    ds_read_b128 a[128:131], v3 offset:16384
    v_cvt_pk_bf16_f32 v129, v130, v131
    v_mfma_f32_16x16x32_bf16 v[120:123], a[168:171], a[104:107], v[120:123]
    s_add_u32 s62, s62, s24
    v_exp_f32 v133, v133
    v_mfma_f32_16x16x32_bf16 v[120:123], a[172:175], a[108:111], v[120:123]
    s_addc_u32 s63, s63, 0
    v_mfma_f32_16x16x32_bf16 v[136:139], a[172:175], a[124:127], v[144:147]
    v_exp_f32 v134, v134
    v_mfma_f32_16x16x32_bf16 v[136:139], a[168:171], a[120:123], v[136:139]
    ds_read_b128 a[132:135], v3 offset:17408
    v_cvt_pk_bf16_f32 v130, v132, v133
    v_mfma_f32_16x16x32_bf16 v[136:139], a[164:167], a[116:119], v[136:139]
    v_exp_f32 v135, v135
    v_mfma_f32_16x16x32_bf16 v[136:139], a[160:163], a[112:115], v[136:139]
    s_waitcnt lgkmcnt(2)
    v_mfma_f32_16x16x32_bf16 v[140:143], a[176:179], a[112:115], v[148:151]
    v_exp_f32 v116, v116
    v_mfma_f32_16x16x32_bf16 v[140:143], a[180:183], a[116:119], v[140:143]
    ds_read_b128 a[136:139], v3 offset:18432
    v_cvt_pk_bf16_f32 v131, v134, v135
    v_mfma_f32_16x16x32_bf16 v[140:143], a[184:187], a[120:123], v[140:143]
    v_exp_f32 v117, v117
    v_mfma_f32_16x16x32_bf16 v[140:143], a[188:191], a[124:127], v[140:143]
    global_load_lds_dwordx4 v4, s[62:63] offset:0 sc1
    v_mfma_f32_16x16x32_bf16 v[124:127], a[188:191], a[108:111], v[148:151]
    v_exp_f32 v118, v118
    v_mfma_f32_16x16x32_bf16 v[124:127], a[184:187], a[104:107], v[124:127]
    ds_read_b128 a[140:143], v3 offset:19456
    v_cvt_pk_bf16_f32 v114, v116, v117
    v_mfma_f32_16x16x32_bf16 v[124:127], a[180:183], a[100:103], v[124:127]
    v_exp_f32 v119, v119
    v_mfma_f32_16x16x32_bf16 v[124:127], a[176:179], a[96:99], v[124:127]
    v_mfma_f32_16x16x32_bf16 v[108:111], a[176:179], a[80:83], v[148:151]
    v_exp_f32 v100, v100
    v_mfma_f32_16x16x32_bf16 v[108:111], a[180:183], a[84:87], v[108:111]
    ds_read_b128 a[144:147], v3 offset:20480
    v_cvt_pk_bf16_f32 v115, v118, v119
    v_mfma_f32_16x16x32_bf16 v[108:111], a[184:187], a[88:91], v[108:111]
    v_exp_f32 v101, v101
    v_mfma_f32_16x16x32_bf16 v[108:111], a[188:191], a[92:95], v[108:111]
    global_load_lds_dwordx4 v4, s[62:63] offset:1024 sc1
    v_mfma_f32_16x16x32_bf16 v[92:95], a[188:191], a[76:79], v[148:151]
    v_exp_f32 v102, v102
    v_mfma_f32_16x16x32_bf16 v[92:95], a[184:187], a[72:75], v[92:95]
    ds_read_b128 a[148:151], v3 offset:21504
    v_cvt_pk_bf16_f32 v98, v100, v101
    v_mfma_f32_16x16x32_bf16 v[92:95], a[180:183], a[68:71], v[92:95]
    v_exp_f32 v103, v103
    v_mfma_f32_16x16x32_bf16 v[92:95], a[176:179], a[64:67], v[92:95]
    s_waitcnt lgkmcnt(4)
    v_mfma_f32_16x16x32_bf16 v[176:179], a[128:131], v[16:19], v[176:179]
    v_exp_f32 v84, v84
    v_mfma_f32_16x16x32_bf16 v[176:179], a[132:135], v[20:23], v[176:179]
    ds_read_b128 a[152:155], v3 offset:22528
    v_cvt_pk_bf16_f32 v99, v102, v103
    v_mfma_f32_16x16x32_bf16 v[208:211], a[132:135], v[36:39], v[208:211]
    v_exp_f32 v85, v85
    v_mfma_f32_16x16x32_bf16 v[208:211], a[128:131], v[32:35], v[208:211]
    global_load_lds_dwordx4 v4, s[62:63] offset:2048 sc1
    v_mfma_f32_16x16x32_bf16 a[0:3], a[128:131], v[48:51], a[0:3]
    v_exp_f32 v86, v86
    v_mfma_f32_16x16x32_bf16 a[0:3], a[132:135], v[52:55], a[0:3]
    ds_read_b128 a[156:159], v3 offset:23552
    v_cvt_pk_bf16_f32 v82, v84, v85
    v_mfma_f32_16x16x32_bf16 a[32:35], a[132:135], v[68:71], a[32:35]
    v_exp_f32 v87, v87
    v_mfma_f32_16x16x32_bf16 a[32:35], a[128:131], v[64:67], a[32:35]
    s_waitcnt lgkmcnt(4)
    v_mfma_f32_16x16x32_bf16 a[36:39], a[136:139], v[64:67], a[36:39]
    v_exp_f32 v88, v88
    v_mfma_f32_16x16x32_bf16 a[36:39], a[140:143], v[68:71], a[36:39]
    ds_read_b128 a[160:163], v3 offset:24576
    v_cvt_pk_bf16_f32 v83, v86, v87
    v_mfma_f32_16x16x32_bf16 a[4:7], a[140:143], v[52:55], a[4:7]
    v_exp_f32 v89, v89
    v_mfma_f32_16x16x32_bf16 a[4:7], a[136:139], v[48:51], a[4:7]
    global_load_lds_dwordx4 v4, s[62:63] offset:3072 sc1
    v_mfma_f32_16x16x32_bf16 v[212:215], a[136:139], v[32:35], v[212:215]
    v_exp_f32 v90, v90
    v_mfma_f32_16x16x32_bf16 v[212:215], a[140:143], v[36:39], v[212:215]
    ds_read_b128 a[164:167], v3 offset:25600
    v_cvt_pk_bf16_f32 v84, v88, v89
    v_mfma_f32_16x16x32_bf16 v[180:183], a[140:143], v[20:23], v[180:183]
    v_exp_f32 v91, v91
    v_mfma_f32_16x16x32_bf16 v[180:183], a[136:139], v[16:19], v[180:183]
    s_waitcnt lgkmcnt(4)
    v_mfma_f32_16x16x32_bf16 v[184:187], a[144:147], v[16:19], v[184:187]
    v_exp_f32 v104, v104
    v_mfma_f32_16x16x32_bf16 v[184:187], a[148:151], v[20:23], v[184:187]
    ds_read_b128 a[168:171], v3 offset:26624
    v_cvt_pk_bf16_f32 v85, v90, v91
    v_mfma_f32_16x16x32_bf16 v[216:219], a[148:151], v[36:39], v[216:219]
    v_exp_f32 v105, v105
    v_mfma_f32_16x16x32_bf16 v[216:219], a[144:147], v[32:35], v[216:219]
    v_mfma_f32_16x16x32_bf16 a[8:11], a[144:147], v[48:51], a[8:11]
    v_exp_f32 v106, v106
    v_mfma_f32_16x16x32_bf16 a[8:11], a[148:151], v[52:55], a[8:11]
    ds_read_b128 a[172:175], v3 offset:27648
    v_cvt_pk_bf16_f32 v100, v104, v105
    v_mfma_f32_16x16x32_bf16 a[40:43], a[148:151], v[68:71], a[40:43]
    v_exp_f32 v107, v107
    v_mfma_f32_16x16x32_bf16 a[40:43], a[144:147], v[64:67], a[40:43]
    s_waitcnt lgkmcnt(4)
    v_mfma_f32_16x16x32_bf16 a[44:47], a[152:155], v[64:67], a[44:47]
    v_exp_f32 v120, v120
    v_mfma_f32_16x16x32_bf16 a[44:47], a[156:159], v[68:71], a[44:47]
    ds_read_b128 a[176:179], v3 offset:28672
    v_cvt_pk_bf16_f32 v101, v106, v107
    v_mfma_f32_16x16x32_bf16 a[12:15], a[156:159], v[52:55], a[12:15]
    v_exp_f32 v121, v121
    v_mfma_f32_16x16x32_bf16 a[12:15], a[152:155], v[48:51], a[12:15]
    v_mfma_f32_16x16x32_bf16 v[220:223], a[152:155], v[32:35], v[220:223]
    v_exp_f32 v122, v122
    v_mfma_f32_16x16x32_bf16 v[220:223], a[156:159], v[36:39], v[220:223]
    ds_read_b128 a[180:183], v3 offset:29696
    v_cvt_pk_bf16_f32 v116, v120, v121
    v_mfma_f32_16x16x32_bf16 v[188:191], a[156:159], v[20:23], v[188:191]
    v_exp_f32 v123, v123
    v_mfma_f32_16x16x32_bf16 v[188:191], a[152:155], v[16:19], v[188:191]
    s_waitcnt lgkmcnt(4)
    v_mfma_f32_16x16x32_bf16 v[192:195], a[160:163], v[16:19], v[192:195]
    v_exp_f32 v136, v136
    v_mfma_f32_16x16x32_bf16 v[192:195], a[164:167], v[20:23], v[192:195]
    ds_read_b128 a[184:187], v3 offset:30720
    v_cvt_pk_bf16_f32 v117, v122, v123
    v_mfma_f32_16x16x32_bf16 v[224:227], a[164:167], v[36:39], v[224:227]
    s_waitcnt vmcnt(12)
    v_exp_f32 v137, v137
    v_mfma_f32_16x16x32_bf16 v[224:227], a[160:163], v[32:35], v[224:227]
    s_barrier
    v_mfma_f32_16x16x32_bf16 a[16:19], a[160:163], v[48:51], a[16:19]
    v_exp_f32 v138, v138
    v_mfma_f32_16x16x32_bf16 a[16:19], a[164:167], v[52:55], a[16:19]
    ds_read_b128 a[188:191], v3 offset:31744
    v_cvt_pk_bf16_f32 v132, v136, v137
    v_mfma_f32_16x16x32_bf16 a[48:51], a[164:167], v[68:71], a[48:51]
    v_exp_f32 v139, v139
    v_mfma_f32_16x16x32_bf16 a[48:51], a[160:163], v[64:67], a[48:51]
    s_waitcnt lgkmcnt(4)
    v_mfma_f32_16x16x32_bf16 a[52:55], a[168:171], v[64:67], a[52:55]
    v_exp_f32 v140, v140
    v_mfma_f32_16x16x32_bf16 a[52:55], a[172:175], v[68:71], a[52:55]
    ds_read_b128 a[128:131], v3 offset:32768
    v_cvt_pk_bf16_f32 v133, v138, v139
    v_mfma_f32_16x16x32_bf16 a[20:23], a[172:175], v[52:55], a[20:23]
    v_exp_f32 v141, v141
    v_mfma_f32_16x16x32_bf16 a[20:23], a[168:171], v[48:51], a[20:23]
    v_mfma_f32_16x16x32_bf16 v[228:231], a[168:171], v[32:35], v[228:231]
    v_exp_f32 v142, v142
    v_mfma_f32_16x16x32_bf16 v[228:231], a[172:175], v[36:39], v[228:231]
    ds_read_b128 a[132:135], v3 offset:33792
    v_cvt_pk_bf16_f32 v134, v140, v141
    v_mfma_f32_16x16x32_bf16 v[196:199], a[172:175], v[20:23], v[196:199]
    v_exp_f32 v143, v143
    v_mfma_f32_16x16x32_bf16 v[196:199], a[168:171], v[16:19], v[196:199]
    s_waitcnt lgkmcnt(4)
    v_mfma_f32_16x16x32_bf16 v[200:203], a[176:179], v[16:19], v[200:203]
    v_exp_f32 v124, v124
    v_mfma_f32_16x16x32_bf16 v[200:203], a[180:183], v[20:23], v[200:203]
    ds_read_b128 a[136:139], v3 offset:34816
    v_cvt_pk_bf16_f32 v135, v142, v143
    v_mfma_f32_16x16x32_bf16 v[232:235], a[180:183], v[36:39], v[232:235]
    v_exp_f32 v125, v125
    v_mfma_f32_16x16x32_bf16 v[232:235], a[176:179], v[32:35], v[232:235]
    ds_read_b128 v[168:171], v6 offset:0
    v_mfma_f32_16x16x32_bf16 a[24:27], a[176:179], v[48:51], a[24:27]
    v_exp_f32 v126, v126
    v_mfma_f32_16x16x32_bf16 a[24:27], a[180:183], v[52:55], a[24:27]
    ds_read_b128 a[140:143], v3 offset:35840
    v_cvt_pk_bf16_f32 v118, v124, v125
    v_mfma_f32_16x16x32_bf16 a[56:59], a[180:183], v[68:71], a[56:59]
    v_exp_f32 v127, v127
    v_mfma_f32_16x16x32_bf16 a[56:59], a[176:179], v[64:67], a[56:59]
    s_waitcnt lgkmcnt(5)
    v_mfma_f32_16x16x32_bf16 a[60:63], a[184:187], v[64:67], a[60:63]
    v_exp_f32 v108, v108
    v_mfma_f32_16x16x32_bf16 a[60:63], a[188:191], v[68:71], a[60:63]
    ds_read_b128 a[144:147], v3 offset:36864
    v_cvt_pk_bf16_f32 v119, v126, v127
    v_mfma_f32_16x16x32_bf16 a[28:31], a[188:191], v[52:55], a[28:31]
    v_exp_f32 v109, v109
    v_mfma_f32_16x16x32_bf16 a[28:31], a[184:187], v[48:51], a[28:31]
    ds_read_b128 v[144:147], v5 offset:256
    v_mfma_f32_16x16x32_bf16 v[236:239], a[184:187], v[32:35], v[236:239]
    v_exp_f32 v110, v110
    v_mfma_f32_16x16x32_bf16 v[236:239], a[188:191], v[36:39], v[236:239]
    ds_read_b128 a[148:151], v3 offset:37888
    v_cvt_pk_bf16_f32 v102, v108, v109
    v_mfma_f32_16x16x32_bf16 v[204:207], a[188:191], v[20:23], v[204:207]
    v_exp_f32 v111, v111
    v_mfma_f32_16x16x32_bf16 v[204:207], a[184:187], v[16:19], v[204:207]
    s_waitcnt lgkmcnt(4)
    v_smfmac_f32_16x16x64_bf16 v[152:155], v[168:171], v[16:23], v172
    v_smfmac_f32_16x16x64_bf16 v[156:159], v[168:171], v[32:39], v172
    s_waitcnt lgkmcnt(1)
    v_smfmac_f32_16x16x64_bf16 v[160:163], v[168:171], v[48:55], v172
    v_smfmac_f32_16x16x64_bf16 v[164:167], v[168:171], v[64:71], v172
    v_mfma_f32_16x16x32_bf16 v[16:19], a[128:131], a[64:67], v[144:147]
    s_add_u32 s19, m0, s23
    v_exp_f32 v92, v92
    v_mfma_f32_16x16x32_bf16 v[16:19], a[132:135], a[68:71], v[16:19]
    s_and_b32 m0, s19, s25
    ds_read_b128 a[152:155], v3 offset:38912
    v_cvt_pk_bf16_f32 v103, v110, v111
    v_mfma_f32_16x16x32_bf16 v[16:19], a[136:139], a[72:75], v[16:19]
    s_sub_u32 s62, s62, s23
    v_exp_f32 v93, v93
    v_mfma_f32_16x16x32_bf16 v[16:19], a[140:143], a[76:79], v[16:19]
    s_subb_u32 s63, s63, 0
    v_mfma_f32_16x16x32_bf16 v[32:35], a[140:143], a[92:95], v[144:147]
    v_exp_f32 v94, v94
    v_mfma_f32_16x16x32_bf16 v[32:35], a[136:139], a[88:91], v[32:35]
    ds_read_b128 a[156:159], v3 offset:39936
    v_cvt_pk_bf16_f32 v86, v92, v93
    v_mfma_f32_16x16x32_bf16 v[32:35], a[132:135], a[84:87], v[32:35]
    v_exp_f32 v95, v95
    v_mfma_f32_16x16x32_bf16 v[32:35], a[128:131], a[80:83], v[32:35]
    ds_read_b128 v[148:151], v5 offset:320
    v_mfma_f32_16x16x32_bf16 v[48:51], a[128:131], a[96:99], v[144:147]
    v_exp_f32 v16, v16
    v_mfma_f32_16x16x32_bf16 v[48:51], a[132:135], a[100:103], v[48:51]
    ds_read_b128 a[160:163], v3 offset:40960
    v_cvt_pk_bf16_f32 v87, v94, v95
    v_mfma_f32_16x16x32_bf16 v[48:51], a[136:139], a[104:107], v[48:51]
    v_exp_f32 v17, v17
    v_mfma_f32_16x16x32_bf16 v[48:51], a[140:143], a[108:111], v[48:51]
    global_load_lds_dwordx4 v4, s[62:63] offset:0 sc1
    v_mfma_f32_16x16x32_bf16 v[64:67], a[140:143], a[124:127], v[144:147]
    v_exp_f32 v18, v18
    v_mfma_f32_16x16x32_bf16 v[64:67], a[136:139], a[120:123], v[64:67]
    ds_read_b128 a[164:167], v3 offset:41984
    v_cvt_pk_bf16_f32 v16, v16, v17
    v_mfma_f32_16x16x32_bf16 v[64:67], a[132:135], a[116:119], v[64:67]
    v_exp_f32 v19, v19
    v_mfma_f32_16x16x32_bf16 v[64:67], a[128:131], a[112:115], v[64:67]
    s_waitcnt lgkmcnt(2)
    global_load_lds_dwordx4 v4, s[62:63] offset:1024 sc1
    v_mfma_f32_16x16x32_bf16 v[68:71], a[144:147], a[112:115], v[148:151]
    v_exp_f32 v32, v32
    v_mfma_f32_16x16x32_bf16 v[68:71], a[148:151], a[116:119], v[68:71]
    ds_read_b128 a[168:171], v3 offset:43008
    v_cvt_pk_bf16_f32 v17, v18, v19
    v_mfma_f32_16x16x32_bf16 v[68:71], a[152:155], a[120:123], v[68:71]
    v_exp_f32 v33, v33
    v_mfma_f32_16x16x32_bf16 v[68:71], a[156:159], a[124:127], v[68:71]
    global_load_lds_dwordx4 v4, s[62:63] offset:2048 sc1
    v_mfma_f32_16x16x32_bf16 v[52:55], a[156:159], a[108:111], v[148:151]
    v_exp_f32 v34, v34
    v_mfma_f32_16x16x32_bf16 v[52:55], a[152:155], a[104:107], v[52:55]
    ds_read_b128 a[172:175], v3 offset:44032
    v_cvt_pk_bf16_f32 v32, v32, v33
    v_mfma_f32_16x16x32_bf16 v[52:55], a[148:151], a[100:103], v[52:55]
    v_exp_f32 v35, v35
    v_mfma_f32_16x16x32_bf16 v[52:55], a[144:147], a[96:99], v[52:55]
    ds_read_b128 v[144:147], v5 offset:384
    v_mfma_f32_16x16x32_bf16 v[36:39], a[144:147], a[80:83], v[148:151]
    v_exp_f32 v48, v48
    v_mfma_f32_16x16x32_bf16 v[36:39], a[148:151], a[84:87], v[36:39]
    ds_read_b128 a[176:179], v3 offset:45056
    v_cvt_pk_bf16_f32 v33, v34, v35
    v_mfma_f32_16x16x32_bf16 v[36:39], a[152:155], a[88:91], v[36:39]
    v_exp_f32 v49, v49
    v_mfma_f32_16x16x32_bf16 v[36:39], a[156:159], a[92:95], v[36:39]
    global_load_lds_dwordx4 v4, s[62:63] offset:3072 sc1
    v_mfma_f32_16x16x32_bf16 v[20:23], a[156:159], a[76:79], v[148:151]
    v_exp_f32 v50, v50
    v_mfma_f32_16x16x32_bf16 v[20:23], a[152:155], a[72:75], v[20:23]
    ds_read_b128 a[180:183], v3 offset:46080
    v_cvt_pk_bf16_f32 v48, v48, v49
    v_mfma_f32_16x16x32_bf16 v[20:23], a[148:151], a[68:71], v[20:23]
    v_exp_f32 v51, v51
    v_mfma_f32_16x16x32_bf16 v[20:23], a[144:147], a[64:67], v[20:23]
    s_waitcnt lgkmcnt(2)
    v_mfma_f32_16x16x32_bf16 v[24:27], a[160:163], a[64:67], v[144:147]
    v_exp_f32 v64, v64
    v_mfma_f32_16x16x32_bf16 v[24:27], a[164:167], a[68:71], v[24:27]
    ds_read_b128 a[184:187], v3 offset:47104
    v_cvt_pk_bf16_f32 v49, v50, v51
    v_mfma_f32_16x16x32_bf16 v[24:27], a[168:171], a[72:75], v[24:27]
    v_exp_f32 v65, v65
    v_mfma_f32_16x16x32_bf16 v[24:27], a[172:175], a[76:79], v[24:27]
    v_mfma_f32_16x16x32_bf16 v[40:43], a[172:175], a[92:95], v[144:147]
    v_exp_f32 v66, v66
    v_mfma_f32_16x16x32_bf16 v[40:43], a[168:171], a[88:91], v[40:43]
    ds_read_b128 a[188:191], v3 offset:48128
    v_cvt_pk_bf16_f32 v64, v64, v65
    v_mfma_f32_16x16x32_bf16 v[40:43], a[164:167], a[84:87], v[40:43]
    v_exp_f32 v67, v67
    v_mfma_f32_16x16x32_bf16 v[40:43], a[160:163], a[80:83], v[40:43]
    ds_read_b128 v[148:151], v5 offset:448
    v_mfma_f32_16x16x32_bf16 v[56:59], a[160:163], a[96:99], v[144:147]
    s_add_u32 s19, m0, s23
    v_exp_f32 v68, v68
    v_mfma_f32_16x16x32_bf16 v[56:59], a[164:167], a[100:103], v[56:59]
    s_and_b32 m0, s19, s25
    ds_read_b128 a[128:131], v3 offset:49152
    v_cvt_pk_bf16_f32 v65, v66, v67
    v_mfma_f32_16x16x32_bf16 v[56:59], a[168:171], a[104:107], v[56:59]
    s_add_u32 s62, s62, s24
    v_exp_f32 v69, v69
    v_mfma_f32_16x16x32_bf16 v[56:59], a[172:175], a[108:111], v[56:59]
    s_addc_u32 s63, s63, 0
    v_mfma_f32_16x16x32_bf16 v[72:75], a[172:175], a[124:127], v[144:147]
    v_exp_f32 v70, v70
    v_mfma_f32_16x16x32_bf16 v[72:75], a[168:171], a[120:123], v[72:75]
    ds_read_b128 a[132:135], v3 offset:50176
    v_cvt_pk_bf16_f32 v66, v68, v69
    v_mfma_f32_16x16x32_bf16 v[72:75], a[164:167], a[116:119], v[72:75]
    v_exp_f32 v71, v71
    v_mfma_f32_16x16x32_bf16 v[72:75], a[160:163], a[112:115], v[72:75]
    s_waitcnt lgkmcnt(2)
    v_mfma_f32_16x16x32_bf16 v[76:79], a[176:179], a[112:115], v[148:151]
    v_exp_f32 v52, v52
    v_mfma_f32_16x16x32_bf16 v[76:79], a[180:183], a[116:119], v[76:79]
    ds_read_b128 a[136:139], v3 offset:51200
    v_cvt_pk_bf16_f32 v67, v70, v71
    v_mfma_f32_16x16x32_bf16 v[76:79], a[184:187], a[120:123], v[76:79]
    v_exp_f32 v53, v53
    v_mfma_f32_16x16x32_bf16 v[76:79], a[188:191], a[124:127], v[76:79]
    global_load_lds_dwordx4 v4, s[62:63] offset:0 sc1
    v_mfma_f32_16x16x32_bf16 v[60:63], a[188:191], a[108:111], v[148:151]
    v_exp_f32 v54, v54
    v_mfma_f32_16x16x32_bf16 v[60:63], a[184:187], a[104:107], v[60:63]
    ds_read_b128 a[140:143], v3 offset:52224
    v_cvt_pk_bf16_f32 v50, v52, v53
    v_mfma_f32_16x16x32_bf16 v[60:63], a[180:183], a[100:103], v[60:63]
    v_exp_f32 v55, v55
    v_mfma_f32_16x16x32_bf16 v[60:63], a[176:179], a[96:99], v[60:63]
    v_mfma_f32_16x16x32_bf16 v[44:47], a[176:179], a[80:83], v[148:151]
    v_exp_f32 v36, v36
    v_mfma_f32_16x16x32_bf16 v[44:47], a[180:183], a[84:87], v[44:47]
    ds_read_b128 a[144:147], v3 offset:53248
    v_cvt_pk_bf16_f32 v51, v54, v55
    v_mfma_f32_16x16x32_bf16 v[44:47], a[184:187], a[88:91], v[44:47]
    v_exp_f32 v37, v37
    v_mfma_f32_16x16x32_bf16 v[44:47], a[188:191], a[92:95], v[44:47]
    global_load_lds_dwordx4 v4, s[62:63] offset:1024 sc1
    v_mfma_f32_16x16x32_bf16 v[28:31], a[188:191], a[76:79], v[148:151]
    v_exp_f32 v38, v38
    v_mfma_f32_16x16x32_bf16 v[28:31], a[184:187], a[72:75], v[28:31]
    ds_read_b128 a[148:151], v3 offset:54272
    v_cvt_pk_bf16_f32 v34, v36, v37
    v_mfma_f32_16x16x32_bf16 v[28:31], a[180:183], a[68:71], v[28:31]
    v_exp_f32 v39, v39
    v_mfma_f32_16x16x32_bf16 v[28:31], a[176:179], a[64:67], v[28:31]
    s_waitcnt lgkmcnt(4)
    v_mfma_f32_16x16x32_bf16 v[176:179], a[128:131], v[80:83], v[176:179]
    v_exp_f32 v20, v20
    v_mfma_f32_16x16x32_bf16 v[176:179], a[132:135], v[84:87], v[176:179]
    ds_read_b128 a[152:155], v3 offset:55296
    v_cvt_pk_bf16_f32 v35, v38, v39
    v_mfma_f32_16x16x32_bf16 v[208:211], a[132:135], v[100:103], v[208:211]
    v_exp_f32 v21, v21
    v_mfma_f32_16x16x32_bf16 v[208:211], a[128:131], v[96:99], v[208:211]
    global_load_lds_dwordx4 v4, s[62:63] offset:2048 sc1
    v_mfma_f32_16x16x32_bf16 a[0:3], a[128:131], v[112:115], a[0:3]
    v_exp_f32 v22, v22
    v_mfma_f32_16x16x32_bf16 a[0:3], a[132:135], v[116:119], a[0:3]
    ds_read_b128 a[156:159], v3 offset:56320
    v_cvt_pk_bf16_f32 v18, v20, v21
    v_mfma_f32_16x16x32_bf16 a[32:35], a[132:135], v[132:135], a[32:35]
    v_exp_f32 v23, v23
    v_mfma_f32_16x16x32_bf16 a[32:35], a[128:131], v[128:131], a[32:35]
    s_waitcnt lgkmcnt(4)
    v_mfma_f32_16x16x32_bf16 a[36:39], a[136:139], v[128:131], a[36:39]
    v_exp_f32 v24, v24
    v_mfma_f32_16x16x32_bf16 a[36:39], a[140:143], v[132:135], a[36:39]
    ds_read_b128 a[160:163], v3 offset:57344
    v_cvt_pk_bf16_f32 v19, v22, v23
    v_mfma_f32_16x16x32_bf16 a[4:7], a[140:143], v[116:119], a[4:7]
    v_exp_f32 v25, v25
    v_mfma_f32_16x16x32_bf16 a[4:7], a[136:139], v[112:115], a[4:7]
    global_load_lds_dwordx4 v4, s[62:63] offset:3072 sc1
    v_mfma_f32_16x16x32_bf16 v[212:215], a[136:139], v[96:99], v[212:215]
    v_exp_f32 v26, v26
    v_mfma_f32_16x16x32_bf16 v[212:215], a[140:143], v[100:103], v[212:215]
    ds_read_b128 a[164:167], v3 offset:58368
    v_cvt_pk_bf16_f32 v20, v24, v25
    v_mfma_f32_16x16x32_bf16 v[180:183], a[140:143], v[84:87], v[180:183]
    v_exp_f32 v27, v27
    v_mfma_f32_16x16x32_bf16 v[180:183], a[136:139], v[80:83], v[180:183]
    s_waitcnt lgkmcnt(4)
    v_mfma_f32_16x16x32_bf16 v[184:187], a[144:147], v[80:83], v[184:187]
    v_exp_f32 v40, v40
    v_mfma_f32_16x16x32_bf16 v[184:187], a[148:151], v[84:87], v[184:187]
    ds_read_b128 a[168:171], v3 offset:59392
    v_cvt_pk_bf16_f32 v21, v26, v27
    v_mfma_f32_16x16x32_bf16 v[216:219], a[148:151], v[100:103], v[216:219]
    v_exp_f32 v41, v41
    v_mfma_f32_16x16x32_bf16 v[216:219], a[144:147], v[96:99], v[216:219]
    v_mfma_f32_16x16x32_bf16 a[8:11], a[144:147], v[112:115], a[8:11]
    v_exp_f32 v42, v42
    v_mfma_f32_16x16x32_bf16 a[8:11], a[148:151], v[116:119], a[8:11]
    ds_read_b128 a[172:175], v3 offset:60416
    v_cvt_pk_bf16_f32 v36, v40, v41
    v_mfma_f32_16x16x32_bf16 a[40:43], a[148:151], v[132:135], a[40:43]
    v_exp_f32 v43, v43
    v_mfma_f32_16x16x32_bf16 a[40:43], a[144:147], v[128:131], a[40:43]
    s_waitcnt lgkmcnt(4)
    v_mfma_f32_16x16x32_bf16 a[44:47], a[152:155], v[128:131], a[44:47]
    v_exp_f32 v56, v56
    v_mfma_f32_16x16x32_bf16 a[44:47], a[156:159], v[132:135], a[44:47]
    ds_read_b128 a[176:179], v3 offset:61440
    v_cvt_pk_bf16_f32 v37, v42, v43
    v_mfma_f32_16x16x32_bf16 a[12:15], a[156:159], v[116:119], a[12:15]
    v_exp_f32 v57, v57
    v_mfma_f32_16x16x32_bf16 a[12:15], a[152:155], v[112:115], a[12:15]
    v_mfma_f32_16x16x32_bf16 v[220:223], a[152:155], v[96:99], v[220:223]
    v_exp_f32 v58, v58
    v_mfma_f32_16x16x32_bf16 v[220:223], a[156:159], v[100:103], v[220:223]
    ds_read_b128 a[180:183], v3 offset:62464
    v_cvt_pk_bf16_f32 v52, v56, v57
    v_mfma_f32_16x16x32_bf16 v[188:191], a[156:159], v[84:87], v[188:191]
    v_exp_f32 v59, v59
    v_mfma_f32_16x16x32_bf16 v[188:191], a[152:155], v[80:83], v[188:191]
    s_waitcnt lgkmcnt(4)
    v_mfma_f32_16x16x32_bf16 v[192:195], a[160:163], v[80:83], v[192:195]
    v_exp_f32 v72, v72
    v_mfma_f32_16x16x32_bf16 v[192:195], a[164:167], v[84:87], v[192:195]
    ds_read_b128 a[184:187], v3 offset:63488
    v_cvt_pk_bf16_f32 v53, v58, v59
    v_mfma_f32_16x16x32_bf16 v[224:227], a[164:167], v[100:103], v[224:227]
    s_waitcnt vmcnt(12)
    v_exp_f32 v73, v73
    v_mfma_f32_16x16x32_bf16 v[224:227], a[160:163], v[96:99], v[224:227]
    s_barrier
    v_mfma_f32_16x16x32_bf16 a[16:19], a[160:163], v[112:115], a[16:19]
    v_exp_f32 v74, v74
    v_mfma_f32_16x16x32_bf16 a[16:19], a[164:167], v[116:119], a[16:19]
    ds_read_b128 a[188:191], v3 offset:64512
    v_cvt_pk_bf16_f32 v68, v72, v73
    v_mfma_f32_16x16x32_bf16 a[48:51], a[164:167], v[132:135], a[48:51]
    v_exp_f32 v75, v75
    v_mfma_f32_16x16x32_bf16 a[48:51], a[160:163], v[128:131], a[48:51]
    s_waitcnt lgkmcnt(4)
    v_xor_b32 v3, 0x10000, v3
    v_mfma_f32_16x16x32_bf16 a[52:55], a[168:171], v[128:131], a[52:55]
    v_exp_f32 v76, v76
    v_mfma_f32_16x16x32_bf16 a[52:55], a[172:175], v[132:135], a[52:55]
    ds_read_b128 a[128:131], v3 offset:0
    v_cvt_pk_bf16_f32 v69, v74, v75
    v_mfma_f32_16x16x32_bf16 a[20:23], a[172:175], v[116:119], a[20:23]
    v_exp_f32 v77, v77
    v_mfma_f32_16x16x32_bf16 a[20:23], a[168:171], v[112:115], a[20:23]
    v_mfma_f32_16x16x32_bf16 v[228:231], a[168:171], v[96:99], v[228:231]
    v_exp_f32 v78, v78
    v_mfma_f32_16x16x32_bf16 v[228:231], a[172:175], v[100:103], v[228:231]
    ds_read_b128 a[132:135], v3 offset:1024
    v_cvt_pk_bf16_f32 v70, v76, v77
    v_mfma_f32_16x16x32_bf16 v[196:199], a[172:175], v[84:87], v[196:199]
    v_exp_f32 v79, v79
    v_mfma_f32_16x16x32_bf16 v[196:199], a[168:171], v[80:83], v[196:199]
    s_waitcnt lgkmcnt(4)
    v_mfma_f32_16x16x32_bf16 v[200:203], a[176:179], v[80:83], v[200:203]
    v_exp_f32 v60, v60
    v_mfma_f32_16x16x32_bf16 v[200:203], a[180:183], v[84:87], v[200:203]
    ds_read_b128 a[136:139], v3 offset:2048
    v_cvt_pk_bf16_f32 v71, v78, v79
    v_mfma_f32_16x16x32_bf16 v[232:235], a[180:183], v[100:103], v[232:235]
    v_exp_f32 v61, v61
    v_mfma_f32_16x16x32_bf16 v[232:235], a[176:179], v[96:99], v[232:235]
    ds_read_b128 v[168:171], v6 offset:512
    v_mfma_f32_16x16x32_bf16 a[24:27], a[176:179], v[112:115], a[24:27]
    v_exp_f32 v62, v62
    v_mfma_f32_16x16x32_bf16 a[24:27], a[180:183], v[116:119], a[24:27]
    ds_read_b128 a[140:143], v3 offset:3072
    v_cvt_pk_bf16_f32 v54, v60, v61
    v_mfma_f32_16x16x32_bf16 a[56:59], a[180:183], v[132:135], a[56:59]
    v_exp_f32 v63, v63
    v_mfma_f32_16x16x32_bf16 a[56:59], a[176:179], v[128:131], a[56:59]
    s_waitcnt lgkmcnt(5)
    v_mfma_f32_16x16x32_bf16 a[60:63], a[184:187], v[128:131], a[60:63]
    v_exp_f32 v44, v44
    v_mfma_f32_16x16x32_bf16 a[60:63], a[188:191], v[132:135], a[60:63]
    ds_read_b128 a[144:147], v3 offset:4096
    v_cvt_pk_bf16_f32 v55, v62, v63
    v_mfma_f32_16x16x32_bf16 a[28:31], a[188:191], v[116:119], a[28:31]
    v_exp_f32 v45, v45
    v_mfma_f32_16x16x32_bf16 a[28:31], a[184:187], v[112:115], a[28:31]
    ds_read_b128 v[144:147], v5 offset:512
    v_mfma_f32_16x16x32_bf16 v[236:239], a[184:187], v[96:99], v[236:239]
    v_exp_f32 v46, v46
    v_mfma_f32_16x16x32_bf16 v[236:239], a[188:191], v[100:103], v[236:239]
    ds_read_b128 a[148:151], v3 offset:5120
    v_cvt_pk_bf16_f32 v38, v44, v45
    v_mfma_f32_16x16x32_bf16 v[204:207], a[188:191], v[84:87], v[204:207]
    v_exp_f32 v47, v47
    v_mfma_f32_16x16x32_bf16 v[204:207], a[184:187], v[80:83], v[204:207]
    s_waitcnt lgkmcnt(4)
    v_smfmac_f32_16x16x64_bf16 v[152:155], v[168:171], v[80:87], v172
    s_add_u32 s17, s17, 1
    v_add_u32 v5, 0x200, v5
    v_smfmac_f32_16x16x64_bf16 v[156:159], v[168:171], v[96:103], v172
    s_waitcnt lgkmcnt(1)
    v_add_u32 v6, 0x400, v6
    v_smfmac_f32_16x16x64_bf16 v[160:163], v[168:171], v[112:119], v172
    s_cmp_lt_u32 s17, 16
    v_smfmac_f32_16x16x64_bf16 v[164:167], v[168:171], v[128:135], v172
    s_cbranch_scc1 Lloop
Lpost:
    v_mfma_f32_16x16x32_bf16 v[112:115], a[128:131], a[96:99], v[144:147]
    s_nop 0
    ds_read_b128 v[168:171], v175 offset:14336
    ds_read_b128 a[192:195], v2 offset:16384
    v_mfma_f32_16x16x32_bf16 v[112:115], a[132:135], a[100:103], v[112:115]
Lpad5:
    s_cbranch_execz Lready
    v_exp_f32 v28, v28
    v_mfma_f32_16x16x32_bf16 v[112:115], a[136:139], a[104:107], v[112:115]
    ds_read_b128 a[196:199], v2 offset:17408
    v_cvt_pk_bf16_f32 v39, v46, v47
    v_mfma_f32_16x16x32_bf16 v[112:115], a[140:143], a[108:111], v[112:115]
    s_add_u32 m0, s60, 81920
    v_exp_f32 v29, v29
    v_mfma_f32_16x16x32_bf16 v[128:131], a[140:143], a[124:127], v[144:147]
    s_add_u32 s62, s8, 999424
    v_exp_f32 v30, v30
    v_mfma_f32_16x16x32_bf16 v[128:131], a[136:139], a[120:123], v[128:131]
    s_addc_u32 s63, s9, 0
    v_exp_f32 v31, v31
    v_mfma_f32_16x16x32_bf16 v[128:131], a[132:135], a[116:119], v[128:131]
    global_load_lds_dwordx4 v4, s[62:63] offset:0 sc1
    ds_read_b128 a[200:203], v2 offset:18432
    v_mfma_f32_16x16x32_bf16 v[128:131], a[128:131], a[112:115], v[128:131]
    s_waitcnt lgkmcnt(3)
    ds_read_b128 a[204:207], v2 offset:19456
    v_cvt_pk_bf16_f32 v22, v28, v29
    v_cvt_pk_bf16_f32 v23, v30, v31
    v_smfmac_f32_16x16x64_bf16 v[156:159], v[168:171], v[32:39], v172
    ds_read_b128 a[208:211], v2 offset:20480
    v_smfmac_f32_16x16x64_bf16 v[152:155], v[168:171], v[16:23], v172
    s_waitcnt lgkmcnt(4)
    ds_read_b128 a[212:215], v2 offset:21504
    v_mfma_f32_16x16x32_bf16 v[208:211], a[192:195], v[32:35], v[208:211]
    s_waitcnt lgkmcnt(4)
    global_load_lds_dwordx4 v4, s[62:63] offset:1024 sc1
    v_mfma_f32_16x16x32_bf16 v[208:211], a[196:199], v[36:39], v[208:211]
    s_nop 0
    ds_read_b128 a[216:219], v2 offset:22528
    ds_read_b128 a[220:223], v2 offset:23552
    v_mfma_f32_16x16x32_bf16 v[176:179], a[196:199], v[20:23], v[176:179]
    s_nop 0
    ds_read_b128 a[224:227], v2 offset:24576
    ds_read_b128 a[228:231], v2 offset:25600
    v_mfma_f32_16x16x32_bf16 v[176:179], a[192:195], v[16:19], v[176:179]
    s_waitcnt lgkmcnt(7)
    ds_read_b128 a[232:235], v2 offset:26624
    ds_read_b128 a[236:239], v2 offset:27648
    v_mfma_f32_16x16x32_bf16 v[180:183], a[200:203], v[16:19], v[180:183]
    s_waitcnt lgkmcnt(8)
    global_load_lds_dwordx4 v4, s[62:63] offset:2048 sc1
    v_mfma_f32_16x16x32_bf16 v[180:183], a[204:207], v[20:23], v[180:183]
    s_nop 0
    ds_read_b128 a[240:243], v2 offset:28672
    ds_read_b128 a[244:247], v2 offset:29696
    v_mfma_f32_16x16x32_bf16 v[212:215], a[204:207], v[36:39], v[212:215]
    v_add_f32 v153, v152, v153
    v_add_f32 v152, v154, v155
    v_mov_b32 v154, v153
    v_mfma_f32_16x16x32_bf16 v[212:215], a[200:203], v[32:35], v[212:215]
    s_waitcnt lgkmcnt(9)
    v_mov_b32 v155, v152
    v_add_f32 v157, v156, v157
    v_mfma_f32_16x16x32_bf16 v[216:219], a[208:211], v[32:35], v[216:219]
    s_waitcnt lgkmcnt(8)
    global_load_lds_dwordx4 v4, s[62:63] offset:3072 sc1
    v_add_f32 v156, v158, v159
    v_mov_b32 v158, v157
    v_mfma_f32_16x16x32_bf16 v[216:219], a[212:215], v[36:39], v[216:219]
    v_mov_b32 v159, v156
    v_permlane16_swap_b32 v153, v154
    v_mfma_f32_16x16x32_bf16 v[184:187], a[212:215], v[20:23], v[184:187]
    v_permlane16_swap_b32 v152, v155
    v_permlane16_swap_b32 v157, v158
    v_mfma_f32_16x16x32_bf16 v[184:187], a[208:211], v[16:19], v[184:187]
    s_waitcnt lgkmcnt(7)
    v_permlane16_swap_b32 v156, v159
    v_add_f32 v152, v152, v155
    v_mfma_f32_16x16x32_bf16 v[188:191], a[216:219], v[16:19], v[188:191]
    s_waitcnt lgkmcnt(6)
    v_add_f32 v154, v153, v154
    v_add_f32 v156, v156, v159
    v_mfma_f32_16x16x32_bf16 v[188:191], a[220:223], v[20:23], v[188:191]
    v_add_f32 v158, v157, v158
    v_rcp_f32 v153, v152
    v_mfma_f32_16x16x32_bf16 v[220:223], a[220:223], v[36:39], v[220:223]
    v_rcp_f32 v157, v156
    v_mfma_f32_16x16x32_bf16 v[220:223], a[216:219], v[32:35], v[220:223]
    s_waitcnt lgkmcnt(5)
    v_cmp_ge_f32 s[64:65], s20, v152
    v_cmp_le_f32 s[66:67], s21, v152
    v_mfma_f32_16x16x32_bf16 v[224:227], a[224:227], v[32:35], v[224:227]
    s_waitcnt lgkmcnt(4)
    v_mul_f32 v154, -v154, v153
    v_cmp_ge_f32 s[68:69], s20, v156
    v_mfma_f32_16x16x32_bf16 v[224:227], a[228:231], v[36:39], v[224:227]
    v_cmp_le_f32 s[70:71], s21, v156
    v_mul_f32 v158, -v158, v157
    v_mfma_f32_16x16x32_bf16 v[192:195], a[228:231], v[20:23], v[192:195]
    v_fma_f32 v176, v176, v153, v154
    v_fma_f32 v180, v180, v153, v154
    v_mfma_f32_16x16x32_bf16 v[192:195], a[224:227], v[16:19], v[192:195]
    s_waitcnt lgkmcnt(3)
    v_fma_f32 v177, v177, v153, v154
    v_fma_f32 v181, v181, v153, v154
    v_mfma_f32_16x16x32_bf16 v[196:199], a[232:235], v[16:19], v[196:199]
    s_waitcnt lgkmcnt(2)
    ds_read_b128 a[248:251], v2 offset:30720
    v_fma_f32 v178, v178, v153, v154
    v_fma_f32 v182, v182, v153, v154
    v_mfma_f32_16x16x32_bf16 v[196:199], a[236:239], v[20:23], v[196:199]
    ds_read_b128 a[252:255], v2 offset:31744
    v_fma_f32 v179, v179, v153, v154
    v_fma_f32 v183, v183, v153, v154
    v_mfma_f32_16x16x32_bf16 v[228:231], a[236:239], v[36:39], v[228:231]
    v_cvt_pk_bf16_f32 v176, v176, v180
    v_cvt_pk_bf16_f32 v177, v177, v181
    v_mfma_f32_16x16x32_bf16 v[228:231], a[232:235], v[32:35], v[228:231]
    s_waitcnt lgkmcnt(3)
    v_cvt_pk_bf16_f32 v178, v178, v182
    v_cvt_pk_bf16_f32 v179, v179, v183
    v_mfma_f32_16x16x32_bf16 v[232:235], a[240:243], v[32:35], v[232:235]
    s_waitcnt lgkmcnt(2)
    global_store_dwordx4 v1, v[176:179], s[12:13] offset:-4096 sc1
    ds_read_b128 v[148:151], v174 offset:7488
    v_mfma_f32_16x16x32_bf16 v[232:235], a[244:247], v[36:39], v[232:235]
    s_nop 0
    ds_read_b128 a[152:155], v2 offset:6144
    ds_read_b128 a[156:159], v2 offset:7168
    v_mfma_f32_16x16x32_bf16 v[200:203], a[244:247], v[20:23], v[200:203]
    s_nop 0
    ds_read_b128 a[160:163], v2 offset:8192
    ds_read_b128 v[144:147], v174 offset:7552
    v_mfma_f32_16x16x32_bf16 v[200:203], a[240:243], v[16:19], v[200:203]
    s_waitcnt lgkmcnt(6)
    ds_read_b128 a[164:167], v2 offset:9216
    v_fma_f32 v208, v208, v157, v158
    v_mfma_f32_16x16x32_bf16 v[204:207], a[248:251], v[16:19], v[204:207]
    s_waitcnt lgkmcnt(6)
    ds_read_b128 a[168:171], v2 offset:10240
    v_fma_f32 v212, v212, v157, v158
    v_mfma_f32_16x16x32_bf16 v[204:207], a[252:255], v[20:23], v[204:207]
    ds_read_b128 a[172:175], v2 offset:11264
    v_fma_f32 v209, v209, v157, v158
    v_mfma_f32_16x16x32_bf16 v[236:239], a[252:255], v[36:39], v[236:239]
    v_fma_f32 v213, v213, v157, v158
    v_fma_f32 v210, v210, v157, v158
    v_mfma_f32_16x16x32_bf16 v[236:239], a[248:251], v[32:35], v[236:239]
    s_waitcnt lgkmcnt(7)
    v_fma_f32 v214, v214, v157, v158
    v_fma_f32 v211, v211, v157, v158
    v_mfma_f32_16x16x32_bf16 v[132:135], a[144:147], a[112:115], v[148:151]
    v_fma_f32 v215, v215, v157, v158
    v_cvt_pk_bf16_f32 v208, v208, v212
    v_mfma_f32_16x16x32_bf16 v[132:135], a[148:151], a[116:119], v[132:135]
    s_waitcnt lgkmcnt(6)
    v_cvt_pk_bf16_f32 v209, v209, v213
    v_cvt_pk_bf16_f32 v210, v210, v214
    v_mfma_f32_16x16x32_bf16 v[132:135], a[152:155], a[120:123], v[132:135]
    s_waitcnt lgkmcnt(5)
    ds_read_b128 a[176:179], v2 offset:12288
    v_cvt_pk_bf16_f32 v211, v211, v215
    v_mfma_f32_16x16x32_bf16 v[132:135], a[156:159], a[124:127], v[132:135]
    global_store_dwordx4 v1, v[208:211], s[12:13] offset:0 sc1
    v_mfma_f32_16x16x32_bf16 v[116:119], a[156:159], a[108:111], v[148:151]
    s_nop 0
    ds_read_b128 a[180:183], v2 offset:13312
    ds_read_b128 a[184:187], v2 offset:14336
    v_mfma_f32_16x16x32_bf16 v[116:119], a[152:155], a[104:107], v[116:119]
    s_nop 0
    ds_read_b128 v[148:151], v174 offset:7616
    ds_read_b128 a[188:191], v2 offset:15360
    v_mfma_f32_16x16x32_bf16 v[116:119], a[148:151], a[100:103], v[116:119]
    v_fma_f32 v184, v184, v153, v154
    v_fma_f32 v188, v188, v153, v154
    v_mfma_f32_16x16x32_bf16 v[116:119], a[144:147], a[96:99], v[116:119]
    s_waitcnt lgkmcnt(8)
    v_fma_f32 v185, v185, v153, v154
    v_fma_f32 v189, v189, v153, v154
    v_mfma_f32_16x16x32_bf16 v[120:123], a[160:163], a[96:99], v[144:147]
    s_waitcnt lgkmcnt(7)
    v_fma_f32 v186, v186, v153, v154
    v_fma_f32 v190, v190, v153, v154
    v_mfma_f32_16x16x32_bf16 v[120:123], a[164:167], a[100:103], v[120:123]
    s_waitcnt lgkmcnt(6)
    v_fma_f32 v187, v187, v153, v154
    v_fma_f32 v191, v191, v153, v154
    v_mfma_f32_16x16x32_bf16 v[120:123], a[168:171], a[104:107], v[120:123]
    s_waitcnt lgkmcnt(5)
    v_cvt_pk_bf16_f32 v184, v184, v188
    v_cvt_pk_bf16_f32 v185, v185, v189
    v_mfma_f32_16x16x32_bf16 v[120:123], a[172:175], a[108:111], v[120:123]
    v_cvt_pk_bf16_f32 v186, v186, v190
    v_cvt_pk_bf16_f32 v187, v187, v191
    v_mfma_f32_16x16x32_bf16 v[136:139], a[172:175], a[124:127], v[144:147]
    global_store_dwordx4 v1, v[184:187], s[12:13] offset:-4032 sc1
    v_mfma_f32_16x16x32_bf16 v[136:139], a[168:171], a[120:123], v[136:139]
    v_fma_f32 v216, v216, v157, v158
    v_fma_f32 v220, v220, v157, v158
    v_mfma_f32_16x16x32_bf16 v[136:139], a[164:167], a[116:119], v[136:139]
    v_fma_f32 v217, v217, v157, v158
    v_fma_f32 v221, v221, v157, v158
    v_mfma_f32_16x16x32_bf16 v[136:139], a[160:163], a[112:115], v[136:139]
    s_waitcnt lgkmcnt(1)
    v_fma_f32 v218, v218, v157, v158
    v_fma_f32 v222, v222, v157, v158
    v_mfma_f32_16x16x32_bf16 v[140:143], a[176:179], a[112:115], v[148:151]
    v_fma_f32 v219, v219, v157, v158
    v_fma_f32 v223, v223, v157, v158
    v_mfma_f32_16x16x32_bf16 v[140:143], a[180:183], a[116:119], v[140:143]
    v_cvt_pk_bf16_f32 v216, v216, v220
    v_cvt_pk_bf16_f32 v217, v217, v221
    v_mfma_f32_16x16x32_bf16 v[140:143], a[184:187], a[120:123], v[140:143]
    s_waitcnt lgkmcnt(0)
    v_cvt_pk_bf16_f32 v218, v218, v222
    v_cvt_pk_bf16_f32 v219, v219, v223
    v_mfma_f32_16x16x32_bf16 v[140:143], a[188:191], a[124:127], v[140:143]
    global_store_dwordx4 v1, v[216:219], s[12:13] offset:64 sc1
    v_mfma_f32_16x16x32_bf16 v[124:127], a[188:191], a[108:111], v[148:151]
    v_fma_f32 v192, v192, v153, v154
    v_fma_f32 v196, v196, v153, v154
    v_mfma_f32_16x16x32_bf16 v[124:127], a[184:187], a[104:107], v[124:127]
    v_exp_f32 v112, v112
    v_mfma_f32_16x16x32_bf16 v[124:127], a[180:183], a[100:103], v[124:127]
    v_fma_f32 v193, v193, v153, v154
    v_fma_f32 v197, v197, v153, v154
    v_mfma_f32_16x16x32_bf16 v[124:127], a[176:179], a[96:99], v[124:127]
    v_exp_f32 v113, v113
    v_mfma_f32_16x16x32_bf16 a[0:3], a[192:195], v[48:51], a[0:3]
    v_fma_f32 v194, v194, v153, v154
    v_fma_f32 v198, v198, v153, v154
    v_mfma_f32_16x16x32_bf16 a[0:3], a[196:199], v[52:55], a[0:3]
    v_exp_f32 v114, v114
    v_mfma_f32_16x16x32_bf16 a[32:35], a[196:199], v[68:71], a[32:35]
    v_fma_f32 v195, v195, v153, v154
    v_fma_f32 v199, v199, v153, v154
    v_mfma_f32_16x16x32_bf16 a[32:35], a[192:195], v[64:67], a[32:35]
    v_exp_f32 v115, v115
    v_mfma_f32_16x16x32_bf16 a[36:39], a[200:203], v[64:67], a[36:39]
    v_cvt_pk_bf16_f32 v192, v192, v196
    v_cvt_pk_bf16_f32 v193, v193, v197
    v_mfma_f32_16x16x32_bf16 a[36:39], a[204:207], v[68:71], a[36:39]
    v_exp_f32 v128, v128
    v_mfma_f32_16x16x32_bf16 a[4:7], a[204:207], v[52:55], a[4:7]
    v_cvt_pk_bf16_f32 v194, v194, v198
    v_cvt_pk_bf16_f32 v195, v195, v199
    v_mfma_f32_16x16x32_bf16 a[4:7], a[200:203], v[48:51], a[4:7]
    v_exp_f32 v129, v129
    v_mfma_f32_16x16x32_bf16 a[8:11], a[208:211], v[48:51], a[8:11]
    global_store_dwordx4 v1, v[192:195], s[12:13] offset:-3968 sc1
    v_mfma_f32_16x16x32_bf16 a[8:11], a[212:215], v[52:55], a[8:11]
    v_exp_f32 v130, v130
    v_mfma_f32_16x16x32_bf16 a[40:43], a[212:215], v[68:71], a[40:43]
    v_exp_f32 v131, v131
    v_mfma_f32_16x16x32_bf16 a[40:43], a[208:211], v[64:67], a[40:43]
    v_exp_f32 v132, v132
    v_mfma_f32_16x16x32_bf16 a[44:47], a[216:219], v[64:67], a[44:47]
    v_exp_f32 v133, v133
    v_mfma_f32_16x16x32_bf16 a[44:47], a[220:223], v[68:71], a[44:47]
    v_exp_f32 v134, v134
    v_mfma_f32_16x16x32_bf16 a[12:15], a[220:223], v[52:55], a[12:15]
    ds_read_b128 v[144:147], v174 offset:7680
    v_fma_f32 v224, v224, v157, v158
    v_mfma_f32_16x16x32_bf16 a[12:15], a[216:219], v[48:51], a[12:15]
    v_exp_f32 v135, v135
    v_mfma_f32_16x16x32_bf16 a[16:19], a[224:227], v[48:51], a[16:19]
    s_add_u32 m0, s60, 114688
    v_exp_f32 v116, v116
    v_mfma_f32_16x16x32_bf16 a[16:19], a[228:231], v[52:55], a[16:19]
    s_waitcnt vmcnt(13)
    v_exp_f32 v117, v117
    v_mfma_f32_16x16x32_bf16 a[48:51], a[228:231], v[68:71], a[48:51]
    s_barrier
    v_mfma_f32_16x16x32_bf16 a[48:51], a[224:227], v[64:67], a[48:51]
    s_add_u32 s62, s8, 1032192
    ds_read_b128 a[128:131], v2 offset:32768
    ds_read_b128 a[132:135], v2 offset:33792
    v_mfma_f32_16x16x32_bf16 a[52:55], a[232:235], v[64:67], a[52:55]
    s_addc_u32 s63, s9, 0
    ds_read_b128 a[136:139], v2 offset:34816
    ds_read_b128 a[140:143], v2 offset:35840
    v_mfma_f32_16x16x32_bf16 a[52:55], a[236:239], v[68:71], a[52:55]
    global_load_lds_dwordx4 v4, s[62:63] offset:0 sc1
    v_mfma_f32_16x16x32_bf16 a[20:23], a[236:239], v[52:55], a[20:23]
    s_nop 0
    ds_read_b128 a[144:147], v2 offset:36864
    ds_read_b128 v[148:151], v174 offset:7744
    v_mfma_f32_16x16x32_bf16 a[20:23], a[232:235], v[48:51], a[20:23]
    ds_read_b128 a[148:151], v2 offset:37888
    v_fma_f32 v228, v228, v157, v158
    v_mfma_f32_16x16x32_bf16 a[24:27], a[240:243], v[48:51], a[24:27]
    ds_read_b128 a[152:155], v2 offset:38912
    v_fma_f32 v225, v225, v157, v158
    v_mfma_f32_16x16x32_bf16 a[24:27], a[244:247], v[52:55], a[24:27]
    global_load_lds_dwordx4 v4, s[62:63] offset:1024 sc1
    v_mfma_f32_16x16x32_bf16 a[56:59], a[244:247], v[68:71], a[56:59]
    ds_read_b128 a[156:159], v2 offset:39936
    v_fma_f32 v229, v229, v157, v158
    v_mfma_f32_16x16x32_bf16 a[56:59], a[240:243], v[64:67], a[56:59]
    v_exp_f32 v118, v118
    v_mfma_f32_16x16x32_bf16 a[60:63], a[248:251], v[64:67], a[60:63]
    v_exp_f32 v119, v119
    v_mfma_f32_16x16x32_bf16 a[60:63], a[252:255], v[68:71], a[60:63]
    global_load_lds_dwordx4 v4, s[62:63] offset:2048 sc1
    v_mfma_f32_16x16x32_bf16 a[28:31], a[252:255], v[52:55], a[28:31]
    ds_read_b128 a[160:163], v2 offset:40960
    v_fma_f32 v226, v226, v157, v158
    v_mfma_f32_16x16x32_bf16 a[28:31], a[248:251], v[48:51], a[28:31]
    ds_read_b128 a[164:167], v2 offset:41984
    v_fma_f32 v230, v230, v157, v158
    v_smfmac_f32_16x16x64_bf16 v[160:163], v[168:171], v[48:55], v172
    ds_read_b128 a[168:171], v2 offset:43008
    v_smfmac_f32_16x16x64_bf16 v[164:167], v[168:171], v[64:71], v172
    s_waitcnt lgkmcnt(11)
    ds_read_b128 a[172:175], v2 offset:44032
    v_mfma_f32_16x16x32_bf16 v[48:51], a[128:131], a[96:99], v[144:147]
    s_waitcnt lgkmcnt(11)
    global_load_lds_dwordx4 v4, s[62:63] offset:3072 sc1
    v_mfma_f32_16x16x32_bf16 v[48:51], a[132:135], a[100:103], v[48:51]
    s_waitcnt lgkmcnt(10)
    v_exp_f32 v120, v120
    v_mfma_f32_16x16x32_bf16 v[48:51], a[136:139], a[104:107], v[48:51]
    s_waitcnt lgkmcnt(9)
    v_exp_f32 v121, v121
    v_mfma_f32_16x16x32_bf16 v[48:51], a[140:143], a[108:111], v[48:51]
    v_exp_f32 v122, v122
    v_mfma_f32_16x16x32_bf16 v[64:67], a[140:143], a[124:127], v[144:147]
    ds_read_b128 a[176:179], v2 offset:45056
    v_fma_f32 v227, v227, v157, v158
    v_mfma_f32_16x16x32_bf16 v[64:67], a[136:139], a[120:123], v[64:67]
    s_nop 0
    ds_read_b128 v[144:147], v174 offset:7808
    ds_read_b128 a[180:183], v2 offset:46080
    v_mfma_f32_16x16x32_bf16 v[64:67], a[132:135], a[116:119], v[64:67]
    v_exp_f32 v123, v123
    v_mfma_f32_16x16x32_bf16 v[64:67], a[128:131], a[112:115], v[64:67]
    s_waitcnt lgkmcnt(10)
    ds_read_b128 a[184:187], v2 offset:47104
    ds_read_b128 a[188:191], v2 offset:48128
    v_mfma_f32_16x16x32_bf16 v[68:71], a[144:147], a[112:115], v[148:151]
    s_waitcnt lgkmcnt(11)
    v_exp_f32 v136, v136
    v_mfma_f32_16x16x32_bf16 v[68:71], a[148:151], a[116:119], v[68:71]
    s_waitcnt lgkmcnt(10)
    v_fma_f32 v231, v231, v157, v158
    v_cvt_pk_bf16_f32 v224, v224, v228
    v_mfma_f32_16x16x32_bf16 v[68:71], a[152:155], a[120:123], v[68:71]
    s_waitcnt lgkmcnt(9)
    v_exp_f32 v137, v137
    v_mfma_f32_16x16x32_bf16 v[68:71], a[156:159], a[124:127], v[68:71]
    v_cvt_pk_bf16_f32 v225, v225, v229
    v_cvt_pk_bf16_f32 v226, v226, v230
    v_mfma_f32_16x16x32_bf16 v[52:55], a[156:159], a[108:111], v[148:151]
    v_exp_f32 v138, v138
    v_mfma_f32_16x16x32_bf16 v[52:55], a[152:155], a[104:107], v[52:55]
    ds_read_b128 v[148:151], v174 offset:7872
    v_cvt_pk_bf16_f32 v227, v227, v231
    v_mfma_f32_16x16x32_bf16 v[52:55], a[148:151], a[100:103], v[52:55]
    v_exp_f32 v139, v139
    v_mfma_f32_16x16x32_bf16 v[52:55], a[144:147], a[96:99], v[52:55]
    s_waitcnt lgkmcnt(4)
    global_store_dwordx4 v1, v[224:227], s[12:13] offset:128 sc1
    v_mfma_f32_16x16x32_bf16 v[56:59], a[160:163], a[96:99], v[144:147]
    v_exp_f32 v140, v140
    v_mfma_f32_16x16x32_bf16 v[56:59], a[164:167], a[100:103], v[56:59]
    v_cvt_pk_bf16_f32 v112, v112, v113
    v_cvt_pk_bf16_f32 v113, v114, v115
    v_mfma_f32_16x16x32_bf16 v[56:59], a[168:171], a[104:107], v[56:59]
    v_exp_f32 v141, v141
    v_mfma_f32_16x16x32_bf16 v[56:59], a[172:175], a[108:111], v[56:59]
    ds_read_b128 a[128:131], v2 offset:49152
    v_cvt_pk_bf16_f32 v128, v128, v129
    v_mfma_f32_16x16x32_bf16 v[72:75], a[172:175], a[124:127], v[144:147]
    ds_read_b128 a[132:135], v2 offset:50176
    v_cvt_pk_bf16_f32 v129, v130, v131
    v_mfma_f32_16x16x32_bf16 v[72:75], a[168:171], a[120:123], v[72:75]
    v_exp_f32 v142, v142
    v_mfma_f32_16x16x32_bf16 v[72:75], a[164:167], a[116:119], v[72:75]
    v_cvt_pk_bf16_f32 v130, v132, v133
    v_cvt_pk_bf16_f32 v131, v134, v135
    v_mfma_f32_16x16x32_bf16 v[72:75], a[160:163], a[112:115], v[72:75]
    s_waitcnt lgkmcnt(2)
    v_exp_f32 v143, v143
    v_mfma_f32_16x16x32_bf16 v[76:79], a[176:179], a[112:115], v[148:151]
    v_cvt_pk_bf16_f32 v114, v116, v117
    v_cvt_pk_bf16_f32 v115, v118, v119
    v_mfma_f32_16x16x32_bf16 v[76:79], a[180:183], a[116:119], v[76:79]
    v_exp_f32 v124, v124
    v_mfma_f32_16x16x32_bf16 v[76:79], a[184:187], a[120:123], v[76:79]
    v_cvt_pk_bf16_f32 v116, v120, v121
    v_cvt_pk_bf16_f32 v117, v122, v123
    v_mfma_f32_16x16x32_bf16 v[76:79], a[188:191], a[124:127], v[76:79]
    v_exp_f32 v125, v125
    v_mfma_f32_16x16x32_bf16 v[60:63], a[188:191], a[108:111], v[148:151]
    ds_read_b128 a[136:139], v2 offset:51200
    v_cvt_pk_bf16_f32 v132, v136, v137
    v_mfma_f32_16x16x32_bf16 v[60:63], a[184:187], a[104:107], v[60:63]
    ds_read_b128 a[140:143], v2 offset:52224
    v_cvt_pk_bf16_f32 v133, v138, v139
    v_mfma_f32_16x16x32_bf16 v[60:63], a[180:183], a[100:103], v[60:63]
    v_exp_f32 v126, v126
    v_exp_f32 v127, v127
    v_mfma_f32_16x16x32_bf16 v[60:63], a[176:179], a[96:99], v[60:63]
    s_waitcnt lgkmcnt(3)
    v_cvt_pk_bf16_f32 v134, v140, v141
    v_cvt_pk_bf16_f32 v135, v142, v143
    v_cvt_pk_bf16_f32 v118, v124, v125
    v_cvt_pk_bf16_f32 v119, v126, v127
    v_mfma_f32_16x16x32_bf16 a[0:3], a[128:131], v[112:115], a[0:3]
    s_waitcnt lgkmcnt(2)
    ds_read_b128 a[144:147], v2 offset:53248
    ds_read_b128 a[148:151], v2 offset:54272
    v_mfma_f32_16x16x32_bf16 a[0:3], a[132:135], v[116:119], a[0:3]
    v_fma_f32 v200, v200, v153, v154
    v_fma_f32 v204, v204, v153, v154
    v_mfma_f32_16x16x32_bf16 a[32:35], a[132:135], v[132:135], a[32:35]
    v_fma_f32 v201, v201, v153, v154
    v_fma_f32 v205, v205, v153, v154
    v_mfma_f32_16x16x32_bf16 a[32:35], a[128:131], v[128:131], a[32:35]
    s_waitcnt lgkmcnt(3)
    ds_read_b128 a[152:155], v2 offset:55296
    v_fma_f32 v202, v202, v153, v154
    v_mfma_f32_16x16x32_bf16 a[36:39], a[136:139], v[128:131], a[36:39]
    s_waitcnt lgkmcnt(3)
    v_fma_f32 v206, v206, v153, v154
    v_fma_f32 v203, v203, v153, v154
    v_mfma_f32_16x16x32_bf16 a[36:39], a[140:143], v[132:135], a[36:39]
    ds_read_b128 a[156:159], v2 offset:56320
    v_fma_f32 v207, v207, v153, v154
    v_mfma_f32_16x16x32_bf16 a[4:7], a[140:143], v[116:119], a[4:7]
    v_cvt_pk_bf16_f32 v200, v200, v204
    v_cvt_pk_bf16_f32 v201, v201, v205
    v_mfma_f32_16x16x32_bf16 a[4:7], a[136:139], v[112:115], a[4:7]
    s_waitcnt lgkmcnt(3)
    v_cvt_pk_bf16_f32 v202, v202, v206
    v_cvt_pk_bf16_f32 v203, v203, v207
    v_mfma_f32_16x16x32_bf16 a[8:11], a[144:147], v[112:115], a[8:11]
    s_waitcnt lgkmcnt(2)
    global_store_dwordx4 v1, v[200:203], s[12:13] offset:-3904 sc1
    ds_read_b128 a[160:163], v2 offset:57344
    v_mfma_f32_16x16x32_bf16 a[8:11], a[148:151], v[116:119], a[8:11]
    s_nop 0
    ds_read_b128 a[164:167], v2 offset:58368
    ds_read_b128 a[168:171], v2 offset:59392
    v_mfma_f32_16x16x32_bf16 a[40:43], a[148:151], v[132:135], a[40:43]
    s_nop 0
    ds_read_b128 a[172:175], v2 offset:60416
    ds_read_b128 a[176:179], v2 offset:61440
    v_mfma_f32_16x16x32_bf16 a[40:43], a[144:147], v[128:131], a[40:43]
    s_waitcnt lgkmcnt(6)
    ds_read_b128 a[180:183], v2 offset:62464
    v_fma_f32 v232, v232, v157, v158
    v_mfma_f32_16x16x32_bf16 a[44:47], a[152:155], v[128:131], a[44:47]
    s_waitcnt lgkmcnt(6)
    ds_read_b128 a[184:187], v2 offset:63488
    v_fma_f32 v236, v236, v157, v158
    v_mfma_f32_16x16x32_bf16 a[44:47], a[156:159], v[132:135], a[44:47]
    ds_read_b128 a[188:191], v2 offset:64512
    v_fma_f32 v233, v233, v157, v158
    v_mfma_f32_16x16x32_bf16 a[12:15], a[156:159], v[116:119], a[12:15]
    v_fma_f32 v237, v237, v157, v158
    v_fma_f32 v234, v234, v157, v158
    v_mfma_f32_16x16x32_bf16 a[12:15], a[152:155], v[112:115], a[12:15]
    s_waitcnt lgkmcnt(7)
    v_fma_f32 v238, v238, v157, v158
    v_fma_f32 v235, v235, v157, v158
    v_mfma_f32_16x16x32_bf16 a[16:19], a[160:163], v[112:115], a[16:19]
    s_waitcnt lgkmcnt(6)
    v_fma_f32 v239, v239, v157, v158
    v_cvt_pk_bf16_f32 v232, v232, v236
    v_mfma_f32_16x16x32_bf16 a[16:19], a[164:167], v[116:119], a[16:19]
    ds_read_b128 v[168:171], v175 offset:14848
    v_cvt_pk_bf16_f32 v233, v233, v237
    v_mfma_f32_16x16x32_bf16 a[48:51], a[164:167], v[132:135], a[48:51]
    s_waitcnt vmcnt(11)
    v_cvt_pk_bf16_f32 v234, v234, v238
    v_cvt_pk_bf16_f32 v235, v235, v239
    v_mfma_f32_16x16x32_bf16 a[48:51], a[160:163], v[128:131], a[48:51]
    s_waitcnt lgkmcnt(6)
    s_barrier
    v_mfma_f32_16x16x32_bf16 a[52:55], a[168:171], v[128:131], a[52:55]
    s_waitcnt lgkmcnt(5)
    global_store_dwordx4 v1, v[232:235], s[12:13] offset:192 sc1
    v_mfma_f32_16x16x32_bf16 a[52:55], a[172:175], v[132:135], a[52:55]
    s_nop 0
    ds_read_b128 a[128:131], v173 offset:0
    ds_read_b128 v[240:243], v174 offset:7936
    v_mfma_f32_16x16x32_bf16 a[20:23], a[172:175], v[116:119], a[20:23]
    s_nop 0
    ds_read_b128 a[132:135], v173 offset:1024
    ds_read_b128 a[136:139], v173 offset:2048
    v_mfma_f32_16x16x32_bf16 a[20:23], a[168:171], v[112:115], a[20:23]
    s_waitcnt lgkmcnt(8)
    ds_read_b128 a[140:143], v173 offset:3072
    ds_read_b128 a[156:159], v173 offset:7168
    v_mfma_f32_16x16x32_bf16 a[24:27], a[176:179], v[112:115], a[24:27]
    s_waitcnt lgkmcnt(9)
    ds_read_b128 v[244:247], v174 offset:8000
    ds_read_b128 a[152:155], v173 offset:6144
    v_mfma_f32_16x16x32_bf16 a[24:27], a[180:183], v[116:119], a[24:27]
    s_nop 0
    ds_read_b128 a[148:151], v173 offset:5120
    ds_read_b128 a[144:147], v173 offset:4096
    v_mfma_f32_16x16x32_bf16 a[56:59], a[180:183], v[132:135], a[56:59]
    s_nop 0
    ds_read_b128 a[160:163], v173 offset:8192
    ds_read_b128 v[248:251], v174 offset:8064
    v_mfma_f32_16x16x32_bf16 a[56:59], a[176:179], v[128:131], a[56:59]
    s_waitcnt lgkmcnt(10)
    ds_read_b128 a[164:167], v173 offset:9216
    ds_read_b128 a[168:171], v173 offset:10240
    v_mfma_f32_16x16x32_bf16 a[60:63], a[184:187], v[128:131], a[60:63]
    v_exp_f32 v48, v48
    v_mfma_f32_16x16x32_bf16 a[60:63], a[188:191], v[132:135], a[60:63]
    s_nop 0
    ds_read_b128 a[172:175], v173 offset:11264
    ds_read_b128 v[252:255], v174 offset:8128
    v_mfma_f32_16x16x32_bf16 a[28:31], a[188:191], v[116:119], a[28:31]
    v_exp_f32 v49, v49
    v_mfma_f32_16x16x32_bf16 a[28:31], a[184:187], v[112:115], a[28:31]
    ds_read_b128 a[188:191], v173 offset:15360
    v_cvt_pk_bf16_f32 v48, v48, v49
    v_smfmac_f32_16x16x64_bf16 v[160:163], v[168:171], v[112:119], v172
    s_waitcnt lgkmcnt(10)
    ds_read_b128 a[184:187], v173 offset:14336
    v_smfmac_f32_16x16x64_bf16 v[164:167], v[168:171], v[128:135], v172
    ds_read_b128 a[180:183], v173 offset:13312
    v_mfma_f32_16x16x32_bf16 v[112:115], a[128:131], a[96:99], v[240:243]
    v_exp_f32 v50, v50
    v_mfma_f32_16x16x32_bf16 v[112:115], a[132:135], a[100:103], v[112:115]
    v_exp_f32 v51, v51
    v_mfma_f32_16x16x32_bf16 v[112:115], a[136:139], a[104:107], v[112:115]
    v_exp_f32 v52, v52
    v_mfma_f32_16x16x32_bf16 v[112:115], a[140:143], a[108:111], v[112:115]
    ds_read_b128 a[176:179], v173 offset:12288
    v_cvt_pk_bf16_f32 v49, v50, v51
    v_mfma_f32_16x16x32_bf16 v[116:119], a[156:159], a[108:111], v[244:247]
    s_waitcnt lgkmcnt(12)
    v_exp_f32 v53, v53
    v_mfma_f32_16x16x32_bf16 v[116:119], a[152:155], a[104:107], v[116:119]
    s_waitcnt lgkmcnt(11)
    v_exp_f32 v54, v54
    v_mfma_f32_16x16x32_bf16 v[116:119], a[148:151], a[100:103], v[116:119]
    s_waitcnt lgkmcnt(10)
    v_exp_f32 v55, v55
    v_mfma_f32_16x16x32_bf16 v[116:119], a[144:147], a[96:99], v[116:119]
    s_waitcnt lgkmcnt(8)
    v_exp_f32 v56, v56
    v_mfma_f32_16x16x32_bf16 v[120:123], a[160:163], a[96:99], v[248:251]
    s_waitcnt lgkmcnt(7)
    v_exp_f32 v57, v57
    v_mfma_f32_16x16x32_bf16 v[120:123], a[164:167], a[100:103], v[120:123]
    s_waitcnt lgkmcnt(6)
    v_exp_f32 v58, v58
    v_mfma_f32_16x16x32_bf16 v[120:123], a[168:171], a[104:107], v[120:123]
    s_waitcnt lgkmcnt(5)
    v_exp_f32 v59, v59
    v_mfma_f32_16x16x32_bf16 v[120:123], a[172:175], a[108:111], v[120:123]
    s_waitcnt lgkmcnt(3)
    v_exp_f32 v60, v60
    v_mfma_f32_16x16x32_bf16 v[124:127], a[188:191], a[108:111], v[252:255]
    s_waitcnt lgkmcnt(2)
    v_exp_f32 v61, v61
    v_mfma_f32_16x16x32_bf16 v[124:127], a[184:187], a[104:107], v[124:127]
    s_waitcnt lgkmcnt(1)
    v_exp_f32 v62, v62
    v_mfma_f32_16x16x32_bf16 v[124:127], a[180:183], a[100:103], v[124:127]
    s_waitcnt lgkmcnt(0)
    v_exp_f32 v63, v63
    v_mfma_f32_16x16x32_bf16 v[124:127], a[176:179], a[96:99], v[124:127]
    v_exp_f32 v112, v112
    v_mfma_f32_16x16x32_bf16 v[128:131], a[128:131], a[112:115], v[240:243]
    v_exp_f32 v113, v113
    v_mfma_f32_16x16x32_bf16 v[128:131], a[132:135], a[116:119], v[128:131]
    v_exp_f32 v114, v114
    v_mfma_f32_16x16x32_bf16 v[128:131], a[136:139], a[120:123], v[128:131]
    v_exp_f32 v115, v115
    v_mfma_f32_16x16x32_bf16 v[128:131], a[140:143], a[124:127], v[128:131]
    v_exp_f32 v116, v116
    v_mfma_f32_16x16x32_bf16 v[132:135], a[156:159], a[124:127], v[244:247]
    v_exp_f32 v117, v117
    v_mfma_f32_16x16x32_bf16 v[132:135], a[152:155], a[120:123], v[132:135]
    s_nop 0
    ds_read_b128 v[168:171], v175 offset:15360
    ds_read_b128 a[128:131], v173 offset:16384
    v_mfma_f32_16x16x32_bf16 v[132:135], a[148:151], a[116:119], v[132:135]
    v_exp_f32 v118, v118
    v_mfma_f32_16x16x32_bf16 v[132:135], a[144:147], a[112:115], v[132:135]
    v_exp_f32 v119, v119
    v_mfma_f32_16x16x32_bf16 v[136:139], a[160:163], a[112:115], v[248:251]
    s_nop 0
    ds_read_b128 a[132:135], v173 offset:17408
    ds_read_b128 a[140:143], v173 offset:19456
    v_mfma_f32_16x16x32_bf16 v[136:139], a[164:167], a[116:119], v[136:139]
    v_exp_f32 v120, v120
    v_mfma_f32_16x16x32_bf16 v[136:139], a[168:171], a[120:123], v[136:139]
    v_cvt_pk_bf16_f32 v50, v52, v53
    v_cvt_pk_bf16_f32 v51, v54, v55
    v_mfma_f32_16x16x32_bf16 v[136:139], a[172:175], a[124:127], v[136:139]
Lpad6:
    s_cbranch_execz Lready
    v_exp_f32 v121, v121
    v_mfma_f32_16x16x32_bf16 v[140:143], a[188:191], a[124:127], v[252:255]
    s_waitcnt vmcnt(3)
    ds_read_b128 a[136:139], v173 offset:18432
    v_cvt_pk_bf16_f32 v52, v56, v57
    v_mfma_f32_16x16x32_bf16 v[140:143], a[184:187], a[120:123], v[140:143]
    s_barrier
    ds_read_b128 v[8:11], v175 offset:15872
    v_cvt_pk_bf16_f32 v53, v58, v59
    v_mfma_f32_16x16x32_bf16 v[140:143], a[180:183], a[116:119], v[140:143]
    ds_read_b128 a[192:195], v173 offset:49152
    v_exp_f32 v122, v122
    v_cvt_pk_bf16_f32 v54, v60, v61
    v_cvt_pk_bf16_f32 v55, v62, v63
    v_mfma_f32_16x16x32_bf16 v[140:143], a[176:179], a[112:115], v[140:143]
    s_waitcnt lgkmcnt(6)
    ds_read_b128 a[196:199], v173 offset:50176
    v_exp_f32 v123, v123
    v_smfmac_f32_16x16x64_bf16 v[160:163], v[168:171], v[48:55], v172
    s_waitcnt lgkmcnt(6)
    ds_read_b128 a[204:207], v173 offset:52224
    v_exp_f32 v124, v124
    v_mfma_f32_16x16x32_bf16 a[0:3], a[128:131], v[48:51], a[0:3]
    s_waitcnt lgkmcnt(6)
    ds_read_b128 a[200:203], v173 offset:51200
    v_cvt_pk_bf16_f32 v112, v112, v113
    v_cvt_pk_bf16_f32 v113, v114, v115
    v_exp_f32 v125, v125
    v_mfma_f32_16x16x32_bf16 a[0:3], a[132:135], v[52:55], a[0:3]
    s_waitcnt lgkmcnt(6)
    ds_read_b128 a[208:211], v173 offset:53248
    v_cvt_pk_bf16_f32 v114, v116, v117
    v_cvt_pk_bf16_f32 v115, v118, v119
    v_exp_f32 v126, v126
    v_exp_f32 v127, v127
    v_mfma_f32_16x16x32_bf16 a[4:7], a[140:143], v[52:55], a[4:7]
    s_waitcnt lgkmcnt(6)
    ds_read_b128 a[212:215], v173 offset:54272
    v_cvt_pk_bf16_f32 v116, v120, v121
    v_cvt_pk_bf16_f32 v117, v122, v123
    v_cvt_pk_bf16_f32 v118, v124, v125
    v_cvt_pk_bf16_f32 v119, v126, v127
    v_mfma_f32_16x16x32_bf16 a[4:7], a[136:139], v[48:51], a[4:7]
    s_waitcnt lgkmcnt(6)
    ds_read_b128 a[144:147], v173 offset:20480
    ds_read_b128 a[148:151], v173 offset:21504
    v_smfmac_f32_16x16x64_bf16 v[160:163], v[8:11], v[112:119], v172
    s_waitcnt lgkmcnt(7)
    ds_read_b128 a[156:159], v173 offset:23552
    v_mfma_f32_16x16x32_bf16 a[0:3], a[192:195], v[112:115], a[0:3]
    s_waitcnt lgkmcnt(7)
    v_exp_f32 v64, v64
    v_mfma_f32_16x16x32_bf16 a[0:3], a[196:199], v[116:119], a[0:3]
    s_waitcnt lgkmcnt(6)
    ds_read_b128 a[152:155], v173 offset:22528
    v_exp_f32 v65, v65
    v_mfma_f32_16x16x32_bf16 a[4:7], a[204:207], v[116:119], a[4:7]
    s_waitcnt lgkmcnt(6)
    ds_read_b128 a[220:223], v173 offset:56320
    v_exp_f32 v66, v66
    v_mfma_f32_16x16x32_bf16 a[4:7], a[200:203], v[112:115], a[4:7]
    s_waitcnt lgkmcnt(6)
    ds_read_b128 a[216:219], v173 offset:55296
    v_exp_f32 v67, v67
    v_mfma_f32_16x16x32_bf16 a[8:11], a[208:211], v[112:115], a[8:11]
    s_waitcnt lgkmcnt(6)
    ds_read_b128 a[224:227], v173 offset:57344
    v_exp_f32 v68, v68
    v_mfma_f32_16x16x32_bf16 a[8:11], a[212:215], v[116:119], a[8:11]
    s_waitcnt lgkmcnt(6)
    ds_read_b128 a[228:231], v173 offset:58368
    v_exp_f32 v69, v69
    v_mfma_f32_16x16x32_bf16 a[8:11], a[144:147], v[48:51], a[8:11]
    s_waitcnt lgkmcnt(6)
    ds_read_b128 a[160:163], v173 offset:24576
    v_add_f32 v161, v160, v161
    v_add_f32 v160, v162, v163
    v_mov_b32 v162, v161
    v_mov_b32 v163, v160
    s_nop 0
    v_permlane16_swap_b32 v161, v162
    v_permlane16_swap_b32 v160, v163
    v_add_f32 v160, v160, v163
    v_add_f32 v162, v161, v162
    v_rcp_f32 v161, v160
    v_cmp_ge_f32 s[72:73], s20, v160
    v_cmp_le_f32 s[74:75], s21, v160
    v_mul_f32 v162, -v162, v161
    v_exp_f32 v70, v70
    v_mfma_f32_16x16x32_bf16 a[8:11], a[148:151], v[52:55], a[8:11]
    s_waitcnt lgkmcnt(6)
    ds_read_b128 a[164:167], v173 offset:25600
    v_exp_f32 v71, v71
    v_mfma_f32_16x16x32_bf16 a[12:15], a[156:159], v[52:55], a[12:15]
    s_waitcnt lgkmcnt(6)
    ds_read_b128 a[172:175], v173 offset:27648
    v_accvgpr_read_b32 v16, a0
    v_accvgpr_read_b32 v17, a1
    v_accvgpr_read_b32 v18, a2
    v_accvgpr_read_b32 v19, a3
    v_accvgpr_read_b32 v20, a4
    v_accvgpr_read_b32 v21, a5
    v_accvgpr_read_b32 v22, a6
    v_accvgpr_read_b32 v23, a7
    v_fma_f32 v16, v16, v161, v162
    v_fma_f32 v20, v20, v161, v162
    v_fma_f32 v17, v17, v161, v162
    v_fma_f32 v21, v21, v161, v162
    v_fma_f32 v18, v18, v161, v162
    v_fma_f32 v22, v22, v161, v162
    v_fma_f32 v19, v19, v161, v162
    v_fma_f32 v23, v23, v161, v162
    v_cvt_pk_bf16_f32 v16, v16, v20
    v_cvt_pk_bf16_f32 v17, v17, v21
    v_cvt_pk_bf16_f32 v18, v18, v22
    v_cvt_pk_bf16_f32 v19, v19, v23
    v_exp_f32 v72, v72
    v_mfma_f32_16x16x32_bf16 a[12:15], a[152:155], v[48:51], a[12:15]
    s_waitcnt lgkmcnt(6)
    global_store_dwordx4 v1, v[16:19], s[14:15] offset:-4096 sc1
    ds_read_b128 a[168:171], v173 offset:26624
    v_exp_f32 v73, v73
    v_mfma_f32_16x16x32_bf16 a[12:15], a[220:223], v[116:119], a[12:15]
    s_waitcnt lgkmcnt(6)
    ds_read_b128 a[236:239], v173 offset:60416
    v_exp_f32 v74, v74
    v_mfma_f32_16x16x32_bf16 a[12:15], a[216:219], v[112:115], a[12:15]
    s_waitcnt lgkmcnt(6)
    ds_read_b128 a[232:235], v173 offset:59392
    v_exp_f32 v75, v75
    v_mfma_f32_16x16x32_bf16 a[16:19], a[224:227], v[112:115], a[16:19]
    s_waitcnt lgkmcnt(6)
    ds_read_b128 a[240:243], v173 offset:61440
    v_exp_f32 v76, v76
    v_mfma_f32_16x16x32_bf16 a[16:19], a[228:231], v[116:119], a[16:19]
    s_waitcnt lgkmcnt(6)
    ds_read_b128 a[244:247], v173 offset:62464
    v_exp_f32 v77, v77
    v_mfma_f32_16x16x32_bf16 a[16:19], a[160:163], v[48:51], a[16:19]
    s_waitcnt lgkmcnt(6)
    ds_read_b128 a[176:179], v173 offset:28672
    v_exp_f32 v78, v78
    v_mfma_f32_16x16x32_bf16 a[16:19], a[164:167], v[52:55], a[16:19]
    s_waitcnt lgkmcnt(6)
    ds_read_b128 a[180:183], v173 offset:29696
    v_exp_f32 v79, v79
    v_mfma_f32_16x16x32_bf16 a[20:23], a[172:175], v[52:55], a[20:23]
    s_waitcnt lgkmcnt(6)
    ds_read_b128 a[188:191], v173 offset:31744
    v_accvgpr_read_b32 v24, a8
    v_accvgpr_read_b32 v25, a9
    v_accvgpr_read_b32 v26, a10
    v_accvgpr_read_b32 v27, a11
    v_accvgpr_read_b32 v28, a12
    v_accvgpr_read_b32 v29, a13
    v_accvgpr_read_b32 v30, a14
    v_accvgpr_read_b32 v31, a15
    v_fma_f32 v24, v24, v161, v162
    v_fma_f32 v28, v28, v161, v162
    v_fma_f32 v25, v25, v161, v162
    v_fma_f32 v29, v29, v161, v162
    v_fma_f32 v26, v26, v161, v162
    v_fma_f32 v30, v30, v161, v162
    v_fma_f32 v27, v27, v161, v162
    v_fma_f32 v31, v31, v161, v162
    v_cvt_pk_bf16_f32 v24, v24, v28
    v_cvt_pk_bf16_f32 v25, v25, v29
    v_cvt_pk_bf16_f32 v26, v26, v30
    v_cvt_pk_bf16_f32 v27, v27, v31
    v_exp_f32 v128, v128
    v_mfma_f32_16x16x32_bf16 a[20:23], a[168:171], v[48:51], a[20:23]
    s_waitcnt lgkmcnt(6)
    global_store_dwordx4 v1, v[24:27], s[14:15] offset:-4032 sc1
    ds_read_b128 a[184:187], v173 offset:30720
    v_exp_f32 v129, v129
    v_mfma_f32_16x16x32_bf16 a[20:23], a[236:239], v[116:119], a[20:23]
    s_waitcnt lgkmcnt(6)
    ds_read_b128 a[252:255], v173 offset:64512
    v_exp_f32 v130, v130
    v_mfma_f32_16x16x32_bf16 a[20:23], a[232:235], v[112:115], a[20:23]
    s_waitcnt lgkmcnt(6)
    ds_read_b128 a[248:251], v173 offset:63488
    v_exp_f32 v131, v131
    v_mfma_f32_16x16x32_bf16 a[24:27], a[240:243], v[112:115], a[24:27]
    s_waitcnt lgkmcnt(6)
    v_exp_f32 v132, v132
    v_mfma_f32_16x16x32_bf16 a[24:27], a[244:247], v[116:119], a[24:27]
    s_waitcnt lgkmcnt(5)
    v_exp_f32 v133, v133
    v_mfma_f32_16x16x32_bf16 a[24:27], a[176:179], v[48:51], a[24:27]
    s_waitcnt lgkmcnt(4)
    v_exp_f32 v134, v134
    v_mfma_f32_16x16x32_bf16 a[24:27], a[180:183], v[52:55], a[24:27]
    s_waitcnt lgkmcnt(3)
    v_exp_f32 v135, v135
    v_mfma_f32_16x16x32_bf16 a[28:31], a[188:191], v[52:55], a[28:31]
    s_waitcnt lgkmcnt(2)
    v_accvgpr_read_b32 v32, a16
    v_accvgpr_read_b32 v33, a17
    v_accvgpr_read_b32 v34, a18
    v_accvgpr_read_b32 v35, a19
    v_accvgpr_read_b32 v36, a20
    v_accvgpr_read_b32 v37, a21
    v_accvgpr_read_b32 v38, a22
    v_accvgpr_read_b32 v39, a23
    v_fma_f32 v32, v32, v161, v162
    v_fma_f32 v36, v36, v161, v162
    v_fma_f32 v33, v33, v161, v162
    v_fma_f32 v37, v37, v161, v162
    v_fma_f32 v34, v34, v161, v162
    v_fma_f32 v38, v38, v161, v162
    v_fma_f32 v35, v35, v161, v162
    v_fma_f32 v39, v39, v161, v162
    v_cvt_pk_bf16_f32 v32, v32, v36
    v_cvt_pk_bf16_f32 v33, v33, v37
    v_cvt_pk_bf16_f32 v34, v34, v38
    v_cvt_pk_bf16_f32 v35, v35, v39
    v_cvt_pk_bf16_f32 v64, v64, v65
    v_cvt_pk_bf16_f32 v65, v66, v67
    v_exp_f32 v136, v136
    v_mfma_f32_16x16x32_bf16 a[28:31], a[184:187], v[48:51], a[28:31]
    s_waitcnt lgkmcnt(1)
    global_store_dwordx4 v1, v[32:35], s[14:15] offset:-3968 sc1
    v_cvt_pk_bf16_f32 v66, v68, v69
    v_cvt_pk_bf16_f32 v67, v70, v71
    v_exp_f32 v137, v137
    v_mfma_f32_16x16x32_bf16 a[28:31], a[252:255], v[116:119], a[28:31]
    s_waitcnt lgkmcnt(0)
    v_cvt_pk_bf16_f32 v68, v72, v73
    v_cvt_pk_bf16_f32 v69, v74, v75
    v_exp_f32 v138, v138
    v_cvt_pk_bf16_f32 v70, v76, v77
    v_cvt_pk_bf16_f32 v71, v78, v79
    v_mfma_f32_16x16x32_bf16 a[28:31], a[248:251], v[112:115], a[28:31]
    v_exp_f32 v139, v139
    v_smfmac_f32_16x16x64_bf16 v[164:167], v[168:171], v[64:71], v172
    v_exp_f32 v140, v140
    v_mfma_f32_16x16x32_bf16 a[32:35], a[128:131], v[64:67], a[32:35]
    v_cvt_pk_bf16_f32 v128, v128, v129
    v_cvt_pk_bf16_f32 v129, v130, v131
    v_exp_f32 v141, v141
    v_mfma_f32_16x16x32_bf16 a[32:35], a[132:135], v[68:71], a[32:35]
    v_cvt_pk_bf16_f32 v130, v132, v133
    v_cvt_pk_bf16_f32 v131, v134, v135
    v_exp_f32 v142, v142
    v_exp_f32 v143, v143
    v_mfma_f32_16x16x32_bf16 a[36:39], a[140:143], v[68:71], a[36:39]
    v_cvt_pk_bf16_f32 v132, v136, v137
    v_cvt_pk_bf16_f32 v133, v138, v139
    v_cvt_pk_bf16_f32 v134, v140, v141
    v_cvt_pk_bf16_f32 v135, v142, v143
    v_mfma_f32_16x16x32_bf16 a[36:39], a[136:139], v[64:67], a[36:39]
    v_accvgpr_read_b32 v40, a24
    v_accvgpr_read_b32 v41, a25
    v_accvgpr_read_b32 v42, a26
    v_accvgpr_read_b32 v43, a27
    v_accvgpr_read_b32 v44, a28
    v_accvgpr_read_b32 v45, a29
    v_accvgpr_read_b32 v46, a30
    v_accvgpr_read_b32 v47, a31
    v_fma_f32 v40, v40, v161, v162
    v_fma_f32 v44, v44, v161, v162
    v_fma_f32 v41, v41, v161, v162
    v_fma_f32 v45, v45, v161, v162
    v_fma_f32 v42, v42, v161, v162
    v_fma_f32 v46, v46, v161, v162
    v_fma_f32 v43, v43, v161, v162
    v_fma_f32 v47, v47, v161, v162
    v_cvt_pk_bf16_f32 v40, v40, v44
    v_cvt_pk_bf16_f32 v41, v41, v45
    v_cvt_pk_bf16_f32 v42, v42, v46
    v_cvt_pk_bf16_f32 v43, v43, v47
    v_smfmac_f32_16x16x64_bf16 v[164:167], v[8:11], v[128:135], v172
    global_store_dwordx4 v1, v[40:43], s[14:15] offset:-3904 sc1
    v_mfma_f32_16x16x32_bf16 a[32:35], a[192:195], v[128:131], a[32:35]
    v_mfma_f32_16x16x32_bf16 a[32:35], a[196:199], v[132:135], a[32:35]
    v_mfma_f32_16x16x32_bf16 a[36:39], a[204:207], v[132:135], a[36:39]
    v_mfma_f32_16x16x32_bf16 a[36:39], a[200:203], v[128:131], a[36:39]
    v_mfma_f32_16x16x32_bf16 a[40:43], a[208:211], v[128:131], a[40:43]
    v_mfma_f32_16x16x32_bf16 a[40:43], a[212:215], v[132:135], a[40:43]
    v_mfma_f32_16x16x32_bf16 a[40:43], a[144:147], v[64:67], a[40:43]
    s_nop 3
    v_add_f32 v165, v164, v165
    v_add_f32 v164, v166, v167
    v_mov_b32 v166, v165
    v_mov_b32 v167, v164
    s_nop 0
    v_permlane16_swap_b32 v165, v166
    v_permlane16_swap_b32 v164, v167
    v_add_f32 v164, v164, v167
    v_add_f32 v166, v165, v166
    v_rcp_f32 v165, v164
    v_cmp_ge_f32 s[76:77], s20, v164
    v_cmp_le_f32 s[78:79], s21, v164
    v_mul_f32 v166, -v166, v165
    v_mfma_f32_16x16x32_bf16 a[40:43], a[148:151], v[68:71], a[40:43]
    v_mfma_f32_16x16x32_bf16 a[44:47], a[156:159], v[68:71], a[44:47]
    v_accvgpr_read_b32 v80, a32
    v_accvgpr_read_b32 v81, a33
    v_accvgpr_read_b32 v82, a34
    v_accvgpr_read_b32 v83, a35
    v_accvgpr_read_b32 v84, a36
    v_accvgpr_read_b32 v85, a37
    v_accvgpr_read_b32 v86, a38
    v_accvgpr_read_b32 v87, a39
    v_fma_f32 v80, v80, v165, v166
    v_fma_f32 v84, v84, v165, v166
    v_fma_f32 v81, v81, v165, v166
    v_fma_f32 v85, v85, v165, v166
    v_fma_f32 v82, v82, v165, v166
    v_fma_f32 v86, v86, v165, v166
    v_fma_f32 v83, v83, v165, v166
    v_fma_f32 v87, v87, v165, v166
    v_cvt_pk_bf16_f32 v80, v80, v84
    v_cvt_pk_bf16_f32 v81, v81, v85
    v_cvt_pk_bf16_f32 v82, v82, v86
    v_cvt_pk_bf16_f32 v83, v83, v87
    v_mfma_f32_16x16x32_bf16 a[44:47], a[152:155], v[64:67], a[44:47]
    global_store_dwordx4 v1, v[80:83], s[14:15] offset:0 sc1
    v_mfma_f32_16x16x32_bf16 a[44:47], a[220:223], v[132:135], a[44:47]
    v_mfma_f32_16x16x32_bf16 a[44:47], a[216:219], v[128:131], a[44:47]
    v_mfma_f32_16x16x32_bf16 a[48:51], a[224:227], v[128:131], a[48:51]
    v_mfma_f32_16x16x32_bf16 a[48:51], a[228:231], v[132:135], a[48:51]
    v_mfma_f32_16x16x32_bf16 a[48:51], a[160:163], v[64:67], a[48:51]
    v_mfma_f32_16x16x32_bf16 a[48:51], a[164:167], v[68:71], a[48:51]
    v_mfma_f32_16x16x32_bf16 a[52:55], a[172:175], v[68:71], a[52:55]
    v_accvgpr_read_b32 v88, a40
    v_accvgpr_read_b32 v89, a41
    v_accvgpr_read_b32 v90, a42
    v_accvgpr_read_b32 v91, a43
    v_accvgpr_read_b32 v92, a44
    v_accvgpr_read_b32 v93, a45
    v_accvgpr_read_b32 v94, a46
    v_accvgpr_read_b32 v95, a47
    v_fma_f32 v88, v88, v165, v166
    v_fma_f32 v92, v92, v165, v166
    v_fma_f32 v89, v89, v165, v166
    v_fma_f32 v93, v93, v165, v166
    v_fma_f32 v90, v90, v165, v166
    v_fma_f32 v94, v94, v165, v166
    v_fma_f32 v91, v91, v165, v166
    v_fma_f32 v95, v95, v165, v166
    v_cvt_pk_bf16_f32 v88, v88, v92
    v_cvt_pk_bf16_f32 v89, v89, v93
    v_cvt_pk_bf16_f32 v90, v90, v94
    v_cvt_pk_bf16_f32 v91, v91, v95
    v_mfma_f32_16x16x32_bf16 a[52:55], a[168:171], v[64:67], a[52:55]
    global_store_dwordx4 v1, v[88:91], s[14:15] offset:64 sc1
    v_mfma_f32_16x16x32_bf16 a[52:55], a[236:239], v[132:135], a[52:55]
    v_mfma_f32_16x16x32_bf16 a[52:55], a[232:235], v[128:131], a[52:55]
    v_mfma_f32_16x16x32_bf16 a[56:59], a[240:243], v[128:131], a[56:59]
    v_mfma_f32_16x16x32_bf16 a[56:59], a[244:247], v[132:135], a[56:59]
    v_mfma_f32_16x16x32_bf16 a[56:59], a[176:179], v[64:67], a[56:59]
    v_mfma_f32_16x16x32_bf16 a[56:59], a[180:183], v[68:71], a[56:59]
    v_mfma_f32_16x16x32_bf16 a[60:63], a[188:191], v[68:71], a[60:63]
    v_accvgpr_read_b32 v96, a48
    v_accvgpr_read_b32 v97, a49
    v_accvgpr_read_b32 v98, a50
    v_accvgpr_read_b32 v99, a51
    v_accvgpr_read_b32 v100, a52
    v_accvgpr_read_b32 v101, a53
    v_accvgpr_read_b32 v102, a54
    v_accvgpr_read_b32 v103, a55
    v_fma_f32 v96, v96, v165, v166
    v_fma_f32 v100, v100, v165, v166
    v_fma_f32 v97, v97, v165, v166
    v_fma_f32 v101, v101, v165, v166
    v_fma_f32 v98, v98, v165, v166
    v_fma_f32 v102, v102, v165, v166
    v_fma_f32 v99, v99, v165, v166
    v_fma_f32 v103, v103, v165, v166
    v_cvt_pk_bf16_f32 v96, v96, v100
    v_cvt_pk_bf16_f32 v97, v97, v101
    v_cvt_pk_bf16_f32 v98, v98, v102
    v_cvt_pk_bf16_f32 v99, v99, v103
    v_mfma_f32_16x16x32_bf16 a[60:63], a[184:187], v[64:67], a[60:63]
    global_store_dwordx4 v1, v[96:99], s[14:15] offset:128 sc1
    v_mfma_f32_16x16x32_bf16 a[60:63], a[252:255], v[132:135], a[60:63]
    v_mfma_f32_16x16x32_bf16 a[60:63], a[248:251], v[128:131], a[60:63]
    v_accvgpr_read_b32 v104, a56
    v_accvgpr_read_b32 v105, a57
    v_accvgpr_read_b32 v106, a58
    v_accvgpr_read_b32 v107, a59
    s_nop 3
    v_accvgpr_read_b32 v108, a60
    v_accvgpr_read_b32 v109, a61
    v_accvgpr_read_b32 v110, a62
    v_accvgpr_read_b32 v111, a63
    v_fma_f32 v104, v104, v165, v166
    v_fma_f32 v108, v108, v165, v166
    v_fma_f32 v105, v105, v165, v166
    v_fma_f32 v109, v109, v165, v166
    v_fma_f32 v106, v106, v165, v166
    v_fma_f32 v110, v110, v165, v166
    v_fma_f32 v107, v107, v165, v166
    v_fma_f32 v111, v111, v165, v166
    v_cvt_pk_bf16_f32 v104, v104, v108
    v_cvt_pk_bf16_f32 v105, v105, v109
    v_cvt_pk_bf16_f32 v106, v106, v110
    v_cvt_pk_bf16_f32 v107, v107, v111
    global_store_dwordx4 v1, v[104:107], s[14:15] offset:192 sc1
    s_and_b64 s[64:65], s[64:65], s[66:67]
    s_and_b64 s[64:65], s[64:65], s[68:69]
    s_and_b64 s[64:65], s[64:65], s[70:71]
    s_and_b64 s[64:65], s[64:65], s[72:73]
    s_and_b64 s[64:65], s[64:65], s[74:75]
    s_and_b64 s[64:65], s[64:65], s[76:77]
    s_and_b64 s[64:65], s[64:65], s[78:79]
    s_cmp_eq_u64 s[64:65], exec
    s_cbranch_scc0 Lslow
Ldone:
Lend:
    s_endpgm
Lrecheck:
    s_cselect_b32 s59, 1, 0
    s_mov_b32 s57, 0
Lrecheck_loop:
    global_load_ubyte v9, v15, s[6:7] sc1
    global_load_dword v10, v8, s[70:71] sc1
    s_add_u32 s57, s57, 1
    s_cmp_gt_u32 s57, 65536
    s_cbranch_scc1 Lrecheck_fail
    s_waitcnt vmcnt(0)
    v_and_or_b32 v10, v10, 3, 4
    v_cmp_ne_u32 vcc, v9, v10
    s_cbranch_vccnz Lrecheck_loop
    s_cmp_lg_u32 s59, 0
    s_branch Lchecked
Lrecheck_fail:
    s_waitcnt vmcnt(0)
    v_mov_b32 v9, 135168
    v_mov_b32 v10, 0x7fc00000
    ds_write_b32 v9, v10
    s_waitcnt lgkmcnt(0)
    s_cmp_lg_u32 s59, 0
    s_branch Lchecked
Lslow:
    s_waitcnt vmcnt(0) lgkmcnt(0)
    v_mov_b32 v80, 0
    v_mov_b32 v81, 0
    v_mov_b32 v82, 0
    v_mov_b32 v83, 0
    v_mov_b32 v84, 0
    v_mov_b32 v85, 0
    v_mov_b32 v86, 0
    v_mov_b32 v87, 0
    v_mov_b32 v88, 0
    v_mov_b32 v89, 0
    v_mov_b32 v90, 0
    v_mov_b32 v91, 0
    v_mov_b32 v92, 0
    v_mov_b32 v93, 0
    v_mov_b32 v94, 0
    v_mov_b32 v95, 0
    v_mov_b32 v96, 0
    v_mov_b32 v97, 0
    v_mov_b32 v98, 0
    v_mov_b32 v99, 0
    v_mov_b32 v100, 0
    v_mov_b32 v101, 0
    v_mov_b32 v102, 0
    v_mov_b32 v103, 0
    v_mov_b32 v104, 0
    v_mov_b32 v105, 0
    v_mov_b32 v106, 0
    v_mov_b32 v107, 0
    v_mov_b32 v108, 0
    v_mov_b32 v109, 0
    v_mov_b32 v110, 0
    v_mov_b32 v111, 0
    v_mov_b32 v112, 0
    v_mov_b32 v113, 0
    v_mov_b32 v114, 0
    v_mov_b32 v115, 0
    v_mov_b32 v116, 0
    v_mov_b32 v117, 0
    v_mov_b32 v118, 0
    v_mov_b32 v119, 0
    v_mov_b32 v120, 0
    v_mov_b32 v121, 0
    v_mov_b32 v122, 0
    v_mov_b32 v123, 0
    v_mov_b32 v124, 0
    v_mov_b32 v125, 0
    v_mov_b32 v126, 0
    v_mov_b32 v127, 0
    v_mov_b32 v128, 0
    v_mov_b32 v129, 0
    v_mov_b32 v130, 0
    v_mov_b32 v131, 0
    v_mov_b32 v132, 0
    v_mov_b32 v133, 0
    v_mov_b32 v134, 0
    v_mov_b32 v135, 0
    v_mov_b32 v136, 0
    v_mov_b32 v137, 0
    v_mov_b32 v138, 0
    v_mov_b32 v139, 0
    v_mov_b32 v140, 0
    v_mov_b32 v141, 0
    v_mov_b32 v142, 0
    v_mov_b32 v143, 0
    v_mov_b32 v152, 0
    v_mov_b32 v153, 0
    v_mov_b32 v154, 0
    v_mov_b32 v155, 0
    v_mov_b32 v156, 0
    v_mov_b32 v157, 0
    v_mov_b32 v158, 0
    v_mov_b32 v159, 0
    v_mov_b32 v160, 0
    v_mov_b32 v161, 0
    v_mov_b32 v162, 0
    v_mov_b32 v163, 0
    v_mov_b32 v164, 0
    v_mov_b32 v165, 0
    v_mov_b32 v166, 0
    v_mov_b32 v167, 0
    v_mov_b32 v176, 0
    v_mov_b32 v177, 0
    v_mov_b32 v178, 0
    v_mov_b32 v179, 0
    v_mov_b32 v180, 0
    v_mov_b32 v181, 0
    v_mov_b32 v182, 0
    v_mov_b32 v183, 0
    v_mov_b32 v184, 0
    v_mov_b32 v185, 0
    v_mov_b32 v186, 0
    v_mov_b32 v187, 0
    v_mov_b32 v188, 0
    v_mov_b32 v189, 0
    v_mov_b32 v190, 0
    v_mov_b32 v191, 0
    v_mov_b32 v192, 0
    v_mov_b32 v193, 0
    v_mov_b32 v194, 0
    v_mov_b32 v195, 0
    v_mov_b32 v196, 0
    v_mov_b32 v197, 0
    v_mov_b32 v198, 0
    v_mov_b32 v199, 0
    v_mov_b32 v200, 0
    v_mov_b32 v201, 0
    v_mov_b32 v202, 0
    v_mov_b32 v203, 0
    v_mov_b32 v204, 0
    v_mov_b32 v205, 0
    v_mov_b32 v206, 0
    v_mov_b32 v207, 0
    v_mov_b32 v208, 0
    v_mov_b32 v209, 0
    v_mov_b32 v210, 0
    v_mov_b32 v211, 0
    v_mov_b32 v212, 0
    v_mov_b32 v213, 0
    v_mov_b32 v214, 0
    v_mov_b32 v215, 0
    v_mov_b32 v216, 0
    v_mov_b32 v217, 0
    v_mov_b32 v218, 0
    v_mov_b32 v219, 0
    v_mov_b32 v220, 0
    v_mov_b32 v221, 0
    v_mov_b32 v222, 0
    v_mov_b32 v223, 0
    v_mov_b32 v224, 0
    v_mov_b32 v225, 0
    v_mov_b32 v226, 0
    v_mov_b32 v227, 0
    v_mov_b32 v228, 0
    v_mov_b32 v229, 0
    v_mov_b32 v230, 0
    v_mov_b32 v231, 0
    v_mov_b32 v232, 0
    v_mov_b32 v233, 0
    v_mov_b32 v234, 0
    v_mov_b32 v235, 0
    v_mov_b32 v236, 0
    v_mov_b32 v237, 0
    v_mov_b32 v238, 0
    v_mov_b32 v239, 0
    v_mov_b32 v248, 0xff800000
    v_mov_b32 v249, 0xff800000
    v_mov_b32 v250, 0xff800000
    v_mov_b32 v251, 0xff800000
    s_mov_b32 s17, 0
    s_mov_b32 s61, s16
    s_mov_b32 s16, 0
Lslow_loop:
    s_lshl_b32 s33, s32, 6
    s_add_u32 s33, s33, s17
    v_and_b32 v14, 15, v0
    v_bfe_u32 v15, v0, 4, 2
    s_lshl_b32 s56, s33, 14
    s_lshr_b32 s57, s16, 1
    s_lshl_b32 s57, s57, 13
    s_add_u32 s57, s57, s56
    s_and_b32 s58, s16, 1
    s_lshl_b32 s59, s58, 8
    s_add_u32 s57, s57, s59
    v_lshlrev_b32 v8, 9, v14
    v_lshl_add_u32 v8, v15, 5, v8
    v_add_u32 v8, s57, v8
    s_lshr_b32 s57, s33, 2
    s_lshl_b32 s57, s57, 8
    s_lshl_b32 s59, s58, 7
    s_add_u32 s57, s57, s59
    v_lshl_add_u32 v9, v15, 4, s57
    s_lshl_b32 s57, s16, 7
    s_add_u32 s57, s57, s56
    v_lshlrev_b32 v10, 11, v15
    v_lshl_add_u32 v10, v14, 3, v10
    v_add_u32 v10, s57, v10
    v_add_u32 v11, 0x2000, v10
    s_lshl_b32 s57, s33, 6
    v_lshl_add_u32 v12, v15, 3, s57
    v_add_u32 v7, 0x2000, v8
    global_load_dwordx4 v[48:51], v8, s[38:39] offset:0
    global_load_dwordx4 v[52:55], v8, s[38:39] offset:16
    global_load_dwordx4 v[56:59], v8, s[38:39] offset:128
    global_load_dwordx4 v[60:63], v8, s[38:39] offset:144
    global_load_dwordx4 v[64:67], v9, s[42:43] offset:0
    global_load_dwordx4 v[72:75], v9, s[44:45] offset:0
    global_load_dwordx4 v[68:71], v9, s[42:43] offset:64
    global_load_dwordx4 v[76:79], v9, s[44:45] offset:64
    s_waitcnt vmcnt(0)
    v_lshlrev_b32 v168, 16, v64
    v_lshlrev_b32 v169, 16, v72
    v_cvt_f32_i32 v48, v48
    v_mul_f32 v168, s28, v168
    v_sub_f32 v48, v48, v169
    v_mul_f32 v48, v48, v168
    v_and_b32 v170, s29, v64
    v_and_b32 v171, s29, v72
    v_cvt_f32_i32 v49, v49
    v_mul_f32 v170, s28, v170
    v_sub_f32 v49, v49, v171
    v_mul_f32 v49, v49, v170
    v_lshlrev_b32 v168, 16, v65
    v_lshlrev_b32 v169, 16, v73
    v_cvt_f32_i32 v50, v50
    v_mul_f32 v168, s28, v168
    v_sub_f32 v50, v50, v169
    v_mul_f32 v50, v50, v168
    v_and_b32 v170, s29, v65
    v_and_b32 v171, s29, v73
    v_cvt_f32_i32 v51, v51
    v_mul_f32 v170, s28, v170
    v_sub_f32 v51, v51, v171
    v_mul_f32 v51, v51, v170
    v_lshlrev_b32 v168, 16, v66
    v_lshlrev_b32 v169, 16, v74
    v_cvt_f32_i32 v52, v52
    v_mul_f32 v168, s28, v168
    v_sub_f32 v52, v52, v169
    v_mul_f32 v52, v52, v168
    v_and_b32 v170, s29, v66
    v_and_b32 v171, s29, v74
    v_cvt_f32_i32 v53, v53
    v_mul_f32 v170, s28, v170
    v_sub_f32 v53, v53, v171
    v_mul_f32 v53, v53, v170
    v_lshlrev_b32 v168, 16, v67
    v_lshlrev_b32 v169, 16, v75
    v_cvt_f32_i32 v54, v54
    v_mul_f32 v168, s28, v168
    v_sub_f32 v54, v54, v169
    v_mul_f32 v54, v54, v168
    v_and_b32 v170, s29, v67
    v_and_b32 v171, s29, v75
    v_cvt_f32_i32 v55, v55
    v_mul_f32 v170, s28, v170
    v_sub_f32 v55, v55, v171
    v_mul_f32 v55, v55, v170
    v_cvt_pk_bf16_f32 v144, v48, v49
    v_cvt_pk_bf16_f32 v145, v50, v51
    v_cvt_pk_bf16_f32 v146, v52, v53
    v_cvt_pk_bf16_f32 v147, v54, v55
    v_lshlrev_b32 v168, 16, v68
    v_lshlrev_b32 v169, 16, v76
    v_cvt_f32_i32 v56, v56
    v_mul_f32 v168, s28, v168
    v_sub_f32 v56, v56, v169
    v_mul_f32 v56, v56, v168
    v_and_b32 v170, s29, v68
    v_and_b32 v171, s29, v76
    v_cvt_f32_i32 v57, v57
    v_mul_f32 v170, s28, v170
    v_sub_f32 v57, v57, v171
    v_mul_f32 v57, v57, v170
    v_lshlrev_b32 v168, 16, v69
    v_lshlrev_b32 v169, 16, v77
    v_cvt_f32_i32 v58, v58
    v_mul_f32 v168, s28, v168
    v_sub_f32 v58, v58, v169
    v_mul_f32 v58, v58, v168
    v_and_b32 v170, s29, v69
    v_and_b32 v171, s29, v77
    v_cvt_f32_i32 v59, v59
    v_mul_f32 v170, s28, v170
    v_sub_f32 v59, v59, v171
    v_mul_f32 v59, v59, v170
    v_lshlrev_b32 v168, 16, v70
    v_lshlrev_b32 v169, 16, v78
    v_cvt_f32_i32 v60, v60
    v_mul_f32 v168, s28, v168
    v_sub_f32 v60, v60, v169
    v_mul_f32 v60, v60, v168
    v_and_b32 v170, s29, v70
    v_and_b32 v171, s29, v78
    v_cvt_f32_i32 v61, v61
    v_mul_f32 v170, s28, v170
    v_sub_f32 v61, v61, v171
    v_mul_f32 v61, v61, v170
    v_lshlrev_b32 v168, 16, v71
    v_lshlrev_b32 v169, 16, v79
    v_cvt_f32_i32 v62, v62
    v_mul_f32 v168, s28, v168
    v_sub_f32 v62, v62, v169
    v_mul_f32 v62, v62, v168
    v_and_b32 v170, s29, v71
    v_and_b32 v171, s29, v79
    v_cvt_f32_i32 v63, v63
    v_mul_f32 v170, s28, v170
    v_sub_f32 v63, v63, v171
    v_mul_f32 v63, v63, v170
    v_cvt_pk_bf16_f32 v148, v56, v57
    v_cvt_pk_bf16_f32 v149, v58, v59
    v_cvt_pk_bf16_f32 v150, v60, v61
    v_cvt_pk_bf16_f32 v151, v62, v63
    s_nop 1
    v_mfma_f32_16x16x32_bf16 v[16:19], v[144:147], a[64:67], 0
    v_mfma_f32_16x16x32_bf16 v[24:27], v[144:147], a[80:83], 0
    v_mfma_f32_16x16x32_bf16 v[32:35], v[144:147], a[96:99], 0
    v_mfma_f32_16x16x32_bf16 v[40:43], v[144:147], a[112:115], 0
    v_mfma_f32_16x16x32_bf16 v[16:19], v[148:151], a[68:71], v[16:19]
    v_mfma_f32_16x16x32_bf16 v[24:27], v[148:151], a[84:87], v[24:27]
    v_mfma_f32_16x16x32_bf16 v[32:35], v[148:151], a[100:103], v[32:35]
    v_mfma_f32_16x16x32_bf16 v[40:43], v[148:151], a[116:119], v[40:43]
    global_load_dwordx4 v[48:51], v8, s[38:39] offset:256
    global_load_dwordx4 v[52:55], v8, s[38:39] offset:272
    global_load_dwordx4 v[56:59], v8, s[38:39] offset:384
    global_load_dwordx4 v[60:63], v8, s[38:39] offset:400
    global_load_dwordx4 v[64:67], v9, s[42:43] offset:128
    global_load_dwordx4 v[72:75], v9, s[44:45] offset:128
    global_load_dwordx4 v[68:71], v9, s[42:43] offset:192
    global_load_dwordx4 v[76:79], v9, s[44:45] offset:192
    s_waitcnt vmcnt(0)
    v_lshlrev_b32 v168, 16, v64
    v_lshlrev_b32 v169, 16, v72
    v_cvt_f32_i32 v48, v48
    v_mul_f32 v168, s28, v168
    v_sub_f32 v48, v48, v169
    v_mul_f32 v48, v48, v168
    v_and_b32 v170, s29, v64
    v_and_b32 v171, s29, v72
    v_cvt_f32_i32 v49, v49
    v_mul_f32 v170, s28, v170
    v_sub_f32 v49, v49, v171
    v_mul_f32 v49, v49, v170
    v_lshlrev_b32 v168, 16, v65
    v_lshlrev_b32 v169, 16, v73
    v_cvt_f32_i32 v50, v50
    v_mul_f32 v168, s28, v168
    v_sub_f32 v50, v50, v169
    v_mul_f32 v50, v50, v168
    v_and_b32 v170, s29, v65
    v_and_b32 v171, s29, v73
    v_cvt_f32_i32 v51, v51
    v_mul_f32 v170, s28, v170
    v_sub_f32 v51, v51, v171
    v_mul_f32 v51, v51, v170
    v_lshlrev_b32 v168, 16, v66
    v_lshlrev_b32 v169, 16, v74
    v_cvt_f32_i32 v52, v52
    v_mul_f32 v168, s28, v168
    v_sub_f32 v52, v52, v169
    v_mul_f32 v52, v52, v168
    v_and_b32 v170, s29, v66
    v_and_b32 v171, s29, v74
    v_cvt_f32_i32 v53, v53
    v_mul_f32 v170, s28, v170
    v_sub_f32 v53, v53, v171
    v_mul_f32 v53, v53, v170
    v_lshlrev_b32 v168, 16, v67
    v_lshlrev_b32 v169, 16, v75
    v_cvt_f32_i32 v54, v54
    v_mul_f32 v168, s28, v168
    v_sub_f32 v54, v54, v169
    v_mul_f32 v54, v54, v168
    v_and_b32 v170, s29, v67
    v_and_b32 v171, s29, v75
    v_cvt_f32_i32 v55, v55
    v_mul_f32 v170, s28, v170
    v_sub_f32 v55, v55, v171
    v_mul_f32 v55, v55, v170
    v_cvt_pk_bf16_f32 v144, v48, v49
    v_cvt_pk_bf16_f32 v145, v50, v51
    v_cvt_pk_bf16_f32 v146, v52, v53
    v_cvt_pk_bf16_f32 v147, v54, v55
    v_lshlrev_b32 v168, 16, v68
    v_lshlrev_b32 v169, 16, v76
    v_cvt_f32_i32 v56, v56
    v_mul_f32 v168, s28, v168
    v_sub_f32 v56, v56, v169
    v_mul_f32 v56, v56, v168
    v_and_b32 v170, s29, v68
    v_and_b32 v171, s29, v76
    v_cvt_f32_i32 v57, v57
    v_mul_f32 v170, s28, v170
    v_sub_f32 v57, v57, v171
    v_mul_f32 v57, v57, v170
    v_lshlrev_b32 v168, 16, v69
    v_lshlrev_b32 v169, 16, v77
    v_cvt_f32_i32 v58, v58
    v_mul_f32 v168, s28, v168
    v_sub_f32 v58, v58, v169
    v_mul_f32 v58, v58, v168
    v_and_b32 v170, s29, v69
    v_and_b32 v171, s29, v77
    v_cvt_f32_i32 v59, v59
    v_mul_f32 v170, s28, v170
    v_sub_f32 v59, v59, v171
    v_mul_f32 v59, v59, v170
    v_lshlrev_b32 v168, 16, v70
    v_lshlrev_b32 v169, 16, v78
    v_cvt_f32_i32 v60, v60
    v_mul_f32 v168, s28, v168
    v_sub_f32 v60, v60, v169
    v_mul_f32 v60, v60, v168
    v_and_b32 v170, s29, v70
    v_and_b32 v171, s29, v78
    v_cvt_f32_i32 v61, v61
    v_mul_f32 v170, s28, v170
    v_sub_f32 v61, v61, v171
    v_mul_f32 v61, v61, v170
    v_lshlrev_b32 v168, 16, v71
    v_lshlrev_b32 v169, 16, v79
    v_cvt_f32_i32 v62, v62
    v_mul_f32 v168, s28, v168
    v_sub_f32 v62, v62, v169
    v_mul_f32 v62, v62, v168
    v_and_b32 v170, s29, v71
    v_and_b32 v171, s29, v79
    v_cvt_f32_i32 v63, v63
    v_mul_f32 v170, s28, v170
    v_sub_f32 v63, v63, v171
    v_mul_f32 v63, v63, v170
    v_cvt_pk_bf16_f32 v148, v56, v57
    v_cvt_pk_bf16_f32 v149, v58, v59
    v_cvt_pk_bf16_f32 v150, v60, v61
    v_cvt_pk_bf16_f32 v151, v62, v63
    s_nop 1
    v_mfma_f32_16x16x32_bf16 v[16:19], v[144:147], a[72:75], v[16:19]
    v_mfma_f32_16x16x32_bf16 v[24:27], v[144:147], a[88:91], v[24:27]
    v_mfma_f32_16x16x32_bf16 v[32:35], v[144:147], a[104:107], v[32:35]
    v_mfma_f32_16x16x32_bf16 v[40:43], v[144:147], a[120:123], v[40:43]
    v_mfma_f32_16x16x32_bf16 v[16:19], v[148:151], a[76:79], v[16:19]
    v_mfma_f32_16x16x32_bf16 v[24:27], v[148:151], a[92:95], v[24:27]
    v_mfma_f32_16x16x32_bf16 v[32:35], v[148:151], a[108:111], v[32:35]
    v_mfma_f32_16x16x32_bf16 v[40:43], v[148:151], a[124:127], v[40:43]
    global_load_dwordx4 v[48:51], v7, s[38:39] offset:0
    global_load_dwordx4 v[52:55], v7, s[38:39] offset:16
    global_load_dwordx4 v[56:59], v7, s[38:39] offset:128
    global_load_dwordx4 v[60:63], v7, s[38:39] offset:144
    global_load_dwordx4 v[64:67], v9, s[42:43] offset:0
    global_load_dwordx4 v[72:75], v9, s[44:45] offset:0
    global_load_dwordx4 v[68:71], v9, s[42:43] offset:64
    global_load_dwordx4 v[76:79], v9, s[44:45] offset:64
    s_waitcnt vmcnt(0)
    v_lshlrev_b32 v168, 16, v64
    v_lshlrev_b32 v169, 16, v72
    v_cvt_f32_i32 v48, v48
    v_mul_f32 v168, s28, v168
    v_sub_f32 v48, v48, v169
    v_mul_f32 v48, v48, v168
    v_and_b32 v170, s29, v64
    v_and_b32 v171, s29, v72
    v_cvt_f32_i32 v49, v49
    v_mul_f32 v170, s28, v170
    v_sub_f32 v49, v49, v171
    v_mul_f32 v49, v49, v170
    v_lshlrev_b32 v168, 16, v65
    v_lshlrev_b32 v169, 16, v73
    v_cvt_f32_i32 v50, v50
    v_mul_f32 v168, s28, v168
    v_sub_f32 v50, v50, v169
    v_mul_f32 v50, v50, v168
    v_and_b32 v170, s29, v65
    v_and_b32 v171, s29, v73
    v_cvt_f32_i32 v51, v51
    v_mul_f32 v170, s28, v170
    v_sub_f32 v51, v51, v171
    v_mul_f32 v51, v51, v170
    v_lshlrev_b32 v168, 16, v66
    v_lshlrev_b32 v169, 16, v74
    v_cvt_f32_i32 v52, v52
    v_mul_f32 v168, s28, v168
    v_sub_f32 v52, v52, v169
    v_mul_f32 v52, v52, v168
    v_and_b32 v170, s29, v66
    v_and_b32 v171, s29, v74
    v_cvt_f32_i32 v53, v53
    v_mul_f32 v170, s28, v170
    v_sub_f32 v53, v53, v171
    v_mul_f32 v53, v53, v170
    v_lshlrev_b32 v168, 16, v67
    v_lshlrev_b32 v169, 16, v75
    v_cvt_f32_i32 v54, v54
    v_mul_f32 v168, s28, v168
    v_sub_f32 v54, v54, v169
    v_mul_f32 v54, v54, v168
    v_and_b32 v170, s29, v67
    v_and_b32 v171, s29, v75
    v_cvt_f32_i32 v55, v55
    v_mul_f32 v170, s28, v170
    v_sub_f32 v55, v55, v171
    v_mul_f32 v55, v55, v170
    v_cvt_pk_bf16_f32 v144, v48, v49
    v_cvt_pk_bf16_f32 v145, v50, v51
    v_cvt_pk_bf16_f32 v146, v52, v53
    v_cvt_pk_bf16_f32 v147, v54, v55
    v_lshlrev_b32 v168, 16, v68
    v_lshlrev_b32 v169, 16, v76
    v_cvt_f32_i32 v56, v56
    v_mul_f32 v168, s28, v168
    v_sub_f32 v56, v56, v169
    v_mul_f32 v56, v56, v168
    v_and_b32 v170, s29, v68
    v_and_b32 v171, s29, v76
    v_cvt_f32_i32 v57, v57
    v_mul_f32 v170, s28, v170
    v_sub_f32 v57, v57, v171
    v_mul_f32 v57, v57, v170
    v_lshlrev_b32 v168, 16, v69
    v_lshlrev_b32 v169, 16, v77
    v_cvt_f32_i32 v58, v58
    v_mul_f32 v168, s28, v168
    v_sub_f32 v58, v58, v169
    v_mul_f32 v58, v58, v168
    v_and_b32 v170, s29, v69
    v_and_b32 v171, s29, v77
    v_cvt_f32_i32 v59, v59
    v_mul_f32 v170, s28, v170
    v_sub_f32 v59, v59, v171
    v_mul_f32 v59, v59, v170
    v_lshlrev_b32 v168, 16, v70
    v_lshlrev_b32 v169, 16, v78
    v_cvt_f32_i32 v60, v60
    v_mul_f32 v168, s28, v168
    v_sub_f32 v60, v60, v169
    v_mul_f32 v60, v60, v168
    v_and_b32 v170, s29, v70
    v_and_b32 v171, s29, v78
    v_cvt_f32_i32 v61, v61
    v_mul_f32 v170, s28, v170
    v_sub_f32 v61, v61, v171
    v_mul_f32 v61, v61, v170
    v_lshlrev_b32 v168, 16, v71
    v_lshlrev_b32 v169, 16, v79
    v_cvt_f32_i32 v62, v62
    v_mul_f32 v168, s28, v168
    v_sub_f32 v62, v62, v169
    v_mul_f32 v62, v62, v168
    v_and_b32 v170, s29, v71
    v_and_b32 v171, s29, v79
    v_cvt_f32_i32 v63, v63
    v_mul_f32 v170, s28, v170
    v_sub_f32 v63, v63, v171
    v_mul_f32 v63, v63, v170
    v_cvt_pk_bf16_f32 v148, v56, v57
    v_cvt_pk_bf16_f32 v149, v58, v59
    v_cvt_pk_bf16_f32 v150, v60, v61
    v_cvt_pk_bf16_f32 v151, v62, v63
    s_nop 1
    v_mfma_f32_16x16x32_bf16 v[20:23], v[144:147], a[64:67], 0
    v_mfma_f32_16x16x32_bf16 v[28:31], v[144:147], a[80:83], 0
    v_mfma_f32_16x16x32_bf16 v[36:39], v[144:147], a[96:99], 0
    v_mfma_f32_16x16x32_bf16 v[44:47], v[144:147], a[112:115], 0
    v_mfma_f32_16x16x32_bf16 v[20:23], v[148:151], a[68:71], v[20:23]
    v_mfma_f32_16x16x32_bf16 v[28:31], v[148:151], a[84:87], v[28:31]
    v_mfma_f32_16x16x32_bf16 v[36:39], v[148:151], a[100:103], v[36:39]
    v_mfma_f32_16x16x32_bf16 v[44:47], v[148:151], a[116:119], v[44:47]
    global_load_dwordx4 v[48:51], v7, s[38:39] offset:256
    global_load_dwordx4 v[52:55], v7, s[38:39] offset:272
    global_load_dwordx4 v[56:59], v7, s[38:39] offset:384
    global_load_dwordx4 v[60:63], v7, s[38:39] offset:400
    global_load_dwordx4 v[64:67], v9, s[42:43] offset:128
    global_load_dwordx4 v[72:75], v9, s[44:45] offset:128
    global_load_dwordx4 v[68:71], v9, s[42:43] offset:192
    global_load_dwordx4 v[76:79], v9, s[44:45] offset:192
    s_waitcnt vmcnt(0)
    v_lshlrev_b32 v168, 16, v64
    v_lshlrev_b32 v169, 16, v72
    v_cvt_f32_i32 v48, v48
    v_mul_f32 v168, s28, v168
    v_sub_f32 v48, v48, v169
    v_mul_f32 v48, v48, v168
    v_and_b32 v170, s29, v64
    v_and_b32 v171, s29, v72
    v_cvt_f32_i32 v49, v49
    v_mul_f32 v170, s28, v170
    v_sub_f32 v49, v49, v171
    v_mul_f32 v49, v49, v170
    v_lshlrev_b32 v168, 16, v65
    v_lshlrev_b32 v169, 16, v73
    v_cvt_f32_i32 v50, v50
    v_mul_f32 v168, s28, v168
    v_sub_f32 v50, v50, v169
    v_mul_f32 v50, v50, v168
    v_and_b32 v170, s29, v65
    v_and_b32 v171, s29, v73
    v_cvt_f32_i32 v51, v51
    v_mul_f32 v170, s28, v170
    v_sub_f32 v51, v51, v171
    v_mul_f32 v51, v51, v170
    v_lshlrev_b32 v168, 16, v66
    v_lshlrev_b32 v169, 16, v74
    v_cvt_f32_i32 v52, v52
    v_mul_f32 v168, s28, v168
    v_sub_f32 v52, v52, v169
    v_mul_f32 v52, v52, v168
    v_and_b32 v170, s29, v66
    v_and_b32 v171, s29, v74
    v_cvt_f32_i32 v53, v53
    v_mul_f32 v170, s28, v170
    v_sub_f32 v53, v53, v171
    v_mul_f32 v53, v53, v170
    v_lshlrev_b32 v168, 16, v67
    v_lshlrev_b32 v169, 16, v75
    v_cvt_f32_i32 v54, v54
    v_mul_f32 v168, s28, v168
    v_sub_f32 v54, v54, v169
    v_mul_f32 v54, v54, v168
    v_and_b32 v170, s29, v67
    v_and_b32 v171, s29, v75
    v_cvt_f32_i32 v55, v55
    v_mul_f32 v170, s28, v170
    v_sub_f32 v55, v55, v171
    v_mul_f32 v55, v55, v170
    v_cvt_pk_bf16_f32 v144, v48, v49
    v_cvt_pk_bf16_f32 v145, v50, v51
    v_cvt_pk_bf16_f32 v146, v52, v53
    v_cvt_pk_bf16_f32 v147, v54, v55
    v_lshlrev_b32 v168, 16, v68
    v_lshlrev_b32 v169, 16, v76
    v_cvt_f32_i32 v56, v56
    v_mul_f32 v168, s28, v168
    v_sub_f32 v56, v56, v169
    v_mul_f32 v56, v56, v168
    v_and_b32 v170, s29, v68
    v_and_b32 v171, s29, v76
    v_cvt_f32_i32 v57, v57
    v_mul_f32 v170, s28, v170
    v_sub_f32 v57, v57, v171
    v_mul_f32 v57, v57, v170
    v_lshlrev_b32 v168, 16, v69
    v_lshlrev_b32 v169, 16, v77
    v_cvt_f32_i32 v58, v58
    v_mul_f32 v168, s28, v168
    v_sub_f32 v58, v58, v169
    v_mul_f32 v58, v58, v168
    v_and_b32 v170, s29, v69
    v_and_b32 v171, s29, v77
    v_cvt_f32_i32 v59, v59
    v_mul_f32 v170, s28, v170
    v_sub_f32 v59, v59, v171
    v_mul_f32 v59, v59, v170
    v_lshlrev_b32 v168, 16, v70
    v_lshlrev_b32 v169, 16, v78
    v_cvt_f32_i32 v60, v60
    v_mul_f32 v168, s28, v168
    v_sub_f32 v60, v60, v169
    v_mul_f32 v60, v60, v168
    v_and_b32 v170, s29, v70
    v_and_b32 v171, s29, v78
    v_cvt_f32_i32 v61, v61
    v_mul_f32 v170, s28, v170
    v_sub_f32 v61, v61, v171
    v_mul_f32 v61, v61, v170
    v_lshlrev_b32 v168, 16, v71
    v_lshlrev_b32 v169, 16, v79
    v_cvt_f32_i32 v62, v62
    v_mul_f32 v168, s28, v168
    v_sub_f32 v62, v62, v169
    v_mul_f32 v62, v62, v168
    v_and_b32 v170, s29, v71
    v_and_b32 v171, s29, v79
    v_cvt_f32_i32 v63, v63
    v_mul_f32 v170, s28, v170
    v_sub_f32 v63, v63, v171
    v_mul_f32 v63, v63, v170
    v_cvt_pk_bf16_f32 v148, v56, v57
    v_cvt_pk_bf16_f32 v149, v58, v59
    v_cvt_pk_bf16_f32 v150, v60, v61
    v_cvt_pk_bf16_f32 v151, v62, v63
    s_nop 1
    v_mfma_f32_16x16x32_bf16 v[20:23], v[144:147], a[72:75], v[20:23]
    v_mfma_f32_16x16x32_bf16 v[28:31], v[144:147], a[88:91], v[28:31]
    v_mfma_f32_16x16x32_bf16 v[36:39], v[144:147], a[104:107], v[36:39]
    v_mfma_f32_16x16x32_bf16 v[44:47], v[144:147], a[120:123], v[44:47]
    v_mfma_f32_16x16x32_bf16 v[20:23], v[148:151], a[76:79], v[20:23]
    v_mfma_f32_16x16x32_bf16 v[28:31], v[148:151], a[92:95], v[28:31]
    v_mfma_f32_16x16x32_bf16 v[36:39], v[148:151], a[108:111], v[36:39]
    v_mfma_f32_16x16x32_bf16 v[44:47], v[148:151], a[124:127], v[44:47]
    global_load_dwordx2 v[240:241], v12, s[46:47]
    global_load_dwordx2 v[242:243], v12, s[46:47] offset:32
    global_load_dwordx2 v[244:245], v12, s[48:49]
    global_load_dwordx2 v[246:247], v12, s[48:49] offset:32
    s_nop 7
    v_max3_f32 v253, v16, v17, v18
    v_max3_f32 v253, v253, v19, v20
    v_max3_f32 v253, v253, v21, v22
    v_max3_f32 v253, v253, v23, v248
    v_mov_b32 v254, v253
    s_nop 1
    v_permlane32_swap_b32 v253, v254
    v_max_f32 v253, v253, v254
    v_mov_b32 v254, v253
    s_nop 1
    v_permlane16_swap_b32 v253, v254
    v_max_f32 v253, v253, v254
    v_sub_f32 v252, v248, v253
    v_mov_b32 v248, v253
    v_exp_f32 v252, v252
    v_sub_f32 v16, v16, v253
    v_sub_f32 v17, v17, v253
    v_sub_f32 v18, v18, v253
    v_sub_f32 v19, v19, v253
    v_sub_f32 v20, v20, v253
    v_sub_f32 v21, v21, v253
    v_sub_f32 v22, v22, v253
    v_sub_f32 v23, v23, v253
    v_exp_f32 v16, v16
    v_exp_f32 v17, v17
    v_exp_f32 v18, v18
    v_exp_f32 v19, v19
    v_exp_f32 v20, v20
    v_exp_f32 v21, v21
    v_exp_f32 v22, v22
    v_exp_f32 v23, v23
    v_mul_f32 v152, v152, v252
    v_add_f32 v152, v152, v16
    v_add_f32 v152, v152, v17
    v_add_f32 v152, v152, v18
    v_add_f32 v152, v152, v19
    v_add_f32 v152, v152, v20
    v_add_f32 v152, v152, v21
    v_add_f32 v152, v152, v22
    v_add_f32 v152, v152, v23
    v_cvt_pk_bf16_f32 v16, v16, v17
    v_cvt_pk_bf16_f32 v17, v18, v19
    v_cvt_pk_bf16_f32 v18, v20, v21
    v_cvt_pk_bf16_f32 v19, v22, v23
    v_mul_f32 v176, v176, v252
    v_mul_f32 v177, v177, v252
    v_mul_f32 v178, v178, v252
    v_mul_f32 v179, v179, v252
    v_mul_f32 v180, v180, v252
    v_mul_f32 v181, v181, v252
    v_mul_f32 v182, v182, v252
    v_mul_f32 v183, v183, v252
    v_mul_f32 v184, v184, v252
    v_mul_f32 v185, v185, v252
    v_mul_f32 v186, v186, v252
    v_mul_f32 v187, v187, v252
    v_mul_f32 v188, v188, v252
    v_mul_f32 v189, v189, v252
    v_mul_f32 v190, v190, v252
    v_mul_f32 v191, v191, v252
    v_mul_f32 v192, v192, v252
    v_mul_f32 v193, v193, v252
    v_mul_f32 v194, v194, v252
    v_mul_f32 v195, v195, v252
    v_mul_f32 v196, v196, v252
    v_mul_f32 v197, v197, v252
    v_mul_f32 v198, v198, v252
    v_mul_f32 v199, v199, v252
    v_mul_f32 v200, v200, v252
    v_mul_f32 v201, v201, v252
    v_mul_f32 v202, v202, v252
    v_mul_f32 v203, v203, v252
    v_mul_f32 v204, v204, v252
    v_mul_f32 v205, v205, v252
    v_mul_f32 v206, v206, v252
    v_mul_f32 v207, v207, v252
    v_max3_f32 v253, v24, v25, v26
    v_max3_f32 v253, v253, v27, v28
    v_max3_f32 v253, v253, v29, v30
    v_max3_f32 v253, v253, v31, v249
    v_mov_b32 v254, v253
    s_nop 1
    v_permlane32_swap_b32 v253, v254
    v_max_f32 v253, v253, v254
    v_mov_b32 v254, v253
    s_nop 1
    v_permlane16_swap_b32 v253, v254
    v_max_f32 v253, v253, v254
    v_sub_f32 v252, v249, v253
    v_mov_b32 v249, v253
    v_exp_f32 v252, v252
    v_sub_f32 v24, v24, v253
    v_sub_f32 v25, v25, v253
    v_sub_f32 v26, v26, v253
    v_sub_f32 v27, v27, v253
    v_sub_f32 v28, v28, v253
    v_sub_f32 v29, v29, v253
    v_sub_f32 v30, v30, v253
    v_sub_f32 v31, v31, v253
    v_exp_f32 v24, v24
    v_exp_f32 v25, v25
    v_exp_f32 v26, v26
    v_exp_f32 v27, v27
    v_exp_f32 v28, v28
    v_exp_f32 v29, v29
    v_exp_f32 v30, v30
    v_exp_f32 v31, v31
    v_mul_f32 v156, v156, v252
    v_add_f32 v156, v156, v24
    v_add_f32 v156, v156, v25
    v_add_f32 v156, v156, v26
    v_add_f32 v156, v156, v27
    v_add_f32 v156, v156, v28
    v_add_f32 v156, v156, v29
    v_add_f32 v156, v156, v30
    v_add_f32 v156, v156, v31
    v_cvt_pk_bf16_f32 v24, v24, v25
    v_cvt_pk_bf16_f32 v25, v26, v27
    v_cvt_pk_bf16_f32 v26, v28, v29
    v_cvt_pk_bf16_f32 v27, v30, v31
    v_mul_f32 v208, v208, v252
    v_mul_f32 v209, v209, v252
    v_mul_f32 v210, v210, v252
    v_mul_f32 v211, v211, v252
    v_mul_f32 v212, v212, v252
    v_mul_f32 v213, v213, v252
    v_mul_f32 v214, v214, v252
    v_mul_f32 v215, v215, v252
    v_mul_f32 v216, v216, v252
    v_mul_f32 v217, v217, v252
    v_mul_f32 v218, v218, v252
    v_mul_f32 v219, v219, v252
    v_mul_f32 v220, v220, v252
    v_mul_f32 v221, v221, v252
    v_mul_f32 v222, v222, v252
    v_mul_f32 v223, v223, v252
    v_mul_f32 v224, v224, v252
    v_mul_f32 v225, v225, v252
    v_mul_f32 v226, v226, v252
    v_mul_f32 v227, v227, v252
    v_mul_f32 v228, v228, v252
    v_mul_f32 v229, v229, v252
    v_mul_f32 v230, v230, v252
    v_mul_f32 v231, v231, v252
    v_mul_f32 v232, v232, v252
    v_mul_f32 v233, v233, v252
    v_mul_f32 v234, v234, v252
    v_mul_f32 v235, v235, v252
    v_mul_f32 v236, v236, v252
    v_mul_f32 v237, v237, v252
    v_mul_f32 v238, v238, v252
    v_mul_f32 v239, v239, v252
    v_max3_f32 v253, v32, v33, v34
    v_max3_f32 v253, v253, v35, v36
    v_max3_f32 v253, v253, v37, v38
    v_max3_f32 v253, v253, v39, v250
    v_mov_b32 v254, v253
    s_nop 1
    v_permlane32_swap_b32 v253, v254
    v_max_f32 v253, v253, v254
    v_mov_b32 v254, v253
    s_nop 1
    v_permlane16_swap_b32 v253, v254
    v_max_f32 v253, v253, v254
    v_sub_f32 v252, v250, v253
    v_mov_b32 v250, v253
    v_exp_f32 v252, v252
    v_sub_f32 v32, v32, v253
    v_sub_f32 v33, v33, v253
    v_sub_f32 v34, v34, v253
    v_sub_f32 v35, v35, v253
    v_sub_f32 v36, v36, v253
    v_sub_f32 v37, v37, v253
    v_sub_f32 v38, v38, v253
    v_sub_f32 v39, v39, v253
    v_exp_f32 v32, v32
    v_exp_f32 v33, v33
    v_exp_f32 v34, v34
    v_exp_f32 v35, v35
    v_exp_f32 v36, v36
    v_exp_f32 v37, v37
    v_exp_f32 v38, v38
    v_exp_f32 v39, v39
    v_mul_f32 v160, v160, v252
    v_add_f32 v160, v160, v32
    v_add_f32 v160, v160, v33
    v_add_f32 v160, v160, v34
    v_add_f32 v160, v160, v35
    v_add_f32 v160, v160, v36
    v_add_f32 v160, v160, v37
    v_add_f32 v160, v160, v38
    v_add_f32 v160, v160, v39
    v_cvt_pk_bf16_f32 v32, v32, v33
    v_cvt_pk_bf16_f32 v33, v34, v35
    v_cvt_pk_bf16_f32 v34, v36, v37
    v_cvt_pk_bf16_f32 v35, v38, v39
    v_mul_f32 v80, v80, v252
    v_mul_f32 v81, v81, v252
    v_mul_f32 v82, v82, v252
    v_mul_f32 v83, v83, v252
    v_mul_f32 v84, v84, v252
    v_mul_f32 v85, v85, v252
    v_mul_f32 v86, v86, v252
    v_mul_f32 v87, v87, v252
    v_mul_f32 v88, v88, v252
    v_mul_f32 v89, v89, v252
    v_mul_f32 v90, v90, v252
    v_mul_f32 v91, v91, v252
    v_mul_f32 v92, v92, v252
    v_mul_f32 v93, v93, v252
    v_mul_f32 v94, v94, v252
    v_mul_f32 v95, v95, v252
    v_mul_f32 v96, v96, v252
    v_mul_f32 v97, v97, v252
    v_mul_f32 v98, v98, v252
    v_mul_f32 v99, v99, v252
    v_mul_f32 v100, v100, v252
    v_mul_f32 v101, v101, v252
    v_mul_f32 v102, v102, v252
    v_mul_f32 v103, v103, v252
    v_mul_f32 v104, v104, v252
    v_mul_f32 v105, v105, v252
    v_mul_f32 v106, v106, v252
    v_mul_f32 v107, v107, v252
    v_mul_f32 v108, v108, v252
    v_mul_f32 v109, v109, v252
    v_mul_f32 v110, v110, v252
    v_mul_f32 v111, v111, v252
    v_max3_f32 v253, v40, v41, v42
    v_max3_f32 v253, v253, v43, v44
    v_max3_f32 v253, v253, v45, v46
    v_max3_f32 v253, v253, v47, v251
    v_mov_b32 v254, v253
    s_nop 1
    v_permlane32_swap_b32 v253, v254
    v_max_f32 v253, v253, v254
    v_mov_b32 v254, v253
    s_nop 1
    v_permlane16_swap_b32 v253, v254
    v_max_f32 v253, v253, v254
    v_sub_f32 v252, v251, v253
    v_mov_b32 v251, v253
    v_exp_f32 v252, v252
    v_sub_f32 v40, v40, v253
    v_sub_f32 v41, v41, v253
    v_sub_f32 v42, v42, v253
    v_sub_f32 v43, v43, v253
    v_sub_f32 v44, v44, v253
    v_sub_f32 v45, v45, v253
    v_sub_f32 v46, v46, v253
    v_sub_f32 v47, v47, v253
    v_exp_f32 v40, v40
    v_exp_f32 v41, v41
    v_exp_f32 v42, v42
    v_exp_f32 v43, v43
    v_exp_f32 v44, v44
    v_exp_f32 v45, v45
    v_exp_f32 v46, v46
    v_exp_f32 v47, v47
    v_mul_f32 v164, v164, v252
    v_add_f32 v164, v164, v40
    v_add_f32 v164, v164, v41
    v_add_f32 v164, v164, v42
    v_add_f32 v164, v164, v43
    v_add_f32 v164, v164, v44
    v_add_f32 v164, v164, v45
    v_add_f32 v164, v164, v46
    v_add_f32 v164, v164, v47
    v_cvt_pk_bf16_f32 v40, v40, v41
    v_cvt_pk_bf16_f32 v41, v42, v43
    v_cvt_pk_bf16_f32 v42, v44, v45
    v_cvt_pk_bf16_f32 v43, v46, v47
    v_mul_f32 v112, v112, v252
    v_mul_f32 v113, v113, v252
    v_mul_f32 v114, v114, v252
    v_mul_f32 v115, v115, v252
    v_mul_f32 v116, v116, v252
    v_mul_f32 v117, v117, v252
    v_mul_f32 v118, v118, v252
    v_mul_f32 v119, v119, v252
    v_mul_f32 v120, v120, v252
    v_mul_f32 v121, v121, v252
    v_mul_f32 v122, v122, v252
    v_mul_f32 v123, v123, v252
    v_mul_f32 v124, v124, v252
    v_mul_f32 v125, v125, v252
    v_mul_f32 v126, v126, v252
    v_mul_f32 v127, v127, v252
    v_mul_f32 v128, v128, v252
    v_mul_f32 v129, v129, v252
    v_mul_f32 v130, v130, v252
    v_mul_f32 v131, v131, v252
    v_mul_f32 v132, v132, v252
    v_mul_f32 v133, v133, v252
    v_mul_f32 v134, v134, v252
    v_mul_f32 v135, v135, v252
    v_mul_f32 v136, v136, v252
    v_mul_f32 v137, v137, v252
    v_mul_f32 v138, v138, v252
    v_mul_f32 v139, v139, v252
    v_mul_f32 v140, v140, v252
    v_mul_f32 v141, v141, v252
    v_mul_f32 v142, v142, v252
    v_mul_f32 v143, v143, v252
    s_waitcnt vmcnt(0)
    v_lshlrev_b32 v64, 16, v240
    v_lshlrev_b32 v72, 16, v244
    v_and_b32 v65, s29, v240
    v_and_b32 v73, s29, v244
    v_lshlrev_b32 v66, 16, v241
    v_lshlrev_b32 v74, 16, v245
    v_and_b32 v67, s29, v241
    v_and_b32 v75, s29, v245
    v_lshlrev_b32 v68, 16, v242
    v_lshlrev_b32 v76, 16, v246
    v_and_b32 v69, s29, v242
    v_and_b32 v77, s29, v246
    v_lshlrev_b32 v70, 16, v243
    v_lshlrev_b32 v78, 16, v247
    v_and_b32 v71, s29, v243
    v_and_b32 v79, s29, v247
    global_load_dwordx2 v[48:49], v10, s[40:41] offset:0
    global_load_dwordx2 v[50:51], v10, s[40:41] offset:512
    global_load_dwordx2 v[52:53], v10, s[40:41] offset:1024
    global_load_dwordx2 v[54:55], v10, s[40:41] offset:1536
    global_load_dwordx2 v[56:57], v11, s[40:41] offset:0
    global_load_dwordx2 v[58:59], v11, s[40:41] offset:512
    global_load_dwordx2 v[60:61], v11, s[40:41] offset:1024
    global_load_dwordx2 v[62:63], v11, s[40:41] offset:1536
    s_waitcnt vmcnt(0)
    v_cvt_f32_i32 v48, v48
    v_sub_f32 v48, v48, v72
    v_mul_f32 v48, v48, v64
    v_cvt_f32_i32 v50, v50
    v_sub_f32 v50, v50, v73
    v_mul_f32 v50, v50, v65
    v_cvt_f32_i32 v52, v52
    v_sub_f32 v52, v52, v74
    v_mul_f32 v52, v52, v66
    v_cvt_f32_i32 v54, v54
    v_sub_f32 v54, v54, v75
    v_mul_f32 v54, v54, v67
    v_cvt_f32_i32 v56, v56
    v_sub_f32 v56, v56, v76
    v_mul_f32 v56, v56, v68
    v_cvt_f32_i32 v58, v58
    v_sub_f32 v58, v58, v77
    v_mul_f32 v58, v58, v69
    v_cvt_f32_i32 v60, v60
    v_sub_f32 v60, v60, v78
    v_mul_f32 v60, v60, v70
    v_cvt_f32_i32 v62, v62
    v_sub_f32 v62, v62, v79
    v_mul_f32 v62, v62, v71
    v_cvt_pk_bf16_f32 v144, v48, v50
    v_cvt_pk_bf16_f32 v145, v52, v54
    v_cvt_pk_bf16_f32 v146, v56, v58
    v_cvt_pk_bf16_f32 v147, v60, v62
    v_cvt_f32_i32 v49, v49
    v_sub_f32 v49, v49, v72
    v_mul_f32 v49, v49, v64
    v_cvt_f32_i32 v51, v51
    v_sub_f32 v51, v51, v73
    v_mul_f32 v51, v51, v65
    v_cvt_f32_i32 v53, v53
    v_sub_f32 v53, v53, v74
    v_mul_f32 v53, v53, v66
    v_cvt_f32_i32 v55, v55
    v_sub_f32 v55, v55, v75
    v_mul_f32 v55, v55, v67
    v_cvt_f32_i32 v57, v57
    v_sub_f32 v57, v57, v76
    v_mul_f32 v57, v57, v68
    v_cvt_f32_i32 v59, v59
    v_sub_f32 v59, v59, v77
    v_mul_f32 v59, v59, v69
    v_cvt_f32_i32 v61, v61
    v_sub_f32 v61, v61, v78
    v_mul_f32 v61, v61, v70
    v_cvt_f32_i32 v63, v63
    v_sub_f32 v63, v63, v79
    v_mul_f32 v63, v63, v71
    v_cvt_pk_bf16_f32 v148, v49, v51
    v_cvt_pk_bf16_f32 v149, v53, v55
    v_cvt_pk_bf16_f32 v150, v57, v59
    v_cvt_pk_bf16_f32 v151, v61, v63
    s_nop 1
    v_mfma_f32_16x16x32_bf16 v[176:179], v[144:147], v[16:19], v[176:179]
    v_mfma_f32_16x16x32_bf16 v[208:211], v[144:147], v[24:27], v[208:211]
    v_mfma_f32_16x16x32_bf16 v[80:83], v[144:147], v[32:35], v[80:83]
    v_mfma_f32_16x16x32_bf16 v[112:115], v[144:147], v[40:43], v[112:115]
    v_mfma_f32_16x16x32_bf16 v[180:183], v[148:151], v[16:19], v[180:183]
    v_mfma_f32_16x16x32_bf16 v[212:215], v[148:151], v[24:27], v[212:215]
    v_mfma_f32_16x16x32_bf16 v[84:87], v[148:151], v[32:35], v[84:87]
    v_mfma_f32_16x16x32_bf16 v[116:119], v[148:151], v[40:43], v[116:119]
    global_load_dwordx2 v[48:49], v10, s[40:41] offset:128
    global_load_dwordx2 v[50:51], v10, s[40:41] offset:640
    global_load_dwordx2 v[52:53], v10, s[40:41] offset:1152
    global_load_dwordx2 v[54:55], v10, s[40:41] offset:1664
    global_load_dwordx2 v[56:57], v11, s[40:41] offset:128
    global_load_dwordx2 v[58:59], v11, s[40:41] offset:640
    global_load_dwordx2 v[60:61], v11, s[40:41] offset:1152
    global_load_dwordx2 v[62:63], v11, s[40:41] offset:1664
    s_waitcnt vmcnt(0)
    v_cvt_f32_i32 v48, v48
    v_sub_f32 v48, v48, v72
    v_mul_f32 v48, v48, v64
    v_cvt_f32_i32 v50, v50
    v_sub_f32 v50, v50, v73
    v_mul_f32 v50, v50, v65
    v_cvt_f32_i32 v52, v52
    v_sub_f32 v52, v52, v74
    v_mul_f32 v52, v52, v66
    v_cvt_f32_i32 v54, v54
    v_sub_f32 v54, v54, v75
    v_mul_f32 v54, v54, v67
    v_cvt_f32_i32 v56, v56
    v_sub_f32 v56, v56, v76
    v_mul_f32 v56, v56, v68
    v_cvt_f32_i32 v58, v58
    v_sub_f32 v58, v58, v77
    v_mul_f32 v58, v58, v69
    v_cvt_f32_i32 v60, v60
    v_sub_f32 v60, v60, v78
    v_mul_f32 v60, v60, v70
    v_cvt_f32_i32 v62, v62
    v_sub_f32 v62, v62, v79
    v_mul_f32 v62, v62, v71
    v_cvt_pk_bf16_f32 v144, v48, v50
    v_cvt_pk_bf16_f32 v145, v52, v54
    v_cvt_pk_bf16_f32 v146, v56, v58
    v_cvt_pk_bf16_f32 v147, v60, v62
    v_cvt_f32_i32 v49, v49
    v_sub_f32 v49, v49, v72
    v_mul_f32 v49, v49, v64
    v_cvt_f32_i32 v51, v51
    v_sub_f32 v51, v51, v73
    v_mul_f32 v51, v51, v65
    v_cvt_f32_i32 v53, v53
    v_sub_f32 v53, v53, v74
    v_mul_f32 v53, v53, v66
    v_cvt_f32_i32 v55, v55
    v_sub_f32 v55, v55, v75
    v_mul_f32 v55, v55, v67
    v_cvt_f32_i32 v57, v57
    v_sub_f32 v57, v57, v76
    v_mul_f32 v57, v57, v68
    v_cvt_f32_i32 v59, v59
    v_sub_f32 v59, v59, v77
    v_mul_f32 v59, v59, v69
    v_cvt_f32_i32 v61, v61
    v_sub_f32 v61, v61, v78
    v_mul_f32 v61, v61, v70
    v_cvt_f32_i32 v63, v63
    v_sub_f32 v63, v63, v79
    v_mul_f32 v63, v63, v71
    v_cvt_pk_bf16_f32 v148, v49, v51
    v_cvt_pk_bf16_f32 v149, v53, v55
    v_cvt_pk_bf16_f32 v150, v57, v59
    v_cvt_pk_bf16_f32 v151, v61, v63
    s_nop 1
    v_mfma_f32_16x16x32_bf16 v[184:187], v[144:147], v[16:19], v[184:187]
    v_mfma_f32_16x16x32_bf16 v[216:219], v[144:147], v[24:27], v[216:219]
    v_mfma_f32_16x16x32_bf16 v[88:91], v[144:147], v[32:35], v[88:91]
    v_mfma_f32_16x16x32_bf16 v[120:123], v[144:147], v[40:43], v[120:123]
    v_mfma_f32_16x16x32_bf16 v[188:191], v[148:151], v[16:19], v[188:191]
    v_mfma_f32_16x16x32_bf16 v[220:223], v[148:151], v[24:27], v[220:223]
    v_mfma_f32_16x16x32_bf16 v[92:95], v[148:151], v[32:35], v[92:95]
    v_mfma_f32_16x16x32_bf16 v[124:127], v[148:151], v[40:43], v[124:127]
    global_load_dwordx2 v[48:49], v10, s[40:41] offset:256
    global_load_dwordx2 v[50:51], v10, s[40:41] offset:768
    global_load_dwordx2 v[52:53], v10, s[40:41] offset:1280
    global_load_dwordx2 v[54:55], v10, s[40:41] offset:1792
    global_load_dwordx2 v[56:57], v11, s[40:41] offset:256
    global_load_dwordx2 v[58:59], v11, s[40:41] offset:768
    global_load_dwordx2 v[60:61], v11, s[40:41] offset:1280
    global_load_dwordx2 v[62:63], v11, s[40:41] offset:1792
    s_waitcnt vmcnt(0)
    v_cvt_f32_i32 v48, v48
    v_sub_f32 v48, v48, v72
    v_mul_f32 v48, v48, v64
    v_cvt_f32_i32 v50, v50
    v_sub_f32 v50, v50, v73
    v_mul_f32 v50, v50, v65
    v_cvt_f32_i32 v52, v52
    v_sub_f32 v52, v52, v74
    v_mul_f32 v52, v52, v66
    v_cvt_f32_i32 v54, v54
    v_sub_f32 v54, v54, v75
    v_mul_f32 v54, v54, v67
    v_cvt_f32_i32 v56, v56
    v_sub_f32 v56, v56, v76
    v_mul_f32 v56, v56, v68
    v_cvt_f32_i32 v58, v58
    v_sub_f32 v58, v58, v77
    v_mul_f32 v58, v58, v69
    v_cvt_f32_i32 v60, v60
    v_sub_f32 v60, v60, v78
    v_mul_f32 v60, v60, v70
    v_cvt_f32_i32 v62, v62
    v_sub_f32 v62, v62, v79
    v_mul_f32 v62, v62, v71
    v_cvt_pk_bf16_f32 v144, v48, v50
    v_cvt_pk_bf16_f32 v145, v52, v54
    v_cvt_pk_bf16_f32 v146, v56, v58
    v_cvt_pk_bf16_f32 v147, v60, v62
    v_cvt_f32_i32 v49, v49
    v_sub_f32 v49, v49, v72
    v_mul_f32 v49, v49, v64
    v_cvt_f32_i32 v51, v51
    v_sub_f32 v51, v51, v73
    v_mul_f32 v51, v51, v65
    v_cvt_f32_i32 v53, v53
    v_sub_f32 v53, v53, v74
    v_mul_f32 v53, v53, v66
    v_cvt_f32_i32 v55, v55
    v_sub_f32 v55, v55, v75
    v_mul_f32 v55, v55, v67
    v_cvt_f32_i32 v57, v57
    v_sub_f32 v57, v57, v76
    v_mul_f32 v57, v57, v68
    v_cvt_f32_i32 v59, v59
    v_sub_f32 v59, v59, v77
    v_mul_f32 v59, v59, v69
    v_cvt_f32_i32 v61, v61
    v_sub_f32 v61, v61, v78
    v_mul_f32 v61, v61, v70
    v_cvt_f32_i32 v63, v63
    v_sub_f32 v63, v63, v79
    v_mul_f32 v63, v63, v71
    v_cvt_pk_bf16_f32 v148, v49, v51
    v_cvt_pk_bf16_f32 v149, v53, v55
    v_cvt_pk_bf16_f32 v150, v57, v59
    v_cvt_pk_bf16_f32 v151, v61, v63
    s_nop 1
    v_mfma_f32_16x16x32_bf16 v[192:195], v[144:147], v[16:19], v[192:195]
    v_mfma_f32_16x16x32_bf16 v[224:227], v[144:147], v[24:27], v[224:227]
    v_mfma_f32_16x16x32_bf16 v[96:99], v[144:147], v[32:35], v[96:99]
    v_mfma_f32_16x16x32_bf16 v[128:131], v[144:147], v[40:43], v[128:131]
    v_mfma_f32_16x16x32_bf16 v[196:199], v[148:151], v[16:19], v[196:199]
    v_mfma_f32_16x16x32_bf16 v[228:231], v[148:151], v[24:27], v[228:231]
    v_mfma_f32_16x16x32_bf16 v[100:103], v[148:151], v[32:35], v[100:103]
    v_mfma_f32_16x16x32_bf16 v[132:135], v[148:151], v[40:43], v[132:135]
    global_load_dwordx2 v[48:49], v10, s[40:41] offset:384
    global_load_dwordx2 v[50:51], v10, s[40:41] offset:896
    global_load_dwordx2 v[52:53], v10, s[40:41] offset:1408
    global_load_dwordx2 v[54:55], v10, s[40:41] offset:1920
    global_load_dwordx2 v[56:57], v11, s[40:41] offset:384
    global_load_dwordx2 v[58:59], v11, s[40:41] offset:896
    global_load_dwordx2 v[60:61], v11, s[40:41] offset:1408
    global_load_dwordx2 v[62:63], v11, s[40:41] offset:1920
    s_waitcnt vmcnt(0)
    v_cvt_f32_i32 v48, v48
    v_sub_f32 v48, v48, v72
    v_mul_f32 v48, v48, v64
    v_cvt_f32_i32 v50, v50
    v_sub_f32 v50, v50, v73
    v_mul_f32 v50, v50, v65
    v_cvt_f32_i32 v52, v52
    v_sub_f32 v52, v52, v74
    v_mul_f32 v52, v52, v66
    v_cvt_f32_i32 v54, v54
    v_sub_f32 v54, v54, v75
    v_mul_f32 v54, v54, v67
    v_cvt_f32_i32 v56, v56
    v_sub_f32 v56, v56, v76
    v_mul_f32 v56, v56, v68
    v_cvt_f32_i32 v58, v58
    v_sub_f32 v58, v58, v77
    v_mul_f32 v58, v58, v69
    v_cvt_f32_i32 v60, v60
    v_sub_f32 v60, v60, v78
    v_mul_f32 v60, v60, v70
    v_cvt_f32_i32 v62, v62
    v_sub_f32 v62, v62, v79
    v_mul_f32 v62, v62, v71
    v_cvt_pk_bf16_f32 v144, v48, v50
    v_cvt_pk_bf16_f32 v145, v52, v54
    v_cvt_pk_bf16_f32 v146, v56, v58
    v_cvt_pk_bf16_f32 v147, v60, v62
    v_cvt_f32_i32 v49, v49
    v_sub_f32 v49, v49, v72
    v_mul_f32 v49, v49, v64
    v_cvt_f32_i32 v51, v51
    v_sub_f32 v51, v51, v73
    v_mul_f32 v51, v51, v65
    v_cvt_f32_i32 v53, v53
    v_sub_f32 v53, v53, v74
    v_mul_f32 v53, v53, v66
    v_cvt_f32_i32 v55, v55
    v_sub_f32 v55, v55, v75
    v_mul_f32 v55, v55, v67
    v_cvt_f32_i32 v57, v57
    v_sub_f32 v57, v57, v76
    v_mul_f32 v57, v57, v68
    v_cvt_f32_i32 v59, v59
    v_sub_f32 v59, v59, v77
    v_mul_f32 v59, v59, v69
    v_cvt_f32_i32 v61, v61
    v_sub_f32 v61, v61, v78
    v_mul_f32 v61, v61, v70
    v_cvt_f32_i32 v63, v63
    v_sub_f32 v63, v63, v79
    v_mul_f32 v63, v63, v71
    v_cvt_pk_bf16_f32 v148, v49, v51
    v_cvt_pk_bf16_f32 v149, v53, v55
    v_cvt_pk_bf16_f32 v150, v57, v59
    v_cvt_pk_bf16_f32 v151, v61, v63
    s_nop 1
    v_mfma_f32_16x16x32_bf16 v[200:203], v[144:147], v[16:19], v[200:203]
    v_mfma_f32_16x16x32_bf16 v[232:235], v[144:147], v[24:27], v[232:235]
    v_mfma_f32_16x16x32_bf16 v[104:107], v[144:147], v[32:35], v[104:107]
    v_mfma_f32_16x16x32_bf16 v[136:139], v[144:147], v[40:43], v[136:139]
    v_mfma_f32_16x16x32_bf16 v[204:207], v[148:151], v[16:19], v[204:207]
    v_mfma_f32_16x16x32_bf16 v[236:239], v[148:151], v[24:27], v[236:239]
    v_mfma_f32_16x16x32_bf16 v[108:111], v[148:151], v[32:35], v[108:111]
    v_mfma_f32_16x16x32_bf16 v[140:143], v[148:151], v[40:43], v[140:143]
    s_add_u32 s17, s17, 1
    s_cmp_lt_u32 s17, 64
    s_nop 7
    s_cbranch_scc1 Lslow_loop
    s_mov_b32 s16, s61
    v_mov_b32 v153, v152
    v_mov_b32 v157, v156
    v_mov_b32 v161, v160
    v_mov_b32 v165, v164
    s_nop 1
    v_permlane32_swap_b32 v152, v153
    v_permlane32_swap_b32 v156, v157
    v_permlane32_swap_b32 v160, v161
    v_permlane32_swap_b32 v164, v165
    v_add_f32 v152, v152, v153
    v_add_f32 v156, v156, v157
    v_add_f32 v160, v160, v161
    v_add_f32 v164, v164, v165
    v_mov_b32 v153, v152
    v_mov_b32 v157, v156
    v_mov_b32 v161, v160
    v_mov_b32 v165, v164
    s_nop 1
    v_permlane16_swap_b32 v152, v153
    v_permlane16_swap_b32 v156, v157
    v_permlane16_swap_b32 v160, v161
    v_permlane16_swap_b32 v164, v165
    v_add_f32 v152, v152, v153
    v_add_f32 v156, v156, v157
    v_add_f32 v160, v160, v161
    v_add_f32 v164, v164, v165
    v_rcp_f32 v152, v152
    v_rcp_f32 v156, v156
    v_rcp_f32 v160, v160
    v_rcp_f32 v164, v164
    s_nop 0
    v_pk_mul_f32 v[176:177], v[176:177], v[152:153] op_sel_hi:[1,0]
    v_pk_mul_f32 v[178:179], v[178:179], v[152:153] op_sel_hi:[1,0]
    v_pk_mul_f32 v[180:181], v[180:181], v[152:153] op_sel_hi:[1,0]
    v_pk_mul_f32 v[182:183], v[182:183], v[152:153] op_sel_hi:[1,0]
    v_cvt_pk_bf16_f32 v176, v176, v180
    v_cvt_pk_bf16_f32 v177, v177, v181
    v_cvt_pk_bf16_f32 v178, v178, v182
    v_cvt_pk_bf16_f32 v179, v179, v183
    global_store_dwordx4 v1, v[176:179], s[12:13] offset:-4096 sc1
    v_pk_mul_f32 v[184:185], v[184:185], v[152:153] op_sel_hi:[1,0]
    v_pk_mul_f32 v[186:187], v[186:187], v[152:153] op_sel_hi:[1,0]
    v_pk_mul_f32 v[188:189], v[188:189], v[152:153] op_sel_hi:[1,0]
    v_pk_mul_f32 v[190:191], v[190:191], v[152:153] op_sel_hi:[1,0]
    v_cvt_pk_bf16_f32 v184, v184, v188
    v_cvt_pk_bf16_f32 v185, v185, v189
    v_cvt_pk_bf16_f32 v186, v186, v190
    v_cvt_pk_bf16_f32 v187, v187, v191
    global_store_dwordx4 v1, v[184:187], s[12:13] offset:-4032 sc1
    v_pk_mul_f32 v[192:193], v[192:193], v[152:153] op_sel_hi:[1,0]
    v_pk_mul_f32 v[194:195], v[194:195], v[152:153] op_sel_hi:[1,0]
    v_pk_mul_f32 v[196:197], v[196:197], v[152:153] op_sel_hi:[1,0]
    v_pk_mul_f32 v[198:199], v[198:199], v[152:153] op_sel_hi:[1,0]
    v_cvt_pk_bf16_f32 v192, v192, v196
    v_cvt_pk_bf16_f32 v193, v193, v197
    v_cvt_pk_bf16_f32 v194, v194, v198
    v_cvt_pk_bf16_f32 v195, v195, v199
    global_store_dwordx4 v1, v[192:195], s[12:13] offset:-3968 sc1
    v_pk_mul_f32 v[200:201], v[200:201], v[152:153] op_sel_hi:[1,0]
    v_pk_mul_f32 v[202:203], v[202:203], v[152:153] op_sel_hi:[1,0]
    v_pk_mul_f32 v[204:205], v[204:205], v[152:153] op_sel_hi:[1,0]
    v_pk_mul_f32 v[206:207], v[206:207], v[152:153] op_sel_hi:[1,0]
    v_cvt_pk_bf16_f32 v200, v200, v204
    v_cvt_pk_bf16_f32 v201, v201, v205
    v_cvt_pk_bf16_f32 v202, v202, v206
    v_cvt_pk_bf16_f32 v203, v203, v207
    global_store_dwordx4 v1, v[200:203], s[12:13] offset:-3904 sc1
    v_pk_mul_f32 v[208:209], v[208:209], v[156:157] op_sel_hi:[1,0]
    v_pk_mul_f32 v[210:211], v[210:211], v[156:157] op_sel_hi:[1,0]
    v_pk_mul_f32 v[212:213], v[212:213], v[156:157] op_sel_hi:[1,0]
    v_pk_mul_f32 v[214:215], v[214:215], v[156:157] op_sel_hi:[1,0]
    v_cvt_pk_bf16_f32 v208, v208, v212
    v_cvt_pk_bf16_f32 v209, v209, v213
    v_cvt_pk_bf16_f32 v210, v210, v214
    v_cvt_pk_bf16_f32 v211, v211, v215
    global_store_dwordx4 v1, v[208:211], s[12:13] offset:0 sc1
    v_pk_mul_f32 v[216:217], v[216:217], v[156:157] op_sel_hi:[1,0]
    v_pk_mul_f32 v[218:219], v[218:219], v[156:157] op_sel_hi:[1,0]
    v_pk_mul_f32 v[220:221], v[220:221], v[156:157] op_sel_hi:[1,0]
    v_pk_mul_f32 v[222:223], v[222:223], v[156:157] op_sel_hi:[1,0]
    v_cvt_pk_bf16_f32 v216, v216, v220
    v_cvt_pk_bf16_f32 v217, v217, v221
    v_cvt_pk_bf16_f32 v218, v218, v222
    v_cvt_pk_bf16_f32 v219, v219, v223
    global_store_dwordx4 v1, v[216:219], s[12:13] offset:64 sc1
    v_pk_mul_f32 v[224:225], v[224:225], v[156:157] op_sel_hi:[1,0]
    v_pk_mul_f32 v[226:227], v[226:227], v[156:157] op_sel_hi:[1,0]
    v_pk_mul_f32 v[228:229], v[228:229], v[156:157] op_sel_hi:[1,0]
    v_pk_mul_f32 v[230:231], v[230:231], v[156:157] op_sel_hi:[1,0]
    v_cvt_pk_bf16_f32 v224, v224, v228
    v_cvt_pk_bf16_f32 v225, v225, v229
    v_cvt_pk_bf16_f32 v226, v226, v230
    v_cvt_pk_bf16_f32 v227, v227, v231
    global_store_dwordx4 v1, v[224:227], s[12:13] offset:128 sc1
    v_pk_mul_f32 v[232:233], v[232:233], v[156:157] op_sel_hi:[1,0]
    v_pk_mul_f32 v[234:235], v[234:235], v[156:157] op_sel_hi:[1,0]
    v_pk_mul_f32 v[236:237], v[236:237], v[156:157] op_sel_hi:[1,0]
    v_pk_mul_f32 v[238:239], v[238:239], v[156:157] op_sel_hi:[1,0]
    v_cvt_pk_bf16_f32 v232, v232, v236
    v_cvt_pk_bf16_f32 v233, v233, v237
    v_cvt_pk_bf16_f32 v234, v234, v238
    v_cvt_pk_bf16_f32 v235, v235, v239
    global_store_dwordx4 v1, v[232:235], s[12:13] offset:192 sc1
    v_pk_mul_f32 v[80:81], v[80:81], v[160:161] op_sel_hi:[1,0]
    v_pk_mul_f32 v[82:83], v[82:83], v[160:161] op_sel_hi:[1,0]
    v_pk_mul_f32 v[84:85], v[84:85], v[160:161] op_sel_hi:[1,0]
    v_pk_mul_f32 v[86:87], v[86:87], v[160:161] op_sel_hi:[1,0]
    v_cvt_pk_bf16_f32 v80, v80, v84
    v_cvt_pk_bf16_f32 v81, v81, v85
    v_cvt_pk_bf16_f32 v82, v82, v86
    v_cvt_pk_bf16_f32 v83, v83, v87
    global_store_dwordx4 v1, v[80:83], s[14:15] offset:-4096 sc1
    v_pk_mul_f32 v[88:89], v[88:89], v[160:161] op_sel_hi:[1,0]
    v_pk_mul_f32 v[90:91], v[90:91], v[160:161] op_sel_hi:[1,0]
    v_pk_mul_f32 v[92:93], v[92:93], v[160:161] op_sel_hi:[1,0]
    v_pk_mul_f32 v[94:95], v[94:95], v[160:161] op_sel_hi:[1,0]
    v_cvt_pk_bf16_f32 v88, v88, v92
    v_cvt_pk_bf16_f32 v89, v89, v93
    v_cvt_pk_bf16_f32 v90, v90, v94
    v_cvt_pk_bf16_f32 v91, v91, v95
    global_store_dwordx4 v1, v[88:91], s[14:15] offset:-4032 sc1
    v_pk_mul_f32 v[96:97], v[96:97], v[160:161] op_sel_hi:[1,0]
    v_pk_mul_f32 v[98:99], v[98:99], v[160:161] op_sel_hi:[1,0]
    v_pk_mul_f32 v[100:101], v[100:101], v[160:161] op_sel_hi:[1,0]
    v_pk_mul_f32 v[102:103], v[102:103], v[160:161] op_sel_hi:[1,0]
    v_cvt_pk_bf16_f32 v96, v96, v100
    v_cvt_pk_bf16_f32 v97, v97, v101
    v_cvt_pk_bf16_f32 v98, v98, v102
    v_cvt_pk_bf16_f32 v99, v99, v103
    global_store_dwordx4 v1, v[96:99], s[14:15] offset:-3968 sc1
    v_pk_mul_f32 v[104:105], v[104:105], v[160:161] op_sel_hi:[1,0]
    v_pk_mul_f32 v[106:107], v[106:107], v[160:161] op_sel_hi:[1,0]
    v_pk_mul_f32 v[108:109], v[108:109], v[160:161] op_sel_hi:[1,0]
    v_pk_mul_f32 v[110:111], v[110:111], v[160:161] op_sel_hi:[1,0]
    v_cvt_pk_bf16_f32 v104, v104, v108
    v_cvt_pk_bf16_f32 v105, v105, v109
    v_cvt_pk_bf16_f32 v106, v106, v110
    v_cvt_pk_bf16_f32 v107, v107, v111
    global_store_dwordx4 v1, v[104:107], s[14:15] offset:-3904 sc1
    v_pk_mul_f32 v[112:113], v[112:113], v[164:165] op_sel_hi:[1,0]
    v_pk_mul_f32 v[114:115], v[114:115], v[164:165] op_sel_hi:[1,0]
    v_pk_mul_f32 v[116:117], v[116:117], v[164:165] op_sel_hi:[1,0]
    v_pk_mul_f32 v[118:119], v[118:119], v[164:165] op_sel_hi:[1,0]
    v_cvt_pk_bf16_f32 v112, v112, v116
    v_cvt_pk_bf16_f32 v113, v113, v117
    v_cvt_pk_bf16_f32 v114, v114, v118
    v_cvt_pk_bf16_f32 v115, v115, v119
    global_store_dwordx4 v1, v[112:115], s[14:15] offset:0 sc1
    v_pk_mul_f32 v[120:121], v[120:121], v[164:165] op_sel_hi:[1,0]
    v_pk_mul_f32 v[122:123], v[122:123], v[164:165] op_sel_hi:[1,0]
    v_pk_mul_f32 v[124:125], v[124:125], v[164:165] op_sel_hi:[1,0]
    v_pk_mul_f32 v[126:127], v[126:127], v[164:165] op_sel_hi:[1,0]
    v_cvt_pk_bf16_f32 v120, v120, v124
    v_cvt_pk_bf16_f32 v121, v121, v125
    v_cvt_pk_bf16_f32 v122, v122, v126
    v_cvt_pk_bf16_f32 v123, v123, v127
    global_store_dwordx4 v1, v[120:123], s[14:15] offset:64 sc1
    v_pk_mul_f32 v[128:129], v[128:129], v[164:165] op_sel_hi:[1,0]
    v_pk_mul_f32 v[130:131], v[130:131], v[164:165] op_sel_hi:[1,0]
    v_pk_mul_f32 v[132:133], v[132:133], v[164:165] op_sel_hi:[1,0]
    v_pk_mul_f32 v[134:135], v[134:135], v[164:165] op_sel_hi:[1,0]
    v_cvt_pk_bf16_f32 v128, v128, v132
    v_cvt_pk_bf16_f32 v129, v129, v133
    v_cvt_pk_bf16_f32 v130, v130, v134
    v_cvt_pk_bf16_f32 v131, v131, v135
    global_store_dwordx4 v1, v[128:131], s[14:15] offset:128 sc1
    v_pk_mul_f32 v[136:137], v[136:137], v[164:165] op_sel_hi:[1,0]
    v_pk_mul_f32 v[138:139], v[138:139], v[164:165] op_sel_hi:[1,0]
    v_pk_mul_f32 v[140:141], v[140:141], v[164:165] op_sel_hi:[1,0]
    v_pk_mul_f32 v[142:143], v[142:143], v[164:165] op_sel_hi:[1,0]
    v_cvt_pk_bf16_f32 v136, v136, v140
    v_cvt_pk_bf16_f32 v137, v137, v141
    v_cvt_pk_bf16_f32 v138, v138, v142
    v_cvt_pk_bf16_f32 v139, v139, v143
    global_store_dwordx4 v1, v[136:139], s[14:15] offset:192 sc1
    s_branch Ldone
.section .rodata,"a"
.p2align 6
.amdhsa_kernel standalone__kv_cache_quant_int4_int2_kv_with_per_channel_or_per_token_scales__prompt_kernel
  .amdhsa_next_free_vgpr 512
  .amdhsa_next_free_sgpr 80
  .amdhsa_accum_offset 256
  .amdhsa_group_segment_fixed_size 0
  .amdhsa_kernarg_size 80
  .amdhsa_user_sgpr_count 2
  .amdhsa_user_sgpr_kernarg_segment_ptr 1
  .amdhsa_system_sgpr_workgroup_id_x 1
  .amdhsa_float_denorm_mode_32 3
.end_amdhsa_kernel
.text
```
